```python
import torch

def _softmax(x, axis=-1):
    return torch.softmax(x, dim=axis)
def _gelu(x):
    return torch.nn.functional.gelu(x, approximate="tanh")
def _silu(x):
    return torch.nn.functional.silu(x)
def _sigmoid(x):
    return torch.sigmoid(x)
def _layernorm(x, axis=-1, eps=1e-5):
    m = x.mean(dim=axis, keepdim=True)
    v = x.var(dim=axis, keepdim=True, unbiased=False)
    return (x - m) / torch.sqrt(v + eps)
def _scatter_add(tgt, idx, src, axis=0):
    return tgt.clone().index_add_(axis, idx, src)
def _segment_sum(src, seg, n):
    out = torch.zeros((n,) + src.shape[1:], dtype=src.dtype)
    return out.index_add_(0, seg, src)
def _pad(x, pw):
    flat = tuple(v for pair in reversed(pw) for v in pair)
    return torch.nn.functional.pad(x, flat)

kernel_name = 'recurrent_scan__spectral_gfnet__mixer_channel_mlp__prompt'

def setup_inputs():

    _w = (lambda a: (lambda t: t.to(torch.bfloat16) if t.is_floating_point() else t)(torch.as_tensor(a)))
    def _A_setup():
        B, S, D = 1, 2048, 640
        Df = D // 2 + 1
        return {
            "x": _w((lambda *s: torch.randn(*s, dtype=torch.bfloat16) * 0.05)(B, S, D)),
            "w_r": _w((lambda *s: torch.randn(*s, dtype=torch.bfloat16) * 0.8)(S, Df) * 0.02),
            "w_i": _w((lambda *s: torch.randn(*s, dtype=torch.bfloat16) * 0.8)(S, Df) * 0.02),
        }
    _A_in = _A_setup()

    def _B_setup():
        B, S, D, F = 1, 2048, 640, 1728
        return {
            "x": _w((lambda *s: torch.randn(*s, dtype=torch.bfloat16) * 0.05)(B, S, D)),
            "w1": _w((lambda *s: torch.randn(*s, dtype=torch.bfloat16) * 0.8)(D, F) * (D ** -0.5)),
            "b1": _w((lambda *s: torch.randn(*s, dtype=torch.bfloat16) * 0.8)(F)),
            "w2": _w((lambda *s: torch.randn(*s, dtype=torch.bfloat16) * 0.8)(F, D) * (F ** -0.5)),
            "b2": _w((lambda *s: torch.randn(*s, dtype=torch.bfloat16) * 0.2)(D)),
        }
    _B_in = _B_setup()

    return {
        "A_x": _A_in["x"],
        "A_w_r": _A_in["w_r"],
        "A_w_i": _A_in["w_i"],
        "B_x": _B_in["x"],
        "B_w1": _B_in["w1"],
        "B_b1": _B_in["b1"],
        "B_w2": _B_in["w2"],
        "B_b2": _B_in["b2"],
    }

def reference(A_x, A_w_r, A_w_i, B_x, B_w1, B_b1, B_w2, B_b2):
    def _A_ref(x, w_r, w_i):
        B, S, D = x.shape
        X = (lambda x, axes=(-2,-1): torch.fft.rfft2(x.float(), dim=axes))(x, axes=(-2, -1))
        W = w_r + 1j * w_i
        X = X * W
        y = (lambda x, s, axes=(-2,-1): torch.fft.irfft2(x, s=s, dim=axes).to(torch.bfloat16))(X, (S, D), axes=(-2, -1))
        return y

    def _B_ref(x, w1, b1, w2, b2):
        y = _layernorm(x, axis=-1)
        h = _gelu(torch.einsum("bsd,df->bsf", y, w1) + b1)
        return torch.einsum("bsf,fd->bsd", h, w2) + b2

    x = A_x
    xn = _layernorm(x, axis=-1)
    s = _A_ref(xn, A_w_r, A_w_i)
    g = _silu(_B_ref(xn, B_w1, B_b1, B_w2, B_b2))
    return x + s * g
```

```asm
; @launch grid=(256,1,1) block=(512,1,1) lds=163840
.amdgcn_target "amdgcn-amd-amdhsa--gfx950"
.text
.globl recurrent_scan__spectral_gfnet__mixer_channel_mlp__prompt_kernel
.p2align 8
.type recurrent_scan__spectral_gfnet__mixer_channel_mlp__prompt_kernel,@function
recurrent_scan__spectral_gfnet__mixer_channel_mlp__prompt_kernel:
L_first:
    s_load_dwordx2 s[12:13], s[0:1], 0
    s_load_dwordx2 s[16:17], s[0:1], 32
    s_load_dwordx2 s[24:25], s[0:1], 80
    s_load_dwordx2 s[20:21], s[0:1], 40
    s_load_dwordx2 s[100:101], s[0:1], 72
    s_load_dwordx2 s[8:9], s[0:1], 48
    s_cmp_ge_u32 s2, 256
    s_cbranch_scc1 L_end
    v_lshrrev_b32 v2, 6, v0
    v_and_b32 v1, 63, v0
    v_readfirstlane_b32 s28, v2
    s_and_b32 s54, s2, 1
    s_lshl_b32 s54, s54, 3
    s_lshr_b32 s55, s2, 5
    s_add_u32 s54, s54, s55
    s_bitcmp0_b32 0xe0c0, s54
    s_cbranch_scc1 L_npe
    s_sub_u32 s55, s28, 1
    s_cmp_ge_u32 s55, 2
    s_cbranch_scc1 L_npe
    s_getpc_b64 s[96:97]
L_pe:
    s_bfe_u32 s54, s2, 0x20003
    s_lshl_b32 s55, s55, 2
    s_add_u32 s54, s54, s55
    s_lshl_b32 s54, s54, 13
    v_lshl_add_u32 v9, v1, 7, s54
    v_min_u32 v9, CODE_END - L_pe + 384, v9
    global_load_dword v0, v9, s[96:97]
L_npe:
    s_mov_b32 s14, 2621440
    s_mov_b32 s15, 0x00020000
    s_mov_b32 s18, 2211840
    s_mov_b32 s19, 0x00020000
    s_and_b32 s54, s2, 7
    s_lshr_b32 s55, s2, 3
    s_lshr_b32 s56, s54, 1
    s_lshl_b32 s56, s56, 2
    s_and_b32 s57, s55, 3
    s_add_u32 s29, s56, s57
    s_lshr_b32 s55, s55, 2
    s_and_b32 s54, s54, 1
    s_mul_i32 s57, s57, 3
    s_add_u32 s31, s57, s55
    s_lshl_b32 s30, s54, 3
    s_add_u32 s30, s30, s55
    s_cmp_ge_u32 s31, 10
    s_cselect_b32 s56, 10, 0
    s_sub_u32 s31, s31, s56
    s_lshl_b32 s32, s31, 7
    s_and_b32 s52, s28, 3
    s_lshr_b32 s53, s28, 2
    s_lshl_b32 s72, s52, 12
    s_lshl_b32 s73, s52, 11
    v_lshrrev_b32 v6, 3, v1
    v_mul_u32_u24 v6, 81920, v6
    s_lshl_b32 s55, s29, 2
    s_add_u32 s54, s52, s55
    s_mul_i32 s54, s54, 1280
    v_add_u32 v6, s54, v6
    v_and_b32 v7, 7, v1
    v_lshrrev_b32 v8, 4, v1
    v_xor_b32 v7, v7, v8
    v_lshl_add_u32 v2, v7, 4, v6
    v_xor_b32 v7, 4, v7
    v_lshl_add_u32 v3, v7, 4, v6
    v_add_u32 v3, 655360, v3
    v_add_u32 v4, 1310720, v2
    v_add_u32 v5, 1310720, v3
    s_mov_b32 s22, 3456
    s_mov_b32 s23, 0x00020000
    s_mov_b32 s26, 33554432
    s_mov_b32 s27, 0x00020000
    s_cmp_lt_u32 s30, 6
    s_cbranch_scc1 L_mlp
    s_sub_u32 s30, s30, 6
    s_cmp_lt_u32 s30, 2
    s_cbranch_scc1 L_dft
    s_add_u32 s30, s30, 4
    s_cmp_lt_u32 s30, 11
    s_cbranch_scc1 L_mlp
    s_sub_u32 s30, s30, 9
    s_branch L_dft
L_mlp:
    s_mul_i32 s54, s30, 5
    s_add_u32 s54, s54, 1
    s_lshr_b32 s54, s54, 1
    s_lshl_b32 s58, s54, 7
    s_cmp_eq_u32 s53, 0
    s_cbranch_scc1 L_mlpA
    v_lshrrev_b32 v6, 3, v1
    s_lshl_b32 s54, s52, 4
    v_add_u32 v6, s54, v6
    v_mul_u32_u24 v6, 3456, v6
    v_bfe_u32 v23, v1, 4, 1
    v_lshlrev_b32 v23, 2, v23
    v_and_b32 v24, 7, v1
    v_xor_b32 v23, v23, v24
    v_lshl_add_u32 v6, v23, 4, v6
    v_add_u32 v7, 27648, v6
    s_waitcnt lgkmcnt(0)
    s_add_u32 m0, s72, 81920
    s_nop 0
    buffer_load_dwordx4 v2, s[12:15], s32 offen  lds
    s_add_u32 m0, s72, 82944
    s_nop 0
    buffer_load_dwordx4 v3, s[12:15], s32 offen  lds
    s_add_u32 m0, s72, 83968
    s_nop 0
    buffer_load_dwordx4 v4, s[12:15], s32 offen  lds
    s_add_u32 m0, s72, 84992
    s_nop 0
    buffer_load_dwordx4 v5, s[12:15], s32 offen  lds
    s_mul_i32 s54, s32, 1728
    s_add_u32 s54, s54, s58
    s_add_u32 m0, s73, 0
    s_nop 0
    buffer_load_dwordx4 v6, s[16:19], s54 offen  lds
    s_add_u32 m0, s73, 1024
    s_nop 0
    buffer_load_dwordx4 v7, s[16:19], s54 offen  lds
    s_add_u32 s33, s32, 128
    s_cmp_eq_u32 s33, 1280
    s_cselect_b32 s33, 0, s33
    s_add_u32 s34, s33, 128
    s_cmp_eq_u32 s34, 1280
    s_cselect_b32 s34, 0, s34
    s_add_u32 s35, s34, 128
    s_cmp_eq_u32 s35, 1280
    s_cselect_b32 s35, 0, s35
    s_add_u32 s36, s35, 128
    s_cmp_eq_u32 s36, 1280
    s_cselect_b32 s36, 0, s36
    s_add_u32 s37, s36, 128
    s_cmp_eq_u32 s37, 1280
    s_cselect_b32 s37, 0, s37
    s_add_u32 s38, s37, 128
    s_cmp_eq_u32 s38, 1280
    s_cselect_b32 s38, 0, s38
    s_add_u32 s39, s38, 128
    s_cmp_eq_u32 s39, 1280
    s_cselect_b32 s39, 0, s39
    s_add_u32 s40, s39, 128
    s_cmp_eq_u32 s40, 1280
    s_cselect_b32 s40, 0, s40
    s_add_u32 s41, s40, 128
    s_cmp_eq_u32 s41, 1280
    s_cselect_b32 s41, 0, s41
    v_lshrrev_b32 v8, 2, v1
    s_lshl_b32 s54, s52, 4
    v_add_u32 v8, s54, v8
    v_mul_u32_u24 v8, 3456, v8
    v_and_b32 v23, 3, v1
    v_lshl_add_u32 v8, v23, 4, v8
    s_add_u32 s59, s58, 128
    s_add_u32 s60, s58, 256
    s_sub_u32 s54, s58, 64
    s_bitcmp1_b32 s30, 0
    s_cselect_b32 s60, s54, s60
    s_cmp_eq_u32 s30, 10
    s_cselect_b32 s71, 4, 5
    s_lshl_b32 s56, s29, 2
    s_add_u32 s56, s56, s52
    s_mul_i32 s56, s56, 110592
    s_add_u32 s54, s58, 0
    s_lshl_b32 s61, s54, 5
    s_add_u32 s61, s61, s56
    s_add_u32 s54, s58, 64
    s_lshl_b32 s62, s54, 5
    s_add_u32 s62, s62, s56
    s_add_u32 s54, s59, 0
    s_lshl_b32 s63, s54, 5
    s_add_u32 s63, s63, s56
    s_add_u32 s54, s59, 64
    s_lshl_b32 s64, s54, 5
    s_add_u32 s64, s64, s56
    s_add_u32 s54, s60, 0
    s_lshl_b32 s65, s54, 5
    s_add_u32 s65, s65, s56
    v_and_b32 v23, 31, v1
    v_lshrrev_b32 v21, 5, v1
    v_lshlrev_b32 v19, 4, v23
    v_lshlrev_b32 v18, 4, v1
    v_add_u32 v14, s72, v18
    s_lshl_b32 s31, s29, 2
    s_add_u32 s31, s31, s52
    s_lshl_b32 s31, s31, 4
    s_add_u32 s31, s31, s30
    s_lshl_b32 s31, s31, 7
    s_add_u32 s31, s31, 28442624
    s_mul_i32 s54, s29, 10
    s_lshl_b32 s55, s29, 3
    s_cmp_eq_u32 s30, 10
    s_cselect_b32 s54, s55, s54
    s_cselect_b32 s56, 20, 40
    s_add_u32 s56, s56, 60
    s_mul_i32 s55, s30, 160
    s_add_u32 s54, s54, s55
    s_mul_i32 s66, s54, 1280
    s_mul_i32 s67, s54, 160
    s_add_u32 s67, s67, 20971520
    s_mov_b32 s92, s8
    s_mov_b32 s93, s9
    s_mov_b32 s94, 2211840
    s_mov_b32 s95, 0x00020000
    s_lshl_b32 s57, s52, 6
    s_mov_b32 s55, 276480
    v_add_u32 v176, s57, v1
    v_mov_b32 v180, 2130706432
    v_add_u32 v177, 0, v176
    v_mul_u32_u24 v178, 5243, v177
    v_lshrrev_b32 v178, 19, v178
    v_mul_u32_u24 v179, 100, v178
    v_mov_b32 v182, 1280
    v_sub_u32 v177, v177, v179
    v_cmp_gt_u32 vcc, s56, v177
    v_lshlrev_b32 v179, 4, v177
    v_mad_u32_u24 v179, v178, s55, v179
    v_cndmask_b32 v188, v180, v179, vcc
    v_mul_u32_u24 v179, 205, v177
    v_lshrrev_b32 v179, 11, v179
    v_mul_u32_u24 v181, 10, v179
    v_sub_u32 v177, v177, v181
    v_mul_u32_u24 v178, 80, v178
    v_sub_u32 v181, 1120, v178
    v_cmp_gt_u32 vcc, 5, v177
    s_nop 1
    v_cndmask_b32 v178, v181, v178, vcc
    v_lshl_add_u32 v178, v177, 4, v178
    v_mad_u32_u24 v184, v179, v182, v178
    v_add_u32 v177, 256, v176
    v_mul_u32_u24 v178, 5243, v177
    v_lshrrev_b32 v178, 19, v178
    v_mul_u32_u24 v179, 100, v178
    v_sub_u32 v177, v177, v179
    v_cmp_gt_u32 vcc, s56, v177
    v_lshlrev_b32 v179, 4, v177
    v_mad_u32_u24 v179, v178, s55, v179
    v_cndmask_b32 v189, v180, v179, vcc
    v_mul_u32_u24 v179, 205, v177
    v_lshrrev_b32 v179, 11, v179
    v_mul_u32_u24 v181, 10, v179
    v_sub_u32 v177, v177, v181
    v_mul_u32_u24 v178, 80, v178
    v_sub_u32 v181, 1120, v178
    v_cmp_gt_u32 vcc, 5, v177
    s_nop 1
    v_cndmask_b32 v178, v181, v178, vcc
    v_lshl_add_u32 v178, v177, 4, v178
    v_mad_u32_u24 v185, v179, v182, v178
    v_add_u32 v177, 512, v176
    v_mul_u32_u24 v178, 5243, v177
    v_lshrrev_b32 v178, 19, v178
    v_mul_u32_u24 v179, 100, v178
    v_sub_u32 v177, v177, v179
    v_cmp_gt_u32 vcc, s56, v177
    v_lshlrev_b32 v179, 4, v177
    v_mad_u32_u24 v179, v178, s55, v179
    v_cndmask_b32 v190, v180, v179, vcc
    v_mul_u32_u24 v179, 205, v177
    v_lshrrev_b32 v179, 11, v179
    v_mul_u32_u24 v181, 10, v179
    v_sub_u32 v177, v177, v181
    v_mul_u32_u24 v178, 80, v178
    v_sub_u32 v181, 1120, v178
    v_cmp_gt_u32 vcc, 5, v177
    s_nop 1
    v_cndmask_b32 v178, v181, v178, vcc
    v_lshl_add_u32 v178, v177, 4, v178
    v_mad_u32_u24 v186, v179, v182, v178
    v_add_u32 v177, 768, v176
    v_mul_u32_u24 v178, 5243, v177
    v_lshrrev_b32 v178, 19, v178
    v_mul_u32_u24 v179, 100, v178
    v_sub_u32 v177, v177, v179
    v_cmp_gt_u32 vcc, s56, v177
    v_lshlrev_b32 v179, 4, v177
    v_mad_u32_u24 v179, v178, s55, v179
    v_cndmask_b32 v191, v180, v179, vcc
    v_mul_u32_u24 v179, 205, v177
    v_lshrrev_b32 v179, 11, v179
    v_mul_u32_u24 v181, 10, v179
    v_sub_u32 v177, v177, v181
    v_mul_u32_u24 v178, 80, v178
    v_sub_u32 v181, 1120, v178
    v_cmp_gt_u32 vcc, 5, v177
    s_nop 1
    v_cndmask_b32 v178, v181, v178, vcc
    v_lshl_add_u32 v178, v177, 4, v178
    v_mad_u32_u24 v187, v179, v182, v178
    s_cmp_eq_u32 s52, 0
    s_cselect_b32 vcc_lo, -1, 0
    s_mov_b32 vcc_hi, 0
    v_cndmask_b32 v187, v180, v187, vcc
    v_cndmask_b32 v191, v180, v191, vcc
    s_lshl_b32 s69, s30, 4
    s_add_u32 s69, s69, s29
    s_lshl_b32 s69, s69, 7
    s_add_u32 s69, s69, 28901376
    s_cmp_eq_u32 s52, 0
    s_cselect_b32 s69, s69, 2130706432
    s_lshl_b32 s30, s30, 11
    s_add_u32 s30, s30, 28901376
    s_mov_b64 s[74:75], 0xffff
    v_lshlrev_b32 v11, 7, v1
    s_getpc_b64 s[96:97]
Lot_1:
    s_lshr_b32 s54, s2, 5
    s_lshl_b32 s55, s29, 1
    s_add_u32 s54, s54, s55
    s_and_b32 s54, s54, 7
    s_lshl_b32 s54, s54, 1
    s_and_b32 s55, s2, 1
    s_add_u32 s54, s54, s55
    s_lshl_b32 s54, s54, 5
    s_add_u32 s54, s54, ORDER_TAB - Lot_1
    s_add_u32 s96, s96, s54
    s_addc_u32 s97, s97, 0
    s_load_dwordx4 s[44:47], s[96:97], 0
    s_load_dwordx2 s[48:49], s[96:97], 16
    s_and_b32 s55, s2, 1
    s_mul_i32 s98, s55, 640
    s_lshl_b32 s54, s29, 2
    s_add_u32 s54, s54, s52
    s_lshl_b32 s55, s54, 11
    s_add_u32 s98, s98, s55
    s_add_u32 s99, s98, 28573696
    s_add_u32 s98, s98, 28442624
    s_mul_i32 s54, s54, 110592
    v_lshlrev_b32 v245, 4, v1
    v_add_u32 v240, s54, v245
    s_lshr_b32 s54, s2, 5
    s_mul_i32 s54, s54, 276480
    s_add_u32 s54, s54, 20971520
    v_add_u32 v245, s54, v245
    s_add_u32 s54, s52, 0
    s_mul_i32 s55, s54, 52
    s_lshr_b32 s55, s55, 8
    s_mul_i32 s55, s55, 5
    s_sub_u32 s55, s54, s55
    s_lshl_b32 s55, s55, 10
    v_add_u32 v241, s55, v245
    s_add_u32 s54, s52, 4
    s_mul_i32 s55, s54, 52
    s_lshr_b32 s55, s55, 8
    s_mul_i32 s55, s55, 5
    s_sub_u32 s55, s54, s55
    s_lshl_b32 s55, s55, 10
    v_add_u32 v242, s55, v245
    s_add_u32 s54, s52, 8
    s_mul_i32 s55, s54, 52
    s_lshr_b32 s55, s55, 8
    s_mul_i32 s55, s55, 5
    s_sub_u32 s55, s54, s55
    s_lshl_b32 s55, s55, 10
    v_add_u32 v243, s55, v245
    s_add_u32 s54, s52, 12
    s_mul_i32 s55, s54, 52
    s_lshr_b32 s55, s55, 8
    s_mul_i32 s55, s55, 5
    s_sub_u32 s55, s54, s55
    s_lshl_b32 s55, s55, 10
    s_cmp_eq_u32 s54, 15
    s_cselect_b32 s55, 2130706432, s55
    v_add_u32 v244, s55, v245
    s_mul_i32 s97, s52, 6144
    s_lshl_b32 s7, s52, 10
    s_add_u32 s6, s7, 12288
    s_cmp_eq_u32 s52, 3
    s_cselect_b32 s6, 39936, s6
    s_add_u32 s8, s24, s98
    s_addc_u32 s9, s25, 0
    s_waitcnt vmcnt(0)
    s_barrier
    s_add_u32 m0, s72, 98304
    s_nop 0
    buffer_load_dwordx4 v2, s[12:15], s33 offen  lds
    s_add_u32 m0, s72, 99328
    s_nop 0
    buffer_load_dwordx4 v3, s[12:15], s33 offen  lds
    s_add_u32 m0, s72, 100352
    s_nop 0
    buffer_load_dwordx4 v4, s[12:15], s33 offen  lds
    s_add_u32 m0, s72, 101376
    s_nop 0
    buffer_load_dwordx4 v5, s[12:15], s33 offen  lds
    s_mul_i32 s54, s33, 1728
    s_add_u32 s54, s54, s58
    s_add_u32 m0, s73, 8192
    s_nop 0
    buffer_load_dwordx4 v6, s[16:19], s54 offen  lds
    s_add_u32 m0, s73, 9216
    s_nop 0
    buffer_load_dwordx4 v7, s[16:19], s54 offen  lds
    s_add_u32 m0, s72, 114688
    s_nop 0
    buffer_load_dwordx4 v2, s[12:15], s34 offen  lds
    s_add_u32 m0, s72, 115712
    s_nop 0
    buffer_load_dwordx4 v3, s[12:15], s34 offen  lds
    s_add_u32 m0, s72, 116736
    s_nop 0
    buffer_load_dwordx4 v4, s[12:15], s34 offen  lds
    s_add_u32 m0, s72, 117760
    s_nop 0
    buffer_load_dwordx4 v5, s[12:15], s34 offen  lds
    s_mul_i32 s54, s34, 1728
    s_add_u32 s54, s54, s58
    s_add_u32 m0, s73, 16384
    s_nop 0
    buffer_load_dwordx4 v6, s[16:19], s54 offen  lds
    s_add_u32 m0, s73, 17408
    s_nop 0
    buffer_load_dwordx4 v7, s[16:19], s54 offen  lds
    buffer_load_dwordx4 v[160:163], v184, s[92:95], s66 offen
    buffer_load_dwordx4 v[164:167], v185, s[92:95], s66 offen
    buffer_load_dwordx4 v[168:171], v186, s[92:95], s66 offen
    buffer_load_dwordx4 v[172:175], v187, s[92:95], s66 offen
    s_waitcnt vmcnt(10)
    s_barrier
    s_add_u32 m0, s72, 131072
    s_nop 0
    buffer_load_dwordx4 v2, s[12:15], s35 offen  lds
    s_add_u32 m0, s72, 132096
    s_nop 0
    buffer_load_dwordx4 v3, s[12:15], s35 offen  lds
    s_add_u32 m0, s72, 133120
    s_nop 0
    buffer_load_dwordx4 v4, s[12:15], s35 offen  lds
    s_add_u32 m0, s72, 134144
    s_nop 0
    buffer_load_dwordx4 v5, s[12:15], s35 offen  lds
    s_mul_i32 s54, s35, 1728
    s_add_u32 s54, s54, s58
    s_add_u32 m0, s73, 24576
    s_nop 0
    buffer_load_dwordx4 v6, s[16:19], s54 offen  lds
    s_add_u32 m0, s73, 25600
    s_nop 0
    buffer_load_dwordx4 v7, s[16:19], s54 offen  lds
    s_add_u32 m0, s72, 147456
    s_nop 0
    buffer_load_dwordx4 v2, s[12:15], s36 offen  lds
    s_add_u32 m0, s72, 148480
    s_nop 0
    buffer_load_dwordx4 v3, s[12:15], s36 offen  lds
    s_add_u32 m0, s72, 149504
    s_nop 0
    buffer_load_dwordx4 v4, s[12:15], s36 offen  lds
    s_add_u32 m0, s72, 150528
    s_nop 0
    buffer_load_dwordx4 v5, s[12:15], s36 offen  lds
    s_mul_i32 s54, s36, 1728
    s_add_u32 s54, s54, s58
    s_add_u32 m0, s73, 32768
    s_nop 0
    buffer_load_dwordx4 v6, s[16:19], s54 offen  lds
    s_add_u32 m0, s73, 33792
    s_nop 0
    buffer_load_dwordx4 v7, s[16:19], s54 offen  lds
    s_waitcnt vmcnt(16)
    s_barrier
    s_add_u32 m0, s72, 81920
    s_nop 0
    buffer_load_dwordx4 v2, s[12:15], s37 offen  lds
    s_add_u32 m0, s72, 82944
    s_nop 0
    buffer_load_dwordx4 v3, s[12:15], s37 offen  lds
    s_add_u32 m0, s72, 83968
    s_nop 0
    buffer_load_dwordx4 v4, s[12:15], s37 offen  lds
    s_add_u32 m0, s72, 84992
    s_nop 0
    buffer_load_dwordx4 v5, s[12:15], s37 offen  lds
    s_mul_i32 s54, s37, 1728
    s_add_u32 s54, s54, s58
    s_add_u32 m0, s73, 40960
    s_nop 0
    buffer_load_dwordx4 v6, s[16:19], s54 offen  lds
    s_add_u32 m0, s73, 41984
    s_nop 0
    buffer_load_dwordx4 v7, s[16:19], s54 offen  lds
    s_add_u32 m0, s72, 98304
    s_nop 0
    buffer_load_dwordx4 v2, s[12:15], s38 offen  lds
    s_add_u32 m0, s72, 99328
    s_nop 0
    buffer_load_dwordx4 v3, s[12:15], s38 offen  lds
    s_add_u32 m0, s72, 100352
    s_nop 0
    buffer_load_dwordx4 v4, s[12:15], s38 offen  lds
    s_add_u32 m0, s72, 101376
    s_nop 0
    buffer_load_dwordx4 v5, s[12:15], s38 offen  lds
    s_mul_i32 s54, s38, 1728
    s_add_u32 s54, s54, s58
    s_add_u32 m0, s73, 49152
    s_nop 0
    buffer_load_dwordx4 v6, s[16:19], s54 offen  lds
    s_add_u32 m0, s73, 50176
    s_nop 0
    buffer_load_dwordx4 v7, s[16:19], s54 offen  lds
    s_waitcnt vmcnt(18)
    s_barrier
    s_add_u32 m0, s72, 114688
    s_nop 0
    buffer_load_dwordx4 v2, s[12:15], s39 offen  lds
    s_add_u32 m0, s72, 115712
    s_nop 0
    buffer_load_dwordx4 v3, s[12:15], s39 offen  lds
    s_add_u32 m0, s72, 116736
    s_nop 0
    buffer_load_dwordx4 v4, s[12:15], s39 offen  lds
    s_add_u32 m0, s72, 117760
    s_nop 0
    buffer_load_dwordx4 v5, s[12:15], s39 offen  lds
    s_mul_i32 s54, s39, 1728
    s_add_u32 s54, s54, s58
    s_add_u32 m0, s73, 57344
    s_nop 0
    buffer_load_dwordx4 v6, s[16:19], s54 offen  lds
    s_add_u32 m0, s73, 58368
    s_nop 0
    buffer_load_dwordx4 v7, s[16:19], s54 offen  lds
    s_waitcnt vmcnt(18)
    s_barrier
    s_add_u32 m0, s72, 131072
    s_nop 0
    buffer_load_dwordx4 v2, s[12:15], s40 offen  lds
    s_add_u32 m0, s72, 132096
    s_nop 0
    buffer_load_dwordx4 v3, s[12:15], s40 offen  lds
    s_add_u32 m0, s72, 133120
    s_nop 0
    buffer_load_dwordx4 v4, s[12:15], s40 offen  lds
    s_add_u32 m0, s72, 134144
    s_nop 0
    buffer_load_dwordx4 v5, s[12:15], s40 offen  lds
    s_mul_i32 s54, s40, 1728
    s_add_u32 s54, s54, s58
    s_add_u32 m0, s73, 65536
    s_nop 0
    buffer_load_dwordx4 v6, s[16:19], s54 offen  lds
    s_add_u32 m0, s73, 66560
    s_nop 0
    buffer_load_dwordx4 v7, s[16:19], s54 offen  lds
    s_waitcnt vmcnt(18)
    s_barrier
    s_add_u32 m0, s72, 147456
    s_nop 0
    buffer_load_dwordx4 v2, s[12:15], s41 offen  lds
    s_add_u32 m0, s72, 148480
    s_nop 0
    buffer_load_dwordx4 v3, s[12:15], s41 offen  lds
    s_add_u32 m0, s72, 149504
    s_nop 0
    buffer_load_dwordx4 v4, s[12:15], s41 offen  lds
    s_add_u32 m0, s72, 150528
    s_nop 0
    buffer_load_dwordx4 v5, s[12:15], s41 offen  lds
    s_mul_i32 s54, s41, 1728
    s_add_u32 s54, s54, s58
    s_add_u32 m0, s73, 73728
    s_nop 0
    buffer_load_dwordx4 v6, s[16:19], s54 offen  lds
    s_add_u32 m0, s73, 74752
    s_nop 0
    buffer_load_dwordx4 v7, s[16:19], s54 offen  lds
    s_waitcnt vmcnt(18)
    s_barrier
    s_mul_i32 s54, s32, 1728
    s_add_u32 s54, s54, s59
    s_add_u32 m0, s73, 81920
    s_nop 0
    buffer_load_dwordx4 v6, s[16:19], s54 offen  lds
    s_add_u32 m0, s73, 82944
    s_nop 0
    buffer_load_dwordx4 v7, s[16:19], s54 offen  lds
    s_mul_i32 s54, s33, 1728
    s_add_u32 s54, s54, s59
    s_add_u32 m0, s73, 90112
    s_nop 0
    buffer_load_dwordx4 v6, s[16:19], s54 offen  lds
    s_add_u32 m0, s73, 91136
    s_nop 0
    buffer_load_dwordx4 v7, s[16:19], s54 offen  lds
    s_waitcnt vmcnt(16)
    s_barrier
    s_mul_i32 s54, s34, 1728
    s_add_u32 s54, s54, s59
    s_add_u32 m0, s73, 98304
    s_nop 0
    buffer_load_dwordx4 v6, s[16:19], s54 offen  lds
    s_add_u32 m0, s73, 99328
    s_nop 0
    buffer_load_dwordx4 v7, s[16:19], s54 offen  lds
    s_mul_i32 s54, s35, 1728
    s_add_u32 s54, s54, s59
    s_add_u32 m0, s73, 106496
    s_nop 0
    buffer_load_dwordx4 v6, s[16:19], s54 offen  lds
    s_add_u32 m0, s73, 107520
    s_nop 0
    buffer_load_dwordx4 v7, s[16:19], s54 offen  lds
    buffer_store_dwordx4 v[160:163], v188, s[24:27], s67 offen sc1
    s_waitcnt vmcnt(15)
    s_barrier
    s_mul_i32 s54, s36, 1728
    s_add_u32 s54, s54, s59
    s_add_u32 m0, s73, 114688
    s_nop 0
    buffer_load_dwordx4 v6, s[16:19], s54 offen  lds
    s_add_u32 m0, s73, 115712
    s_nop 0
    buffer_load_dwordx4 v7, s[16:19], s54 offen  lds
    s_mul_i32 s54, s37, 1728
    s_add_u32 s54, s54, s59
    s_add_u32 m0, s73, 122880
    s_nop 0
    buffer_load_dwordx4 v6, s[16:19], s54 offen  lds
    s_add_u32 m0, s73, 123904
    s_nop 0
    buffer_load_dwordx4 v7, s[16:19], s54 offen  lds
    buffer_store_dwordx4 v[164:167], v189, s[24:27], s67 offen sc1
    s_waitcnt vmcnt(14)
    s_barrier
    s_mul_i32 s54, s38, 1728
    s_add_u32 s54, s54, s59
    s_add_u32 m0, s73, 131072
    s_nop 0
    buffer_load_dwordx4 v6, s[16:19], s54 offen  lds
    s_add_u32 m0, s73, 132096
    s_nop 0
    buffer_load_dwordx4 v7, s[16:19], s54 offen  lds
    s_mul_i32 s54, s39, 1728
    s_add_u32 s54, s54, s59
    s_add_u32 m0, s73, 139264
    s_nop 0
    buffer_load_dwordx4 v6, s[16:19], s54 offen  lds
    s_add_u32 m0, s73, 140288
    s_nop 0
    buffer_load_dwordx4 v7, s[16:19], s54 offen  lds
    buffer_store_dwordx4 v[168:171], v190, s[24:27], s67 offen sc1
    s_barrier
    s_mul_i32 s54, s40, 1728
    s_add_u32 s54, s54, s59
    s_add_u32 m0, s73, 147456
    s_nop 0
    buffer_load_dwordx4 v6, s[16:19], s54 offen  lds
    s_add_u32 m0, s73, 148480
    s_nop 0
    buffer_load_dwordx4 v7, s[16:19], s54 offen  lds
    s_mul_i32 s54, s41, 1728
    s_add_u32 s54, s54, s59
    s_add_u32 m0, s73, 155648
    s_nop 0
    buffer_load_dwordx4 v6, s[16:19], s54 offen  lds
    s_add_u32 m0, s73, 156672
    s_nop 0
    buffer_load_dwordx4 v7, s[16:19], s54 offen  lds
    buffer_store_dwordx4 v[172:175], v191, s[24:27], s67 offen sc1
    s_mov_b32 s58, s31
    s_lshl_b32 s54, s52, 9
    v_add_u32 v22, s54, v19
    s_waitcnt vmcnt(6)
    s_barrier
    ds_read_b128 v[24:27], v22 offset:3072
    ds_read_b128 v[80:83], v14 offset:24576
    ds_read_b128 v[84:87], v14 offset:25600
    ds_read_b128 v[88:91], v14 offset:26624
    ds_read_b128 v[92:95], v14 offset:27648
    s_lshr_b32 s55, s73, 1
    s_mul_i32 s54, s32, 1728
    s_add_u32 s54, s54, s60
    s_add_u32 m0, s55, 40960
    s_nop 0
    buffer_load_dwordx4 v8, s[16:19], s54 offen  lds
    s_mul_i32 s54, s33, 1728
    s_add_u32 s54, s54, s60
    s_add_u32 m0, s55, 45056
    s_nop 0
    buffer_load_dwordx4 v8, s[16:19], s54 offen  lds
    s_waitcnt lgkmcnt(3)
    v_mov_b32 v15, v25
    v_mov_b32 v16, v26
    v_mov_b32 v17, v27
    v_readfirstlane_b32 s3, v24
    v_mul_f32 v60, v80, v80
    v_mul_f32 v61, v81, v81
    v_mul_f32 v62, v82, v82
    v_mul_f32 v63, v83, v83
    v_fma_f32 v60, v60, v17, v16
    v_fma_f32 v61, v61, v17, v16
    v_fma_f32 v62, v62, v17, v16
    v_fma_f32 v63, v63, v17, v16
    v_mul_f32 v60, v60, v80
    v_mul_f32 v61, v61, v81
    v_mul_f32 v62, v62, v82
    v_mul_f32 v63, v63, v83
    v_exp_f32 v60, v60
    v_exp_f32 v61, v61
    v_exp_f32 v62, v62
    v_exp_f32 v63, v63
    v_fma_f32 v60, v60, v15, v15
    v_fma_f32 v61, v61, v15, v15
    v_fma_f32 v62, v62, v15, v15
    v_fma_f32 v63, v63, v15, v15
    v_rcp_f32 v60, v60
    v_rcp_f32 v61, v61
    v_rcp_f32 v62, v62
    v_rcp_f32 v63, v63
    v_mul_f32 v80, v80, v60
    v_mul_f32 v81, v81, v61
    v_mul_f32 v82, v82, v62
    v_mul_f32 v83, v83, v63
    v_cvt_pk_bf16_f32 v80, v80, v81
    v_cvt_pk_bf16_f32 v81, v82, v83
    s_mul_i32 s54, s34, 1728
    s_add_u32 s54, s54, s60
    s_add_u32 m0, s55, 49152
    s_nop 0
    buffer_load_dwordx4 v8, s[16:19], s54 offen  lds
    s_mul_i32 s54, s35, 1728
    s_add_u32 s54, s54, s60
    s_add_u32 m0, s55, 53248
    s_nop 0
    buffer_load_dwordx4 v8, s[16:19], s54 offen  lds
    s_waitcnt lgkmcnt(2)
    v_mul_f32 v60, v84, v84
    v_mul_f32 v61, v85, v85
    v_mul_f32 v62, v86, v86
    v_mul_f32 v63, v87, v87
    v_fma_f32 v60, v60, v17, v16
    v_fma_f32 v61, v61, v17, v16
    v_fma_f32 v62, v62, v17, v16
    v_fma_f32 v63, v63, v17, v16
    v_mul_f32 v60, v60, v84
    v_mul_f32 v61, v61, v85
    v_mul_f32 v62, v62, v86
    v_mul_f32 v63, v63, v87
    v_exp_f32 v60, v60
    v_exp_f32 v61, v61
    v_exp_f32 v62, v62
    v_exp_f32 v63, v63
    v_fma_f32 v60, v60, v15, v15
    v_fma_f32 v61, v61, v15, v15
    v_fma_f32 v62, v62, v15, v15
    v_fma_f32 v63, v63, v15, v15
    v_rcp_f32 v60, v60
    v_rcp_f32 v61, v61
    v_rcp_f32 v62, v62
    v_rcp_f32 v63, v63
    v_mul_f32 v84, v84, v60
    v_mul_f32 v85, v85, v61
    v_mul_f32 v86, v86, v62
    v_mul_f32 v87, v87, v63
    v_cvt_pk_bf16_f32 v82, v84, v85
    v_cvt_pk_bf16_f32 v83, v86, v87
    buffer_store_dwordx4 v[80:83], v18, s[24:27], s62 offen offset:0 sc1
    s_waitcnt vmcnt(5)
    s_waitcnt lgkmcnt(0)
    s_barrier
    s_or_b32 s57, s3, 5
    v_mov_b32 v28, s57
    v_mov_b32 v29, 0
    s_mov_b64 exec, 1
    buffer_store_dword v28, v29, s[24:27], s69 offen sc1
    s_mov_b64 exec, -1
    s_mul_i32 s54, s36, 1728
    s_add_u32 s54, s54, s60
    s_add_u32 m0, s55, 57344
    s_nop 0
    buffer_load_dwordx4 v8, s[16:19], s54 offen  lds
    s_mul_i32 s54, s37, 1728
    s_add_u32 s54, s54, s60
    s_add_u32 m0, s55, 61440
    s_nop 0
    buffer_load_dwordx4 v8, s[16:19], s54 offen  lds
    v_mul_f32 v60, v88, v88
    v_mul_f32 v61, v89, v89
    v_mul_f32 v62, v90, v90
    v_mul_f32 v63, v91, v91
    v_fma_f32 v60, v60, v17, v16
    v_fma_f32 v61, v61, v17, v16
    v_fma_f32 v62, v62, v17, v16
    v_fma_f32 v63, v63, v17, v16
    v_mul_f32 v60, v60, v88
    v_mul_f32 v61, v61, v89
    v_mul_f32 v62, v62, v90
    v_mul_f32 v63, v63, v91
    v_exp_f32 v60, v60
    v_exp_f32 v61, v61
    v_exp_f32 v62, v62
    v_exp_f32 v63, v63
    v_fma_f32 v60, v60, v15, v15
    v_fma_f32 v61, v61, v15, v15
    v_fma_f32 v62, v62, v15, v15
    v_fma_f32 v63, v63, v15, v15
    v_rcp_f32 v60, v60
    v_rcp_f32 v61, v61
    v_rcp_f32 v62, v62
    v_rcp_f32 v63, v63
    v_mul_f32 v88, v88, v60
    v_mul_f32 v89, v89, v61
    v_mul_f32 v90, v90, v62
    v_mul_f32 v91, v91, v63
    v_cvt_pk_bf16_f32 v88, v88, v89
    v_cvt_pk_bf16_f32 v89, v90, v91
    s_mul_i32 s54, s38, 1728
    s_add_u32 s54, s54, s60
    s_add_u32 m0, s55, 65536
    s_nop 0
    buffer_load_dwordx4 v8, s[16:19], s54 offen  lds
    s_mul_i32 s54, s39, 1728
    s_add_u32 s54, s54, s60
    s_add_u32 m0, s55, 69632
    s_nop 0
    buffer_load_dwordx4 v8, s[16:19], s54 offen  lds
    v_mul_f32 v60, v92, v92
    v_mul_f32 v61, v93, v93
    v_mul_f32 v62, v94, v94
    v_mul_f32 v63, v95, v95
    v_fma_f32 v60, v60, v17, v16
    v_fma_f32 v61, v61, v17, v16
    v_fma_f32 v62, v62, v17, v16
    v_fma_f32 v63, v63, v17, v16
    v_mul_f32 v60, v60, v92
    v_mul_f32 v61, v61, v93
    v_mul_f32 v62, v62, v94
    v_mul_f32 v63, v63, v95
    v_exp_f32 v60, v60
    v_exp_f32 v61, v61
    v_exp_f32 v62, v62
    v_exp_f32 v63, v63
    v_fma_f32 v60, v60, v15, v15
    v_fma_f32 v61, v61, v15, v15
    v_fma_f32 v62, v62, v15, v15
    v_fma_f32 v63, v63, v15, v15
    v_rcp_f32 v60, v60
    v_rcp_f32 v61, v61
    v_rcp_f32 v62, v62
    v_rcp_f32 v63, v63
    v_mul_f32 v92, v92, v60
    v_mul_f32 v93, v93, v61
    v_mul_f32 v94, v94, v62
    v_mul_f32 v95, v95, v63
    v_cvt_pk_bf16_f32 v90, v92, v93
    v_cvt_pk_bf16_f32 v91, v94, v95
    buffer_store_dwordx4 v[88:91], v18, s[24:27], s62 offen offset:1024 sc1
    s_mul_i32 s54, s40, 1728
    s_add_u32 s54, s54, s60
    s_add_u32 m0, s55, 73728
    s_nop 0
    buffer_load_dwordx4 v8, s[16:19], s54 offen  lds
    s_mul_i32 s54, s41, 1728
    s_add_u32 s54, s54, s60
    s_add_u32 m0, s55, 77824
    s_nop 0
    buffer_load_dwordx4 v8, s[16:19], s54 offen  lds
    s_barrier
    ds_read_b128 v[96:99], v14 offset:8192
    ds_read_b128 v[100:103], v14 offset:9216
    ds_read_b128 v[104:107], v14 offset:10240
    ds_read_b128 v[108:111], v14 offset:11264
    s_waitcnt lgkmcnt(3)
    v_mul_f32 v60, v96, v96
    v_mul_f32 v61, v97, v97
    v_mul_f32 v62, v98, v98
    v_mul_f32 v63, v99, v99
    v_fma_f32 v60, v60, v17, v16
    v_fma_f32 v61, v61, v17, v16
    v_fma_f32 v62, v62, v17, v16
    v_fma_f32 v63, v63, v17, v16
    v_mul_f32 v60, v60, v96
    v_mul_f32 v61, v61, v97
    v_mul_f32 v62, v62, v98
    v_mul_f32 v63, v63, v99
    v_exp_f32 v60, v60
    v_exp_f32 v61, v61
    v_exp_f32 v62, v62
    v_exp_f32 v63, v63
    v_fma_f32 v60, v60, v15, v15
    v_fma_f32 v61, v61, v15, v15
    v_fma_f32 v62, v62, v15, v15
    v_fma_f32 v63, v63, v15, v15
    v_rcp_f32 v60, v60
    v_rcp_f32 v61, v61
    v_rcp_f32 v62, v62
    v_rcp_f32 v63, v63
    v_mul_f32 v96, v96, v60
    v_mul_f32 v97, v97, v61
    v_mul_f32 v98, v98, v62
    v_mul_f32 v99, v99, v63
    v_cvt_pk_bf16_f32 v96, v96, v97
    v_cvt_pk_bf16_f32 v97, v98, v99
    s_waitcnt lgkmcnt(2)
    v_mul_f32 v60, v100, v100
    v_mul_f32 v61, v101, v101
    v_mul_f32 v62, v102, v102
    v_mul_f32 v63, v103, v103
    v_fma_f32 v60, v60, v17, v16
    v_fma_f32 v61, v61, v17, v16
    v_fma_f32 v62, v62, v17, v16
    v_fma_f32 v63, v63, v17, v16
    v_mul_f32 v60, v60, v100
    v_mul_f32 v61, v61, v101
    v_mul_f32 v62, v62, v102
    v_mul_f32 v63, v63, v103
    v_exp_f32 v60, v60
    v_exp_f32 v61, v61
    v_exp_f32 v62, v62
    v_exp_f32 v63, v63
    v_fma_f32 v60, v60, v15, v15
    v_fma_f32 v61, v61, v15, v15
    v_fma_f32 v62, v62, v15, v15
    v_fma_f32 v63, v63, v15, v15
    v_rcp_f32 v60, v60
    v_rcp_f32 v61, v61
    v_rcp_f32 v62, v62
    v_rcp_f32 v63, v63
    v_mul_f32 v100, v100, v60
    v_mul_f32 v101, v101, v61
    v_mul_f32 v102, v102, v62
    v_mul_f32 v103, v103, v63
    v_cvt_pk_bf16_f32 v98, v100, v101
    v_cvt_pk_bf16_f32 v99, v102, v103
    buffer_store_dwordx4 v[96:99], v18, s[24:27], s63 offen offset:0 sc1
    s_mov_b64 exec, s[74:75]
    buffer_load_dword v10, v11, s[24:27], s30 offen offset:0 sc1
    s_mov_b64 exec, -1
    s_waitcnt lgkmcnt(1)
    v_mul_f32 v60, v104, v104
    v_mul_f32 v61, v105, v105
    v_mul_f32 v62, v106, v106
    v_mul_f32 v63, v107, v107
    v_fma_f32 v60, v60, v17, v16
    v_fma_f32 v61, v61, v17, v16
    v_fma_f32 v62, v62, v17, v16
    v_fma_f32 v63, v63, v17, v16
    v_mul_f32 v60, v60, v104
    v_mul_f32 v61, v61, v105
    v_mul_f32 v62, v62, v106
    v_mul_f32 v63, v63, v107
    v_exp_f32 v60, v60
    v_exp_f32 v61, v61
    v_exp_f32 v62, v62
    v_exp_f32 v63, v63
    v_fma_f32 v60, v60, v15, v15
    v_fma_f32 v61, v61, v15, v15
    v_fma_f32 v62, v62, v15, v15
    v_fma_f32 v63, v63, v15, v15
    v_rcp_f32 v60, v60
    v_rcp_f32 v61, v61
    v_rcp_f32 v62, v62
    v_rcp_f32 v63, v63
    v_mul_f32 v104, v104, v60
    v_mul_f32 v105, v105, v61
    v_mul_f32 v106, v106, v62
    v_mul_f32 v107, v107, v63
    v_cvt_pk_bf16_f32 v104, v104, v105
    v_cvt_pk_bf16_f32 v105, v106, v107
    s_waitcnt vmcnt(0)
    s_mov_b32 s56, 0
    s_add_u32 s57, s3, 5
    s_mov_b64 exec, s[74:75]
Lpoll_2:
    v_subrev_u32 v10, s57, v10
    v_cmp_lt_u32 vcc, 2, v10
    s_add_u32 s56, s56, 1
    s_cbranch_vccz Lpoll_2d
    s_cmp_ge_u32 s56, 40000
    s_cbranch_scc1 Lpoll_2d
    s_sleep 2
    buffer_load_dword v10, v11, s[24:27], s30 offen offset:0 sc1
    s_waitcnt vmcnt(0)
    s_branch Lpoll_2
Lpoll_2d:
    s_mov_b64 exec, -1
    s_barrier
    s_or_b32 s57, s3, 2
    v_mov_b32 v28, s57
    v_mov_b32 v29, 0
    s_mov_b64 exec, 1
    buffer_store_dword v28, v29, s[24:27], s58 offen sc1
    s_mov_b64 exec, -1
    s_waitcnt lgkmcnt(0)
    v_mul_f32 v60, v108, v108
    v_mul_f32 v61, v109, v109
    v_mul_f32 v62, v110, v110
    v_mul_f32 v63, v111, v111
    v_fma_f32 v60, v60, v17, v16
    v_fma_f32 v61, v61, v17, v16
    v_fma_f32 v62, v62, v17, v16
    v_fma_f32 v63, v63, v17, v16
    v_mul_f32 v60, v60, v108
    v_mul_f32 v61, v61, v109
    v_mul_f32 v62, v62, v110
    v_mul_f32 v63, v63, v111
    v_exp_f32 v60, v60
    v_exp_f32 v61, v61
    v_exp_f32 v62, v62
    v_exp_f32 v63, v63
    v_fma_f32 v60, v60, v15, v15
    v_fma_f32 v61, v61, v15, v15
    v_fma_f32 v62, v62, v15, v15
    v_fma_f32 v63, v63, v15, v15
    v_rcp_f32 v60, v60
    v_rcp_f32 v61, v61
    v_rcp_f32 v62, v62
    v_rcp_f32 v63, v63
    v_mul_f32 v108, v108, v60
    v_mul_f32 v109, v109, v61
    v_mul_f32 v110, v110, v62
    v_mul_f32 v111, v111, v63
    v_cvt_pk_bf16_f32 v106, v108, v109
    v_cvt_pk_bf16_f32 v107, v110, v111
    buffer_store_dwordx4 v[104:107], v18, s[24:27], s63 offen offset:1024 sc1
    s_barrier
    ds_read_b128 v[120:123], v14 offset:26624
    ds_read_b128 v[124:127], v14 offset:27648
    s_waitcnt lgkmcnt(1)
    v_mul_f32 v60, v120, v120
    v_mul_f32 v61, v121, v121
    v_mul_f32 v62, v122, v122
    v_mul_f32 v63, v123, v123
    v_fma_f32 v60, v60, v17, v16
    v_fma_f32 v61, v61, v17, v16
    v_fma_f32 v62, v62, v17, v16
    v_fma_f32 v63, v63, v17, v16
    v_mul_f32 v60, v60, v120
    v_mul_f32 v61, v61, v121
    v_mul_f32 v62, v62, v122
    v_mul_f32 v63, v63, v123
    v_exp_f32 v60, v60
    v_exp_f32 v61, v61
    v_exp_f32 v62, v62
    v_exp_f32 v63, v63
    v_fma_f32 v60, v60, v15, v15
    v_fma_f32 v61, v61, v15, v15
    v_fma_f32 v62, v62, v15, v15
    v_fma_f32 v63, v63, v15, v15
    v_rcp_f32 v60, v60
    v_rcp_f32 v61, v61
    v_rcp_f32 v62, v62
    v_rcp_f32 v63, v63
    v_mul_f32 v120, v120, v60
    v_mul_f32 v121, v121, v61
    v_mul_f32 v122, v122, v62
    v_mul_f32 v123, v123, v63
    v_cvt_pk_bf16_f32 v120, v120, v121
    v_cvt_pk_bf16_f32 v121, v122, v123
    s_load_dword s10, s[8:9], 0 glc
    s_load_dword s11, s[8:9], 128 glc
    s_load_dword s42, s[8:9], 256 glc
    s_load_dword s43, s[8:9], 384 glc
    s_load_dword s50, s[8:9], 512 glc
    s_load_dword s51, s[8:9], 640 glc
    s_waitcnt lgkmcnt(0)
    v_mul_f32 v60, v124, v124
    v_mul_f32 v61, v125, v125
    v_mul_f32 v62, v126, v126
    v_mul_f32 v63, v127, v127
    v_fma_f32 v60, v60, v17, v16
    v_fma_f32 v61, v61, v17, v16
    v_fma_f32 v62, v62, v17, v16
    v_fma_f32 v63, v63, v17, v16
    v_mul_f32 v60, v60, v124
    v_mul_f32 v61, v61, v125
    v_mul_f32 v62, v62, v126
    v_mul_f32 v63, v63, v127
    v_exp_f32 v60, v60
    v_exp_f32 v61, v61
    v_exp_f32 v62, v62
    v_exp_f32 v63, v63
    v_fma_f32 v60, v60, v15, v15
    v_fma_f32 v61, v61, v15, v15
    v_fma_f32 v62, v62, v15, v15
    v_fma_f32 v63, v63, v15, v15
    v_rcp_f32 v60, v60
    v_rcp_f32 v61, v61
    v_rcp_f32 v62, v62
    v_rcp_f32 v63, v63
    v_mul_f32 v124, v124, v60
    v_mul_f32 v125, v125, v61
    v_mul_f32 v126, v126, v62
    v_mul_f32 v127, v127, v63
    v_cvt_pk_bf16_f32 v122, v124, v125
    v_cvt_pk_bf16_f32 v123, v126, v127
    buffer_store_dwordx4 v[120:123], v18, s[24:27], s64 offen offset:1024 sc1
    s_waitcnt vmcnt(1)
    s_or_b32 s57, s3, 3
    v_mov_b32 v28, s57
    v_mov_b32 v29, 0
    s_mov_b64 exec, 1
    buffer_store_dword v28, v29, s[24:27], s58 offen sc1
    s_mov_b64 exec, -1
    s_mov_b32 s56, 0
    s_add_u32 s57, s3, 2
Lsp_3:
    s_waitcnt lgkmcnt(0)
    s_sub_u32 s10, s10, s57
    s_sub_u32 s11, s11, s57
    s_sub_u32 s42, s42, s57
    s_sub_u32 s43, s43, s57
    s_sub_u32 s50, s50, s57
    s_sub_u32 s51, s51, s57
    s_max_u32 s10, s10, s11
    s_max_u32 s10, s10, s42
    s_max_u32 s10, s10, s43
    s_max_u32 s10, s10, s50
    s_max_u32 s10, s10, s51
    s_cmp_le_u32 s10, 5
    s_cbranch_scc1 Lsp_3d
    s_add_u32 s56, s56, 1
    s_cmp_ge_u32 s56, 40000
    s_cbranch_scc1 Lsp_3d
    s_sleep 2
    s_load_dword s10, s[8:9], 0 glc
    s_load_dword s11, s[8:9], 128 glc
    s_load_dword s42, s[8:9], 256 glc
    s_load_dword s43, s[8:9], 384 glc
    s_load_dword s50, s[8:9], 512 glc
    s_load_dword s51, s[8:9], 640 glc
    s_branch Lsp_3
Lsp_3d:
    s_bfe_u32 s55, s44, 393216
    s_add_u32 m0, s97, 138240
    s_lshl_b32 s55, s55, 11
    buffer_load_dwordx4 v240, s[24:27], s55 offen offset:0 sc1 lds
    buffer_load_dwordx4 v240, s[24:27], s55 offen offset:1024 sc1 lds
    s_bfe_u32 s55, s44, 393222
    s_add_u32 m0, s97, 140288
    s_lshl_b32 s55, s55, 11
    buffer_load_dwordx4 v240, s[24:27], s55 offen offset:0 sc1 lds
    buffer_load_dwordx4 v240, s[24:27], s55 offen offset:1024 sc1 lds
    s_bfe_u32 s55, s44, 393228
    s_add_u32 m0, s97, 142336
    s_lshl_b32 s55, s55, 11
    buffer_load_dwordx4 v240, s[24:27], s55 offen offset:0 sc1 lds
    buffer_load_dwordx4 v240, s[24:27], s55 offen offset:1024 sc1 lds
    s_bfe_u32 s54, s44, 393216
    s_mul_i32 s54, s54, 5120
    s_bfe_u32 s55, s44, 393222
    s_mul_i32 s55, s55, 5120
    s_bfe_u32 s56, s44, 393228
    s_mul_i32 s56, s56, 5120
    s_add_u32 m0, s7, 122880
    s_nop 0
    buffer_load_dwordx4 v241, s[24:27], s54 offen sc1 lds
    s_add_u32 m0, s7, 126976
    s_cmp_eq_u32 s52, 0
    s_cselect_b32 s57, s54, s55
    buffer_load_dwordx4 v242, s[24:27], s57 offen sc1 lds
    s_add_u32 m0, s7, 131072
    s_cmp_lt_u32 s52, 2
    s_cselect_b32 s57, s55, s56
    buffer_load_dwordx4 v243, s[24:27], s57 offen sc1 lds
    s_add_u32 m0, s6, 122880
    s_nop 0
    buffer_load_dwordx4 v244, s[24:27], s56 offen sc1 lds
    s_cmp_eq_u32 s71, 4
    s_cbranch_scc1 L_mlpB4
    s_barrier
    ds_read_b128 v[136:139], v14 offset:10240
    ds_read_b128 v[140:143], v14 offset:11264
    s_waitcnt lgkmcnt(1)
    v_mul_f32 v60, v136, v136
    v_mul_f32 v61, v137, v137
    v_mul_f32 v62, v138, v138
    v_mul_f32 v63, v139, v139
    v_fma_f32 v60, v60, v17, v16
    v_fma_f32 v61, v61, v17, v16
    v_fma_f32 v62, v62, v17, v16
    v_fma_f32 v63, v63, v17, v16
    v_mul_f32 v60, v60, v136
    v_mul_f32 v61, v61, v137
    v_mul_f32 v62, v62, v138
    v_mul_f32 v63, v63, v139
    v_exp_f32 v60, v60
    v_exp_f32 v61, v61
    v_exp_f32 v62, v62
    v_exp_f32 v63, v63
    v_fma_f32 v60, v60, v15, v15
    v_fma_f32 v61, v61, v15, v15
    v_fma_f32 v62, v62, v15, v15
    v_fma_f32 v63, v63, v15, v15
    v_rcp_f32 v60, v60
    v_rcp_f32 v61, v61
    v_rcp_f32 v62, v62
    v_rcp_f32 v63, v63
    v_mul_f32 v136, v136, v60
    v_mul_f32 v137, v137, v61
    v_mul_f32 v138, v138, v62
    v_mul_f32 v139, v139, v63
    v_cvt_pk_bf16_f32 v136, v136, v137
    v_cvt_pk_bf16_f32 v137, v138, v139
    s_waitcnt lgkmcnt(0)
    v_mul_f32 v60, v140, v140
    v_mul_f32 v61, v141, v141
    v_mul_f32 v62, v142, v142
    v_mul_f32 v63, v143, v143
    v_fma_f32 v60, v60, v17, v16
    v_fma_f32 v61, v61, v17, v16
    v_fma_f32 v62, v62, v17, v16
    v_fma_f32 v63, v63, v17, v16
    v_mul_f32 v60, v60, v140
    v_mul_f32 v61, v61, v141
    v_mul_f32 v62, v62, v142
    v_mul_f32 v63, v63, v143
    v_exp_f32 v60, v60
    v_exp_f32 v61, v61
    v_exp_f32 v62, v62
    v_exp_f32 v63, v63
    v_fma_f32 v60, v60, v15, v15
    v_fma_f32 v61, v61, v15, v15
    v_fma_f32 v62, v62, v15, v15
    v_fma_f32 v63, v63, v15, v15
    v_rcp_f32 v60, v60
    v_rcp_f32 v61, v61
    v_rcp_f32 v62, v62
    v_rcp_f32 v63, v63
    v_mul_f32 v140, v140, v60
    v_mul_f32 v141, v141, v61
    v_mul_f32 v142, v142, v62
    v_mul_f32 v143, v143, v63
    v_cvt_pk_bf16_f32 v138, v140, v141
    v_cvt_pk_bf16_f32 v139, v142, v143
    buffer_store_dwordx4 v[136:139], v18, s[24:27], s65 offen offset:1024 sc1
    s_branch L_CB
L_mlpB4:
    s_barrier
    s_branch L_CB
L_mlpA:
    s_setprio 1
    s_memrealtime s[44:45]
    s_or_b32 s55, s2, s28
    s_cmp_lg_u32 s55, 0
    s_waitcnt lgkmcnt(0)
    s_cbranch_scc1 L_notag
    s_lshl_b32 s44, s44, 3
    s_or_b32 s44, s44, 1
    v_mov_b32 v9, 0
    v_mov_b32 v8, s44
    global_store_dword v9, v8, s[100:101] sc1
L_notag:
    s_lshl_b32 s57, s52, 2
    v_and_b32 v13, 15, v1
    v_mov_b32 v180, 2130706432
    s_lshl_b32 s55, s30, 4
    s_add_u32 s63, s55, s57
    v_lshrrev_b32 v10, 4, v1
    v_add_u32 v10, s63, v10
    v_and_b32 v11, 31, v10
    v_mul_u32_u24 v11, 81920, v11
    v_bfe_u32 v12, v10, 5, 2
    s_lshl_b32 s55, s29, 2
    v_add_u32 v12, s55, v12
    v_mul_u32_u24 v12, 1280, v12
    v_lshl_add_u32 v12, v13, 4, v12
    v_add_u32 v204, v11, v12
    s_cmp_ge_u32 s30, 8
    s_cselect_b32 s31, 2130706432, 0
    s_mul_i32 s42, s29, 40
    s_mul_i32 s55, s52, 10
    s_add_u32 s42, s42, s55
    s_mul_i32 s42, s42, 3456
    s_mul_i32 s55, s30, 320
    s_add_u32 s42, s42, s55
    v_lshrrev_b32 v21, 5, v1
    v_and_b32 v23, 31, v1
    v_mul_u32_u24 v12, 3456, v21
    v_lshl_add_u32 v205, v23, 4, v12
    buffer_load_dwordx4 v[228:231], v204, s[12:15], s31 offen offset:0
    buffer_load_dwordx4 v[232:235], v204, s[12:15], s31 offen offset:256
    buffer_load_dwordx4 v[236:239], v204, s[12:15], s31 offen offset:512
    buffer_load_dwordx4 v[240:243], v204, s[12:15], s31 offen offset:768
    buffer_load_dwordx4 v[244:247], v204, s[12:15], s31 offen offset:1024
    s_add_u32 s59, s58, 128
    s_add_u32 s60, s58, 256
    s_sub_u32 s54, s58, 64
    s_bitcmp1_b32 s30, 0
    s_cselect_b32 s60, s54, s60
    s_cmp_eq_u32 s30, 10
    s_cselect_b32 s71, 4, 5
    s_lshl_b32 s56, s29, 2
    s_add_u32 s56, s56, s52
    s_mul_i32 s56, s56, 110592
    s_add_u32 s54, s58, 0
    s_lshl_b32 s61, s54, 5
    s_add_u32 s61, s61, s56
    s_add_u32 s54, s59, 64
    s_lshl_b32 s64, s54, 5
    s_add_u32 s64, s64, s56
    s_add_u32 s54, s60, 0
    s_lshl_b32 s65, s54, 5
    s_add_u32 s65, s65, s56
    v_and_b32 v23, 31, v1
    v_lshrrev_b32 v21, 5, v1
    v_lshlrev_b32 v19, 4, v23
    v_lshlrev_b32 v18, 4, v1
    v_add_u32 v14, s72, v18
    s_cmp_eq_u32 s52, 0
    s_cselect_b32 s54, s58, s59
    s_cmp_ge_u32 s52, 2
    s_cselect_b32 s54, s60, s54
    v_lshl_add_u32 v203, v1, 1, s54
    v_bfe_u32 v25, v1, 1, 3
    v_xor_b32 v25, v25, v21
    s_lshl_b32 s54, s52, 5
    v_add_u32 v26, s54, v23
    v_lshlrev_b32 v26, 7, v26
    v_lshl_add_u32 v26, v25, 4, v26
    v_add_u32 v2, 81920, v26
    v_xor_b32 v3, 32, v2
    v_xor_b32 v4, 64, v2
    v_xor_b32 v5, 96, v2
    v_bfe_u32 v25, v1, 2, 2
    v_lshl_add_u32 v27, v21, 3, v25
    v_bfe_u32 v28, v1, 4, 1
    v_lshlrev_b32 v28, 5, v28
    v_and_b32 v29, 3, v1
    v_lshl_add_u32 v28, v29, 3, v28
    v_lshl_add_u32 v24, v27, 6, v28
    v_add_u32 v24, 40960, v24
    v_lshl_add_u32 v27, v27, 7, v28
    v_lshrrev_b32 v25, 1, v25
    v_lshl_add_u32 v6, v25, 6, v27
    v_xor_b32 v7, 64, v6
    v_lshlrev_b32 v9, 1, v23
    v_mov_b32 v8, 0x05040100
    v_mov_b32 v200, 0x3f80
    v_mov_b32 v201, 0x3f800000
    v_mov_b32 v202, 0x3f803f80
    s_lshl_b32 s55, s30, 4
    s_add_u32 s56, s55, s29
    s_mul_i32 s56, s56, 896
    s_add_u32 s56, s56, 28966912
    s_cmp_eq_u32 s52, 0
    s_cselect_b32 s62, s56, 2130706432
    s_lshl_b32 s54, s52, 2
    s_mul_i32 s63, s63, 896
    s_add_u32 s63, s63, 28966912
    s_and_b32 s55, s55, 16
    s_mul_i32 s55, s55, 128
    v_mul_u32_u24 v12, 48, v1
    v_add_u32 v12, s55, v12
    v_add_u32 v25, 0, v12
    v_subrev_u32 v28, 2560, v25
    v_min_u32 v25, v25, v28
    v_add_u32 v25, s54, v25
    v_add_u32 v26, 16, v12
    v_subrev_u32 v28, 2560, v26
    v_min_u32 v26, v26, v28
    v_add_u32 v26, s54, v26
    v_add_u32 v27, 32, v12
    v_subrev_u32 v28, 2560, v27
    v_min_u32 v27, v27, v28
    v_add_u32 v27, s54, v27
    s_lshl_b32 s54, s29, 11
    s_add_u32 s54, s54, 28835840
    s_add_u32 s54, s54, s31
    v_lshl_add_u32 v10, v10, 4, s54
    v_cmp_eq_u32 vcc, 0, v13
    s_nop 1
    v_cndmask_b32 v16, v180, v10, vcc
    v_mul_u32_u24 v21, 12, v1
    v_add_u32 v21, 73728, v21
    s_mul_i32 s54, s52, 640
    v_lshl_add_u32 v22, v1, 5, s54
    v_add_u32 v22, 73728, v22
    s_lshl_b32 s54, s52, 7
    v_lshl_add_u32 v23, v1, 1, s54
    v_mov_b32 v10, 0
    v_mov_b32 v11, 0
    v_mov_b32 v248, 0
    v_mov_b32 v249, 0
    v_mov_b32 v250, 0
    v_mov_b32 v251, 0
    v_mov_b32 v252, 0
    v_mov_b32 v253, 0
    v_mov_b32 v254, 0
    v_mov_b32 v255, 0
    s_lshl_b32 s58, s29, 2
    s_add_u32 s58, s58, s52
    s_lshl_b32 s58, s58, 4
    s_add_u32 s58, s58, s30
    s_lshl_b32 s58, s58, 7
    s_add_u32 s58, s58, 28573696
    s_getpc_b64 s[96:97]
Lot_4:
    s_lshr_b32 s54, s2, 5
    s_lshl_b32 s55, s29, 1
    s_add_u32 s54, s54, s55
    s_and_b32 s54, s54, 7
    s_lshl_b32 s54, s54, 1
    s_and_b32 s55, s2, 1
    s_add_u32 s54, s54, s55
    s_lshl_b32 s54, s54, 5
    s_add_u32 s54, s54, ORDER_TAB - Lot_4
    s_add_u32 s96, s96, s54
    s_addc_u32 s97, s97, 0
    s_load_dwordx4 s[44:47], s[96:97], 0
    s_load_dwordx2 s[48:49], s[96:97], 16
    s_lshl_b32 s54, s29, 11
    s_lshl_b32 s55, s52, 9
    s_add_u32 s54, s54, s55
    s_add_u32 s54, s54, 28835840
    v_and_b32 v15, 31, v1
    v_lshl_add_u32 v15, v15, 4, s54
    v_mov_b32 v17, 0
    global_load_dword v13, v17, s[100:101] sc1
    s_mov_b32 exec_lo, 0xfffff
    s_mov_b32 exec_hi, 0xfffff
    buffer_load_dwordx4 v[208:211], v205, s[16:19], s42 offen
    s_add_u32 s42, s42, 6912
    buffer_load_dwordx4 v[212:215], v205, s[16:19], s42 offen
    s_add_u32 s42, s42, 6912
    buffer_load_dwordx4 v[216:219], v205, s[16:19], s42 offen
    s_add_u32 s42, s42, 6912
    buffer_load_dwordx4 v[220:223], v205, s[16:19], s42 offen
    s_add_u32 s42, s42, 6912
    buffer_load_dwordx4 v[224:227], v205, s[16:19], s42 offen
    s_mov_b64 exec, -1
    buffer_load_ushort v20, v203, s[20:23], 0 offen
    s_waitcnt vmcnt(7)
    v_dot2c_f32_bf16 v10, v228, v202
    v_dot2c_f32_bf16 v11, v228, v228
    v_dot2c_f32_bf16 v10, v229, v202
    v_dot2c_f32_bf16 v11, v229, v229
    v_dot2c_f32_bf16 v10, v230, v202
    v_dot2c_f32_bf16 v11, v230, v230
    v_dot2c_f32_bf16 v10, v231, v202
    v_dot2c_f32_bf16 v11, v231, v231
    v_dot2c_f32_bf16 v10, v232, v202
    v_dot2c_f32_bf16 v11, v232, v232
    v_dot2c_f32_bf16 v10, v233, v202
    v_dot2c_f32_bf16 v11, v233, v233
    v_dot2c_f32_bf16 v10, v234, v202
    v_dot2c_f32_bf16 v11, v234, v234
    v_dot2c_f32_bf16 v10, v235, v202
    v_dot2c_f32_bf16 v11, v235, v235
    v_dot2c_f32_bf16 v10, v236, v202
    v_dot2c_f32_bf16 v11, v236, v236
    v_dot2c_f32_bf16 v10, v237, v202
    v_dot2c_f32_bf16 v11, v237, v237
    v_dot2c_f32_bf16 v10, v238, v202
    v_dot2c_f32_bf16 v11, v238, v238
    v_dot2c_f32_bf16 v10, v239, v202
    v_dot2c_f32_bf16 v11, v239, v239
    v_dot2c_f32_bf16 v10, v240, v202
    v_dot2c_f32_bf16 v11, v240, v240
    v_dot2c_f32_bf16 v10, v241, v202
    v_dot2c_f32_bf16 v11, v241, v241
    v_dot2c_f32_bf16 v10, v242, v202
    v_dot2c_f32_bf16 v11, v242, v242
    v_dot2c_f32_bf16 v10, v243, v202
    v_dot2c_f32_bf16 v11, v243, v243
    v_dot2c_f32_bf16 v10, v244, v202
    v_dot2c_f32_bf16 v11, v244, v244
    v_dot2c_f32_bf16 v10, v245, v202
    v_dot2c_f32_bf16 v11, v245, v245
    v_dot2c_f32_bf16 v10, v246, v202
    v_dot2c_f32_bf16 v11, v246, v246
    v_dot2c_f32_bf16 v10, v247, v202
    v_dot2c_f32_bf16 v11, v247, v247
    s_nop 1
    v_add_f32_dpp v10, v10, v10 row_ror:8 row_mask:0xf bank_mask:0xf
    v_add_f32_dpp v11, v11, v11 row_ror:8 row_mask:0xf bank_mask:0xf
    s_nop 0
    v_add_f32_dpp v10, v10, v10 row_ror:4 row_mask:0xf bank_mask:0xf
    v_add_f32_dpp v11, v11, v11 row_ror:4 row_mask:0xf bank_mask:0xf
    s_nop 0
    v_add_f32_dpp v10, v10, v10 row_ror:2 row_mask:0xf bank_mask:0xf
    v_add_f32_dpp v11, v11, v11 row_ror:2 row_mask:0xf bank_mask:0xf
    s_nop 0
    v_add_f32_dpp v10, v10, v10 row_ror:1 row_mask:0xf bank_mask:0xf
    v_add_f32_dpp v11, v11, v11 row_ror:1 row_mask:0xf bank_mask:0xf
    v_mul_f32 v10, 0x3acccccd, v10
    v_mul_f32 v11, 0x3acccccd, v11
    v_fma_f32 v192, -v10, v10, v11
    v_max_f32 v192, 0, v192
    v_add_f32 v193, 0x3727c5ac, v192
    v_rsq_f32 v12, v193
    s_nop 0
    v_mul_f32 v193, v12, v12
    v_mul_f32 v193, v193, v192
    v_add_f32 v193, 0x3727c5ac, v193
    v_rsq_f32 v193, v193
    s_nop 0
    v_mul_f32 v11, v12, v193
    s_waitcnt vmcnt(6)
    s_mov_b32 s57, 0
Ltag_5:
    v_readfirstlane_b32 s3, v13
    s_add_u32 s57, s57, 1
    s_cmp_lg_u32 s3, 0
    s_cbranch_scc1 Ltag_5d
    s_cmp_ge_u32 s57, 40000
    s_cbranch_scc1 Ltag_5d
    s_sleep 2
    global_load_dword v13, v17, s[100:101] sc1
    s_waitcnt vmcnt(0)
    s_branch Ltag_5
Ltag_5d:
    s_and_b32 s3, s3, -8
    v_or_b32 v13, 7, v13
    buffer_store_dwordx4 v[10:13], v16, s[24:27], 0 offen sc1
    s_barrier
    ds_read_b128 v[96:99], v2 offset:0
    ds_read_b128 v[100:103], v3 offset:0
    ds_read_b128 v[104:107], v4 offset:0
    ds_read_b128 v[108:111], v5 offset:0
    ds_read_b64_tr_b16 v[32:33], v6 offset:0
    ds_read_b64_tr_b16 v[34:35], v6 offset:512
    ds_read_b64_tr_b16 v[36:37], v7 offset:0
    ds_read_b64_tr_b16 v[38:39], v7 offset:512
    ds_read_b64_tr_b16 v[40:41], v6 offset:2048
    ds_read_b64_tr_b16 v[42:43], v6 offset:2560
    ds_read_b64_tr_b16 v[44:45], v7 offset:2048
    ds_read_b64_tr_b16 v[46:47], v7 offset:2560
    ds_read_b64_tr_b16 v[48:49], v6 offset:4096
    ds_read_b64_tr_b16 v[50:51], v6 offset:4608
    ds_read_b64_tr_b16 v[52:53], v7 offset:4096
    ds_read_b64_tr_b16 v[54:55], v7 offset:4608
    s_waitcnt lgkmcnt(12)
    s_barrier
    ds_read_b128 v[112:115], v2 offset:16384
    ds_read_b128 v[116:119], v3 offset:16384
    ds_read_b128 v[120:123], v4 offset:16384
    ds_read_b128 v[124:127], v5 offset:16384
    s_waitcnt lgkmcnt(12)
    v_mfma_f32_32x32x16_bf16 v[64:79], v[32:35], v[96:99], 0
    v_mfma_f32_32x32x16_bf16 v[80:95], v[36:39], v[96:99], 0
    ds_read_b64_tr_b16 v[56:57], v6 offset:6144
    ds_read_b64_tr_b16 v[58:59], v6 offset:6656
    ds_read_b64_tr_b16 v[60:61], v7 offset:6144
    ds_read_b64_tr_b16 v[62:63], v7 offset:6656
    s_waitcnt lgkmcnt(12)
    v_mfma_f32_32x32x16_bf16 v[64:79], v[40:43], v[100:103], v[64:79]
    v_mfma_f32_32x32x16_bf16 v[80:95], v[44:47], v[100:103], v[80:95]
    ds_read_b64_tr_b16 v[32:33], v6 offset:8192
    ds_read_b64_tr_b16 v[34:35], v6 offset:8704
    ds_read_b64_tr_b16 v[36:37], v7 offset:8192
    ds_read_b64_tr_b16 v[38:39], v7 offset:8704
    s_waitcnt lgkmcnt(12)
    v_mfma_f32_32x32x16_bf16 v[64:79], v[48:51], v[104:107], v[64:79]
    v_mfma_f32_32x32x16_bf16 v[80:95], v[52:55], v[104:107], v[80:95]
    ds_read_b64_tr_b16 v[40:41], v6 offset:10240
    ds_read_b64_tr_b16 v[42:43], v6 offset:10752
    ds_read_b64_tr_b16 v[44:45], v7 offset:10240
    ds_read_b64_tr_b16 v[46:47], v7 offset:10752
    s_waitcnt lgkmcnt(8)
    v_mfma_f32_32x32x16_bf16 v[64:79], v[56:59], v[108:111], v[64:79]
    v_mfma_f32_32x32x16_bf16 v[80:95], v[60:63], v[108:111], v[80:95]
    ds_read_b64_tr_b16 v[48:49], v6 offset:12288
    ds_read_b64_tr_b16 v[50:51], v6 offset:12800
    ds_read_b64_tr_b16 v[52:53], v7 offset:12288
    ds_read_b64_tr_b16 v[54:55], v7 offset:12800
    s_waitcnt vmcnt(2)
    v_dot2c_f32_bf16 v248, v208, v200
    v_dot2c_f32_bf16 v249, v208, v201
    v_dot2c_f32_bf16 v250, v209, v200
    v_dot2c_f32_bf16 v251, v209, v201
    v_dot2c_f32_bf16 v252, v210, v200
    v_dot2c_f32_bf16 v253, v210, v201
    v_dot2c_f32_bf16 v254, v211, v200
    v_dot2c_f32_bf16 v255, v211, v201
    v_dot2c_f32_bf16 v248, v212, v200
    v_dot2c_f32_bf16 v249, v212, v201
    v_dot2c_f32_bf16 v250, v213, v200
    v_dot2c_f32_bf16 v251, v213, v201
    v_dot2c_f32_bf16 v252, v214, v200
    v_dot2c_f32_bf16 v253, v214, v201
    v_dot2c_f32_bf16 v254, v215, v200
    v_dot2c_f32_bf16 v255, v215, v201
    v_dot2c_f32_bf16 v248, v216, v200
    v_dot2c_f32_bf16 v249, v216, v201
    v_dot2c_f32_bf16 v250, v217, v200
    v_dot2c_f32_bf16 v251, v217, v201
    v_dot2c_f32_bf16 v252, v218, v200
    v_dot2c_f32_bf16 v253, v218, v201
    v_dot2c_f32_bf16 v254, v219, v200
    v_dot2c_f32_bf16 v255, v219, v201
    v_dot2c_f32_bf16 v248, v220, v200
    v_dot2c_f32_bf16 v249, v220, v201
    v_dot2c_f32_bf16 v250, v221, v200
    v_dot2c_f32_bf16 v251, v221, v201
    v_dot2c_f32_bf16 v252, v222, v200
    v_dot2c_f32_bf16 v253, v222, v201
    v_dot2c_f32_bf16 v254, v223, v200
    v_dot2c_f32_bf16 v255, v223, v201
    v_dot2c_f32_bf16 v248, v224, v200
    v_dot2c_f32_bf16 v249, v224, v201
    v_dot2c_f32_bf16 v250, v225, v200
    v_dot2c_f32_bf16 v251, v225, v201
    v_dot2c_f32_bf16 v252, v226, v200
    v_dot2c_f32_bf16 v253, v226, v201
    v_dot2c_f32_bf16 v254, v227, v200
    v_dot2c_f32_bf16 v255, v227, v201
    v_mov_b32 v192, v248
    v_mov_b32 v193, v249
    v_mov_b32 v194, v250
    v_mov_b32 v195, v251
    v_mov_b32 v196, v252
    v_mov_b32 v197, v253
    v_mov_b32 v198, v254
    v_mov_b32 v199, v255
    v_permlane32_swap_b32 v192, v248
    v_permlane32_swap_b32 v193, v249
    v_permlane32_swap_b32 v194, v250
    v_permlane32_swap_b32 v195, v251
    v_permlane32_swap_b32 v196, v252
    v_permlane32_swap_b32 v197, v253
    v_permlane32_swap_b32 v198, v254
    v_permlane32_swap_b32 v199, v255
    v_add_f32 v248, v248, v192
    v_add_f32 v249, v249, v193
    v_add_f32 v250, v250, v194
    v_add_f32 v251, v251, v195
    v_add_f32 v252, v252, v196
    v_add_f32 v253, v253, v197
    v_add_f32 v254, v254, v198
    v_add_f32 v255, v255, v199
    s_mov_b64 exec, 0xfffff
    ds_write_b128 v22, v[248:251]
    ds_write_b128 v22, v[252:255] offset:16
    s_mov_b64 exec, -1
    s_waitcnt lgkmcnt(0)
    s_barrier
    ds_read_b128 v[128:131], v2 offset:32768
    ds_read_b128 v[132:135], v3 offset:32768
    ds_read_b128 v[136:139], v4 offset:32768
    ds_read_b128 v[140:143], v5 offset:32768
    ds_read_b32 v240, v21 offset:0
    ds_read_b32 v241, v21 offset:4
    ds_read_b32 v242, v21 offset:8
    ds_read_b32 v244, v21 offset:640
    ds_read_b32 v245, v21 offset:644
    ds_read_b32 v246, v21 offset:648
    ds_read_b32 v248, v21 offset:1280
    ds_read_b32 v249, v21 offset:1284
    ds_read_b32 v250, v21 offset:1288
    ds_read_b32 v252, v21 offset:1920
    ds_read_b32 v253, v21 offset:1924
    ds_read_b32 v254, v21 offset:1928
    v_mfma_f32_32x32x16_bf16 v[64:79], v[32:35], v[112:115], v[64:79]
    v_mfma_f32_32x32x16_bf16 v[80:95], v[36:39], v[112:115], v[80:95]
    ds_read_b64_tr_b16 v[56:57], v6 offset:14336
    ds_read_b64_tr_b16 v[58:59], v6 offset:14848
    ds_read_b64_tr_b16 v[60:61], v7 offset:14336
    ds_read_b64_tr_b16 v[62:63], v7 offset:14848
    v_mfma_f32_32x32x16_bf16 v[64:79], v[40:43], v[116:119], v[64:79]
    v_mfma_f32_32x32x16_bf16 v[80:95], v[44:47], v[116:119], v[80:95]
    ds_read_b64_tr_b16 v[32:33], v6 offset:16384
    ds_read_b64_tr_b16 v[34:35], v6 offset:16896
    ds_read_b64_tr_b16 v[36:37], v7 offset:16384
    ds_read_b64_tr_b16 v[38:39], v7 offset:16896
    s_waitcnt lgkmcnt(8)
    v_add_f32 v240, v240, v244
    v_add_f32 v248, v248, v252
    v_add_f32 v241, v241, v245
    v_add_f32 v249, v249, v253
    v_add_f32 v242, v242, v246
    v_add_f32 v250, v250, v254
    v_add_f32 v240, v240, v248
    v_add_f32 v241, v241, v249
    v_add_f32 v242, v242, v250
    v_mov_b32 v243, v13
    s_mov_b32 exec_hi, 0x3fffff
    buffer_store_dwordx4 v[240:243], v18, s[24:27], s62 offen sc1
    s_mov_b64 exec, -1
    v_mfma_f32_32x32x16_bf16 v[64:79], v[48:51], v[120:123], v[64:79]
    v_mfma_f32_32x32x16_bf16 v[80:95], v[52:55], v[120:123], v[80:95]
    ds_read_b64_tr_b16 v[40:41], v6 offset:18432
    ds_read_b64_tr_b16 v[42:43], v6 offset:18944
    ds_read_b64_tr_b16 v[44:45], v7 offset:18432
    ds_read_b64_tr_b16 v[46:47], v7 offset:18944
    s_waitcnt lgkmcnt(8)
    v_mfma_f32_32x32x16_bf16 v[64:79], v[56:59], v[124:127], v[64:79]
    v_mfma_f32_32x32x16_bf16 v[80:95], v[60:63], v[124:127], v[80:95]
    ds_read_b64_tr_b16 v[48:49], v6 offset:20480
    ds_read_b64_tr_b16 v[50:51], v6 offset:20992
    ds_read_b64_tr_b16 v[52:53], v7 offset:20480
    ds_read_b64_tr_b16 v[54:55], v7 offset:20992
    s_barrier
    ds_read_b128 v[144:147], v2 offset:49152
    ds_read_b128 v[148:151], v3 offset:49152
    ds_read_b128 v[152:155], v4 offset:49152
    ds_read_b128 v[156:159], v5 offset:49152
    s_waitcnt lgkmcnt(12)
    v_mfma_f32_32x32x16_bf16 v[64:79], v[32:35], v[128:131], v[64:79]
    v_mfma_f32_32x32x16_bf16 v[80:95], v[36:39], v[128:131], v[80:95]
    ds_read_b64_tr_b16 v[56:57], v6 offset:22528
    ds_read_b64_tr_b16 v[58:59], v6 offset:23040
    ds_read_b64_tr_b16 v[60:61], v7 offset:22528
    ds_read_b64_tr_b16 v[62:63], v7 offset:23040
    s_waitcnt lgkmcnt(12)
    v_mfma_f32_32x32x16_bf16 v[64:79], v[40:43], v[132:135], v[64:79]
    v_mfma_f32_32x32x16_bf16 v[80:95], v[44:47], v[132:135], v[80:95]
    ds_read_b64_tr_b16 v[32:33], v6 offset:24576
    ds_read_b64_tr_b16 v[34:35], v6 offset:25088
    ds_read_b64_tr_b16 v[36:37], v7 offset:24576
    ds_read_b64_tr_b16 v[38:39], v7 offset:25088
    s_waitcnt lgkmcnt(12)
    v_mfma_f32_32x32x16_bf16 v[64:79], v[48:51], v[136:139], v[64:79]
    v_mfma_f32_32x32x16_bf16 v[80:95], v[52:55], v[136:139], v[80:95]
    ds_read_b64_tr_b16 v[40:41], v6 offset:26624
    ds_read_b64_tr_b16 v[42:43], v6 offset:27136
    ds_read_b64_tr_b16 v[44:45], v7 offset:26624
    ds_read_b64_tr_b16 v[46:47], v7 offset:27136
    s_waitcnt lgkmcnt(8)
    v_mfma_f32_32x32x16_bf16 v[64:79], v[56:59], v[140:143], v[64:79]
    v_mfma_f32_32x32x16_bf16 v[80:95], v[60:63], v[140:143], v[80:95]
    ds_read_b64_tr_b16 v[48:49], v6 offset:28672
    ds_read_b64_tr_b16 v[50:51], v6 offset:29184
    ds_read_b64_tr_b16 v[52:53], v7 offset:28672
    ds_read_b64_tr_b16 v[54:55], v7 offset:29184
    s_barrier
    v_add_u32 v2, 16384, v2
    v_add_u32 v3, 16384, v3
    v_add_u32 v4, 16384, v4
    v_add_u32 v5, 16384, v5
    ds_read_b128 v[160:163], v2 offset:49152
    ds_read_b128 v[164:167], v3 offset:49152
    ds_read_b128 v[168:171], v4 offset:49152
    ds_read_b128 v[172:175], v5 offset:49152
    v_subrev_u32 v2, 16384, v2
    v_subrev_u32 v3, 16384, v3
    v_subrev_u32 v4, 16384, v4
    v_subrev_u32 v5, 16384, v5
    s_waitcnt lgkmcnt(12)
    v_mfma_f32_32x32x16_bf16 v[64:79], v[32:35], v[144:147], v[64:79]
    v_mfma_f32_32x32x16_bf16 v[80:95], v[36:39], v[144:147], v[80:95]
    ds_read_b64_tr_b16 v[56:57], v6 offset:30720
    ds_read_b64_tr_b16 v[58:59], v6 offset:31232
    ds_read_b64_tr_b16 v[60:61], v7 offset:30720
    ds_read_b64_tr_b16 v[62:63], v7 offset:31232
    s_waitcnt lgkmcnt(12)
    v_mfma_f32_32x32x16_bf16 v[64:79], v[40:43], v[148:151], v[64:79]
    v_mfma_f32_32x32x16_bf16 v[80:95], v[44:47], v[148:151], v[80:95]
    ds_read_b64_tr_b16 v[32:33], v6 offset:32768
    ds_read_b64_tr_b16 v[34:35], v6 offset:33280
    ds_read_b64_tr_b16 v[36:37], v7 offset:32768
    ds_read_b64_tr_b16 v[38:39], v7 offset:33280
    s_waitcnt lgkmcnt(12)
    v_mfma_f32_32x32x16_bf16 v[64:79], v[48:51], v[152:155], v[64:79]
    v_mfma_f32_32x32x16_bf16 v[80:95], v[52:55], v[152:155], v[80:95]
    ds_read_b64_tr_b16 v[40:41], v6 offset:34816
    ds_read_b64_tr_b16 v[42:43], v6 offset:35328
    ds_read_b64_tr_b16 v[44:45], v7 offset:34816
    ds_read_b64_tr_b16 v[46:47], v7 offset:35328
    s_waitcnt lgkmcnt(8)
    v_mfma_f32_32x32x16_bf16 v[64:79], v[56:59], v[156:159], v[64:79]
    v_mfma_f32_32x32x16_bf16 v[80:95], v[60:63], v[156:159], v[80:95]
    ds_read_b64_tr_b16 v[48:49], v6 offset:36864
    ds_read_b64_tr_b16 v[50:51], v6 offset:37376
    ds_read_b64_tr_b16 v[52:53], v7 offset:36864
    ds_read_b64_tr_b16 v[54:55], v7 offset:37376
    s_barrier
    ds_read_b128 v[176:179], v2 offset:0
    ds_read_b128 v[180:183], v3 offset:0
    ds_read_b128 v[184:187], v4 offset:0
    ds_read_b128 v[188:191], v5 offset:0
    s_waitcnt lgkmcnt(12)
    v_mfma_f32_32x32x16_bf16 v[64:79], v[32:35], v[160:163], v[64:79]
    v_mfma_f32_32x32x16_bf16 v[80:95], v[36:39], v[160:163], v[80:95]
    ds_read_b64_tr_b16 v[56:57], v6 offset:38912
    ds_read_b64_tr_b16 v[58:59], v6 offset:39424
    ds_read_b64_tr_b16 v[60:61], v7 offset:38912
    ds_read_b64_tr_b16 v[62:63], v7 offset:39424
    s_waitcnt lgkmcnt(12)
    v_mfma_f32_32x32x16_bf16 v[64:79], v[40:43], v[164:167], v[64:79]
    v_mfma_f32_32x32x16_bf16 v[80:95], v[44:47], v[164:167], v[80:95]
    ds_read_b64_tr_b16 v[32:33], v6 offset:40960
    ds_read_b64_tr_b16 v[34:35], v6 offset:41472
    ds_read_b64_tr_b16 v[36:37], v7 offset:40960
    ds_read_b64_tr_b16 v[38:39], v7 offset:41472
    s_waitcnt lgkmcnt(12)
    v_mfma_f32_32x32x16_bf16 v[64:79], v[48:51], v[168:171], v[64:79]
    v_mfma_f32_32x32x16_bf16 v[80:95], v[52:55], v[168:171], v[80:95]
    ds_read_b64_tr_b16 v[40:41], v6 offset:43008
    ds_read_b64_tr_b16 v[42:43], v6 offset:43520
    ds_read_b64_tr_b16 v[44:45], v7 offset:43008
    ds_read_b64_tr_b16 v[46:47], v7 offset:43520
    s_waitcnt lgkmcnt(8)
    v_mfma_f32_32x32x16_bf16 v[64:79], v[56:59], v[172:175], v[64:79]
    v_mfma_f32_32x32x16_bf16 v[80:95], v[60:63], v[172:175], v[80:95]
    ds_read_b64_tr_b16 v[48:49], v6 offset:45056
    ds_read_b64_tr_b16 v[50:51], v6 offset:45568
    ds_read_b64_tr_b16 v[52:53], v7 offset:45056
    ds_read_b64_tr_b16 v[54:55], v7 offset:45568
    s_barrier
    ds_read_b128 v[192:195], v2 offset:16384
    ds_read_b128 v[196:199], v3 offset:16384
    ds_read_b128 v[200:203], v4 offset:16384
    ds_read_b128 v[204:207], v5 offset:16384
    s_waitcnt lgkmcnt(12)
    v_mfma_f32_32x32x16_bf16 v[64:79], v[32:35], v[176:179], v[64:79]
    v_mfma_f32_32x32x16_bf16 v[80:95], v[36:39], v[176:179], v[80:95]
    ds_read_b64_tr_b16 v[56:57], v6 offset:47104
    ds_read_b64_tr_b16 v[58:59], v6 offset:47616
    ds_read_b64_tr_b16 v[60:61], v7 offset:47104
    ds_read_b64_tr_b16 v[62:63], v7 offset:47616
    s_mov_b32 exec_hi, 0x3fffff
    buffer_load_dwordx4 v[240:243], v18, s[24:27], s63 offen offset:0 sc1
    buffer_load_dwordx4 v[244:247], v18, s[24:27], s63 offen offset:896 sc1
    buffer_load_dwordx4 v[248:251], v18, s[24:27], s63 offen offset:1792 sc1
    buffer_load_dwordx4 v[252:255], v18, s[24:27], s63 offen offset:2688 sc1
    s_mov_b64 exec, -1
    buffer_load_dwordx4 v[10:13], v15, s[24:27], 0 offen sc1
    s_waitcnt lgkmcnt(12)
    v_mfma_f32_32x32x16_bf16 v[64:79], v[40:43], v[180:183], v[64:79]
    v_mfma_f32_32x32x16_bf16 v[80:95], v[44:47], v[180:183], v[80:95]
    ds_read_b64_tr_b16 v[32:33], v6 offset:49152
    ds_read_b64_tr_b16 v[34:35], v6 offset:49664
    ds_read_b64_tr_b16 v[36:37], v7 offset:49152
    ds_read_b64_tr_b16 v[38:39], v7 offset:49664
    s_waitcnt lgkmcnt(12)
    v_mfma_f32_32x32x16_bf16 v[64:79], v[48:51], v[184:187], v[64:79]
    v_mfma_f32_32x32x16_bf16 v[80:95], v[52:55], v[184:187], v[80:95]
    ds_read_b64_tr_b16 v[40:41], v6 offset:51200
    ds_read_b64_tr_b16 v[42:43], v6 offset:51712
    ds_read_b64_tr_b16 v[44:45], v7 offset:51200
    ds_read_b64_tr_b16 v[46:47], v7 offset:51712
    s_waitcnt lgkmcnt(8)
    v_mfma_f32_32x32x16_bf16 v[64:79], v[56:59], v[188:191], v[64:79]
    v_mfma_f32_32x32x16_bf16 v[80:95], v[60:63], v[188:191], v[80:95]
    ds_read_b64_tr_b16 v[48:49], v6 offset:53248
    ds_read_b64_tr_b16 v[50:51], v6 offset:53760
    ds_read_b64_tr_b16 v[52:53], v7 offset:53248
    ds_read_b64_tr_b16 v[54:55], v7 offset:53760
    s_barrier
    ds_read_b128 v[208:211], v2 offset:32768
    ds_read_b128 v[212:215], v3 offset:32768
    ds_read_b128 v[216:219], v4 offset:32768
    ds_read_b128 v[220:223], v5 offset:32768
    s_waitcnt lgkmcnt(12)
    v_mfma_f32_32x32x16_bf16 v[64:79], v[32:35], v[192:195], v[64:79]
    v_mfma_f32_32x32x16_bf16 v[80:95], v[36:39], v[192:195], v[80:95]
    ds_read_b64_tr_b16 v[56:57], v6 offset:55296
    ds_read_b64_tr_b16 v[58:59], v6 offset:55808
    ds_read_b64_tr_b16 v[60:61], v7 offset:55296
    ds_read_b64_tr_b16 v[62:63], v7 offset:55808
    ds_write_b16 v23, v20 offset:2560
    s_waitcnt lgkmcnt(13)
    v_mfma_f32_32x32x16_bf16 v[64:79], v[40:43], v[196:199], v[64:79]
    v_mfma_f32_32x32x16_bf16 v[80:95], v[44:47], v[196:199], v[80:95]
    ds_read_b64_tr_b16 v[32:33], v6 offset:57344
    ds_read_b64_tr_b16 v[34:35], v6 offset:57856
    ds_read_b64_tr_b16 v[36:37], v7 offset:57344
    ds_read_b64_tr_b16 v[38:39], v7 offset:57856
    s_waitcnt lgkmcnt(13)
    v_mfma_f32_32x32x16_bf16 v[64:79], v[48:51], v[200:203], v[64:79]
    v_mfma_f32_32x32x16_bf16 v[80:95], v[52:55], v[200:203], v[80:95]
    ds_read_b64_tr_b16 v[40:41], v6 offset:59392
    ds_read_b64_tr_b16 v[42:43], v6 offset:59904
    ds_read_b64_tr_b16 v[44:45], v7 offset:59392
    ds_read_b64_tr_b16 v[46:47], v7 offset:59904
    s_waitcnt lgkmcnt(9)
    v_mfma_f32_32x32x16_bf16 v[64:79], v[56:59], v[204:207], v[64:79]
    v_mfma_f32_32x32x16_bf16 v[80:95], v[60:63], v[204:207], v[80:95]
    ds_read_b64_tr_b16 v[48:49], v6 offset:61440
    ds_read_b64_tr_b16 v[50:51], v6 offset:61952
    ds_read_b64_tr_b16 v[52:53], v7 offset:61440
    ds_read_b64_tr_b16 v[54:55], v7 offset:61952
    s_barrier
    ds_read_b128 v[224:227], v2 offset:49152
    ds_read_b128 v[228:231], v3 offset:49152
    ds_read_b128 v[232:235], v4 offset:49152
    ds_read_b128 v[236:239], v5 offset:49152
    s_waitcnt lgkmcnt(12)
    v_mfma_f32_32x32x16_bf16 v[64:79], v[32:35], v[208:211], v[64:79]
    v_mfma_f32_32x32x16_bf16 v[80:95], v[36:39], v[208:211], v[80:95]
    ds_read_b64_tr_b16 v[56:57], v6 offset:63488
    ds_read_b64_tr_b16 v[58:59], v6 offset:64000
    ds_read_b64_tr_b16 v[60:61], v7 offset:63488
    ds_read_b64_tr_b16 v[62:63], v7 offset:64000
    s_waitcnt lgkmcnt(12)
    v_mfma_f32_32x32x16_bf16 v[64:79], v[40:43], v[212:215], v[64:79]
    v_mfma_f32_32x32x16_bf16 v[80:95], v[44:47], v[212:215], v[80:95]
    v_add_u32 v6, 65536, v6
    v_add_u32 v7, 65536, v7
    ds_read_b64_tr_b16 v[32:33], v6 offset:0
    ds_read_b64_tr_b16 v[34:35], v6 offset:512
    ds_read_b64_tr_b16 v[36:37], v7 offset:0
    ds_read_b64_tr_b16 v[38:39], v7 offset:512
    s_waitcnt lgkmcnt(12)
    v_mfma_f32_32x32x16_bf16 v[64:79], v[48:51], v[216:219], v[64:79]
    v_mfma_f32_32x32x16_bf16 v[80:95], v[52:55], v[216:219], v[80:95]
    ds_read_b64_tr_b16 v[40:41], v6 offset:2048
    ds_read_b64_tr_b16 v[42:43], v6 offset:2560
    ds_read_b64_tr_b16 v[44:45], v7 offset:2048
    ds_read_b64_tr_b16 v[46:47], v7 offset:2560
    s_waitcnt lgkmcnt(8)
    v_mfma_f32_32x32x16_bf16 v[64:79], v[56:59], v[220:223], v[64:79]
    v_mfma_f32_32x32x16_bf16 v[80:95], v[60:63], v[220:223], v[80:95]
    ds_read_b64_tr_b16 v[48:49], v6 offset:4096
    ds_read_b64_tr_b16 v[50:51], v6 offset:4608
    ds_read_b64_tr_b16 v[52:53], v7 offset:4096
    ds_read_b64_tr_b16 v[54:55], v7 offset:4608
    s_waitcnt vmcnt(1)
    s_mov_b32 s56, 0
    s_or_b32 s57, s3, 7
    s_mov_b32 exec_hi, 0x3fffff
Lcs_6:
    v_xor_b32 v243, s57, v243
    v_xor_b32 v247, s57, v247
    v_xor_b32 v251, s57, v251
    v_xor_b32 v255, s57, v255
    v_or3_b32 v243, v243, v247, v251
    v_or_b32 v243, v243, v255
    v_cmp_ne_u32 vcc, 0, v243
    s_add_u32 s56, s56, 1
    s_cbranch_vccz Lcs_6d
    s_cmp_ge_u32 s56, 40000
    s_cbranch_scc1 Lcs_6d
    s_sleep 2
    buffer_load_dwordx4 v[240:243], v18, s[24:27], s63 offen offset:0 sc1
    buffer_load_dwordx4 v[244:247], v18, s[24:27], s63 offen offset:896 sc1
    buffer_load_dwordx4 v[248:251], v18, s[24:27], s63 offen offset:1792 sc1
    buffer_load_dwordx4 v[252:255], v18, s[24:27], s63 offen offset:2688 sc1
    s_waitcnt vmcnt(0)
    s_branch Lcs_6
Lcs_6d:
    v_add_f32 v240, v240, v244
    v_add_f32 v248, v248, v252
    v_add_f32 v241, v241, v245
    v_add_f32 v249, v249, v253
    v_add_f32 v242, v242, v246
    v_add_f32 v250, v250, v254
    v_add_f32 v240, v240, v248
    v_add_f32 v241, v241, v249
    v_add_f32 v242, v242, v250
    ds_write_b32 v25, v240 offset:0
    s_mov_b32 exec_hi, 0x1fffff
    ds_write_b32 v26, v241 offset:0
    ds_write_b32 v27, v242 offset:0
    s_mov_b64 exec, -1
    s_barrier
    v_add_u32 v2, 16384, v2
    v_add_u32 v3, 16384, v3
    v_add_u32 v4, 16384, v4
    v_add_u32 v5, 16384, v5
    ds_read_b128 v[240:243], v2 offset:49152
    ds_read_b128 v[244:247], v3 offset:49152
    ds_read_b128 v[248:251], v4 offset:49152
    ds_read_b128 v[252:255], v5 offset:49152
    s_waitcnt lgkmcnt(15)
    v_mfma_f32_32x32x16_bf16 v[64:79], v[32:35], v[224:227], v[64:79]
    v_mfma_f32_32x32x16_bf16 v[80:95], v[36:39], v[224:227], v[80:95]
    ds_read_b64_tr_b16 v[56:57], v6 offset:6144
    ds_read_b64_tr_b16 v[58:59], v6 offset:6656
    ds_read_b64_tr_b16 v[60:61], v7 offset:6144
    ds_read_b64_tr_b16 v[62:63], v7 offset:6656
    s_waitcnt lgkmcnt(15)
    v_mfma_f32_32x32x16_bf16 v[64:79], v[40:43], v[228:231], v[64:79]
    v_mfma_f32_32x32x16_bf16 v[80:95], v[44:47], v[228:231], v[80:95]
    ds_read_b64_tr_b16 v[32:33], v6 offset:8192
    ds_read_b64_tr_b16 v[34:35], v6 offset:8704
    ds_read_b64_tr_b16 v[36:37], v7 offset:8192
    ds_read_b64_tr_b16 v[38:39], v7 offset:8704
    s_waitcnt vmcnt(0)
    s_mov_b32 s56, 0
    s_or_b32 s57, s3, 7
Lrec_7:
    v_cmp_ne_u32 vcc, s57, v13
    s_add_u32 s56, s56, 1
    s_cbranch_vccz Lrec_7d
    s_cmp_ge_u32 s56, 40000
    s_cbranch_scc1 Lrec_7d
    s_sleep 2
    buffer_load_dwordx4 v[10:13], v15, s[24:27], 0 offen sc1
    s_waitcnt vmcnt(0)
    s_branch Lrec_7
Lrec_7d:
    v_rcp_f32 v15, v11
    v_mul_f32 v16, 0xc0135761, v11
    v_mul_f32 v17, v11, v11
    v_mul_f32 v17, v17, v11
    v_mul_f32 v17, 0xbdd2d3e8, v17
    v_sub_f32 v10, 0, v10
    v_cvt_pk_bf16_f32 v2, v10, v10
    v_cvt_pk_bf16_f32 v13, v15, v15
    v_and_b32 v12, 0xffff0000, v2
    v_and_b32 v13, 0xffff0000, v13
    v_sub_f32 v12, v10, v12
    v_sub_f32 v13, v15, v13
    v_cvt_pk_bf16_f32 v3, v12, v15
    v_cvt_pk_bf16_f32 v4, v13, 0
    v_cmp_gt_u32 vcc, 32, v1
    v_mov_b32 v5, 0
    s_nop 0
    v_cndmask_b32 v2, 0, v2, vcc
    v_cndmask_b32 v3, 0, v3, vcc
    v_cndmask_b32 v4, 0, v4, vcc
    s_lshl_b32 s54, s52, 9
    v_add_u32 v12, s54, v19
    v_mov_b32 v13, s3
    ds_write_b128 v12, v[14:17] offset:3072
    ds_write_b32 v12, v13 offset:3072
    s_waitcnt lgkmcnt(15)
    v_mfma_f32_32x32x16_bf16 v[64:79], v[48:51], v[232:235], v[64:79]
    v_mfma_f32_32x32x16_bf16 v[80:95], v[52:55], v[232:235], v[80:95]
    ds_read_b64_tr_b16 v[40:41], v6 offset:10240
    ds_read_b64_tr_b16 v[42:43], v6 offset:10752
    ds_read_b64_tr_b16 v[44:45], v7 offset:10240
    ds_read_b64_tr_b16 v[46:47], v7 offset:10752
    s_waitcnt lgkmcnt(10)
    v_mfma_f32_32x32x16_bf16 v[64:79], v[56:59], v[236:239], v[64:79]
    v_mfma_f32_32x32x16_bf16 v[80:95], v[60:63], v[236:239], v[80:95]
    ds_read_b64_tr_b16 v[48:49], v6 offset:12288
    ds_read_b64_tr_b16 v[50:51], v6 offset:12800
    ds_read_b64_tr_b16 v[52:53], v7 offset:12288
    ds_read_b64_tr_b16 v[54:55], v7 offset:12800
    s_barrier
    ds_read_b128 v[28:31], v19 offset:512
    ds_read_u16 v26, v9 offset:2624
    ds_read_b128 v[20:23], v19 offset:0
    ds_read_u16 v25, v9 offset:2560
    s_waitcnt lgkmcnt(14)
    v_mfma_f32_32x32x16_bf16 v[64:79], v[32:35], v[240:243], v[64:79]
    v_mfma_f32_32x32x16_bf16 v[80:95], v[36:39], v[240:243], v[80:95]
    ds_read_b64_tr_b16 v[56:57], v6 offset:14336
    ds_read_b64_tr_b16 v[58:59], v6 offset:14848
    ds_read_b64_tr_b16 v[60:61], v7 offset:14336
    ds_read_b64_tr_b16 v[62:63], v7 offset:14848
    s_waitcnt lgkmcnt(6)
    v_add_f32 v28, v28, v29
    v_add_f32 v30, v30, v31
    v_add_f32 v28, v28, v30
    v_cvt_pk_bf16_f32 v29, v28, v28
    v_and_b32 v30, 0xffff0000, v29
    v_sub_f32 v30, v28, v30
    v_cvt_pk_bf16_f32 v28, v28, v30
    v_perm_b32 v29, v26, v29, v8
    v_mov_b32 v30, v26
    v_mov_b32 v31, 0
    v_mfma_f32_32x32x16_bf16 v[64:79], v[40:43], v[244:247], v[64:79]
    v_mfma_f32_32x32x16_bf16 v[80:95], v[44:47], v[244:247], v[80:95]
    s_waitcnt lgkmcnt(4)
    v_add_f32 v20, v20, v21
    v_add_f32 v22, v22, v23
    v_add_f32 v20, v20, v22
    v_cvt_pk_bf16_f32 v21, v20, v20
    v_and_b32 v22, 0xffff0000, v21
    v_sub_f32 v22, v20, v22
    v_cvt_pk_bf16_f32 v20, v20, v22
    v_perm_b32 v21, v25, v21, v8
    v_mov_b32 v22, v25
    v_mov_b32 v23, 0
    v_add_u32 v6, 16384, v6
    v_add_u32 v7, 16384, v7
    v_mfma_f32_32x32x16_bf16 v[64:79], v[48:51], v[248:251], v[64:79]
    v_mfma_f32_32x32x16_bf16 v[80:95], v[52:55], v[248:251], v[80:95]
    v_mfma_f32_32x32x16_bf16 v[80:95], v[28:31], v[2:5], v[80:95]
    v_mfma_f32_32x32x16_bf16 v[64:79], v[20:23], v[2:5], v[64:79]
    ds_read_b128 v[28:31], v19 offset:1024
    ds_read_u16 v26, v9 offset:2688
    s_waitcnt lgkmcnt(2)
    v_mfma_f32_32x32x16_bf16 v[64:79], v[56:59], v[252:255], v[64:79]
    v_mfma_f32_32x32x16_bf16 v[80:95], v[60:63], v[252:255], v[80:95]
    s_waitcnt lgkmcnt(0)
    v_add_f32 v28, v28, v29
    v_add_f32 v30, v30, v31
    v_add_f32 v28, v28, v30
    v_cvt_pk_bf16_f32 v29, v28, v28
    v_and_b32 v30, 0xffff0000, v29
    v_sub_f32 v30, v28, v30
    v_cvt_pk_bf16_f32 v28, v28, v30
    v_perm_b32 v29, v26, v29, v8
    v_mov_b32 v30, v26
    v_mov_b32 v31, 0
    s_nop 0
    ds_write_b128 v14, v[80:83] offset:24576
    ds_write_b128 v14, v[84:87] offset:25600
    ds_write_b128 v14, v[88:91] offset:26624
    ds_write_b128 v14, v[92:95] offset:27648
    s_waitcnt lgkmcnt(0)
    s_barrier
    ds_read_b64_tr_b16 v[32:33], v6 offset:0
    ds_read_b64_tr_b16 v[34:35], v6 offset:512
    ds_read_b64_tr_b16 v[36:37], v6 offset:2048
    ds_read_b64_tr_b16 v[38:39], v6 offset:2560
    ds_read_b64_tr_b16 v[40:41], v6 offset:4096
    ds_read_b64_tr_b16 v[42:43], v6 offset:4608
    ds_read_b64_tr_b16 v[44:45], v6 offset:6144
    ds_read_b64_tr_b16 v[46:47], v6 offset:6656
    v_mfma_f32_32x32x16_bf16 v[80:95], v[28:31], v[2:5], 0
    s_waitcnt lgkmcnt(6)
    v_mfma_f32_32x32x16_bf16 v[80:95], v[32:35], v[96:99], v[80:95]
    ds_read_b64_tr_b16 v[20:21], v6 offset:8192
    ds_read_b64_tr_b16 v[22:23], v6 offset:8704
    v_mul_f32 v10, v64, v64
    v_mul_f32 v11, v65, v65
    s_waitcnt lgkmcnt(6)
    v_mfma_f32_32x32x16_bf16 v[80:95], v[36:39], v[100:103], v[80:95]
    ds_read_b64_tr_b16 v[32:33], v6 offset:10240
    ds_read_b64_tr_b16 v[34:35], v6 offset:10752
    v_mul_f32 v12, v66, v66
    v_mul_f32 v13, v67, v67
    v_fma_f32 v10, v10, v17, v16
    s_waitcnt lgkmcnt(6)
    v_mfma_f32_32x32x16_bf16 v[80:95], v[40:43], v[104:107], v[80:95]
    ds_read_b64_tr_b16 v[36:37], v6 offset:12288
    ds_read_b64_tr_b16 v[38:39], v6 offset:12800
    ds_read_b128 v[28:31], v19 offset:1536
    ds_read_u16 v26, v9 offset:2752
    v_fma_f32 v11, v11, v17, v16
    v_fma_f32 v12, v12, v17, v16
    v_fma_f32 v13, v13, v17, v16
    s_waitcnt lgkmcnt(8)
    v_mfma_f32_32x32x16_bf16 v[80:95], v[44:47], v[108:111], v[80:95]
    ds_read_b64_tr_b16 v[40:41], v6 offset:14336
    ds_read_b64_tr_b16 v[42:43], v6 offset:14848
    v_mul_f32 v10, v10, v64
    v_mul_f32 v11, v11, v65
    v_mul_f32 v12, v12, v66
    s_waitcnt lgkmcnt(8)
    v_mfma_f32_32x32x16_bf16 v[80:95], v[20:23], v[112:115], v[80:95]
    ds_read_b64_tr_b16 v[44:45], v6 offset:16384
    ds_read_b64_tr_b16 v[46:47], v6 offset:16896
    v_mul_f32 v13, v13, v67
    v_exp_f32 v10, v10
    s_waitcnt lgkmcnt(8)
    v_mfma_f32_32x32x16_bf16 v[80:95], v[32:35], v[116:119], v[80:95]
    ds_read_b64_tr_b16 v[20:21], v6 offset:18432
    ds_read_b64_tr_b16 v[22:23], v6 offset:18944
    v_exp_f32 v11, v11
    v_exp_f32 v12, v12
    v_exp_f32 v13, v13
    s_waitcnt lgkmcnt(8)
    v_mfma_f32_32x32x16_bf16 v[80:95], v[36:39], v[120:123], v[80:95]
    ds_read_b64_tr_b16 v[32:33], v6 offset:20480
    ds_read_b64_tr_b16 v[34:35], v6 offset:20992
    v_fma_f32 v10, v10, v15, v15
    v_fma_f32 v11, v11, v15, v15
    v_fma_f32 v12, v12, v15, v15
    s_waitcnt lgkmcnt(6)
    v_mfma_f32_32x32x16_bf16 v[80:95], v[40:43], v[124:127], v[80:95]
    ds_read_b64_tr_b16 v[36:37], v6 offset:22528
    ds_read_b64_tr_b16 v[38:39], v6 offset:23040
    v_fma_f32 v13, v13, v15, v15
    v_rcp_f32 v10, v10
    v_rcp_f32 v11, v11
    s_waitcnt lgkmcnt(6)
    v_mfma_f32_32x32x16_bf16 v[80:95], v[44:47], v[128:131], v[80:95]
    ds_read_b64_tr_b16 v[40:41], v6 offset:24576
    ds_read_b64_tr_b16 v[42:43], v6 offset:25088
    v_rcp_f32 v12, v12
    v_rcp_f32 v13, v13
    s_waitcnt lgkmcnt(6)
    v_mfma_f32_32x32x16_bf16 v[80:95], v[20:23], v[132:135], v[80:95]
    ds_read_b64_tr_b16 v[44:45], v6 offset:26624
    ds_read_b64_tr_b16 v[46:47], v6 offset:27136
    v_mul_f32 v64, v64, v10
    v_mul_f32 v65, v65, v11
    v_mul_f32 v66, v66, v12
    s_waitcnt lgkmcnt(6)
    v_mfma_f32_32x32x16_bf16 v[80:95], v[32:35], v[136:139], v[80:95]
    ds_read_b64_tr_b16 v[20:21], v6 offset:28672
    ds_read_b64_tr_b16 v[22:23], v6 offset:29184
    v_mul_f32 v67, v67, v13
    v_cvt_pk_bf16_f32 v64, v64, v65
    v_cvt_pk_bf16_f32 v65, v66, v67
    s_waitcnt lgkmcnt(6)
    v_mfma_f32_32x32x16_bf16 v[80:95], v[36:39], v[140:143], v[80:95]
    ds_read_b64_tr_b16 v[32:33], v6 offset:30720
    ds_read_b64_tr_b16 v[34:35], v6 offset:31232
    v_mul_f32 v10, v68, v68
    v_mul_f32 v11, v69, v69
    v_mul_f32 v12, v70, v70
    s_waitcnt lgkmcnt(6)
    v_mfma_f32_32x32x16_bf16 v[80:95], v[40:43], v[144:147], v[80:95]
    ds_read_b64_tr_b16 v[36:37], v6 offset:32768
    ds_read_b64_tr_b16 v[38:39], v6 offset:33280
    v_mul_f32 v13, v71, v71
    v_fma_f32 v10, v10, v17, v16
    v_fma_f32 v11, v11, v17, v16
    s_waitcnt lgkmcnt(6)
    v_mfma_f32_32x32x16_bf16 v[80:95], v[44:47], v[148:151], v[80:95]
    ds_read_b64_tr_b16 v[40:41], v6 offset:34816
    ds_read_b64_tr_b16 v[42:43], v6 offset:35328
    v_fma_f32 v12, v12, v17, v16
    v_fma_f32 v13, v13, v17, v16
    s_waitcnt lgkmcnt(6)
    v_mfma_f32_32x32x16_bf16 v[80:95], v[20:23], v[152:155], v[80:95]
    ds_read_b64_tr_b16 v[44:45], v6 offset:36864
    ds_read_b64_tr_b16 v[46:47], v6 offset:37376
    v_mul_f32 v10, v10, v68
    v_mul_f32 v11, v11, v69
    v_mul_f32 v12, v12, v70
    s_waitcnt lgkmcnt(6)
    v_mfma_f32_32x32x16_bf16 v[80:95], v[32:35], v[156:159], v[80:95]
    ds_read_b64_tr_b16 v[20:21], v6 offset:38912
    ds_read_b64_tr_b16 v[22:23], v6 offset:39424
    v_mul_f32 v13, v13, v71
    v_exp_f32 v10, v10
    v_exp_f32 v11, v11
    s_waitcnt lgkmcnt(6)
    v_mfma_f32_32x32x16_bf16 v[80:95], v[36:39], v[160:163], v[80:95]
    ds_read_b64_tr_b16 v[32:33], v6 offset:40960
    ds_read_b64_tr_b16 v[34:35], v6 offset:41472
    v_exp_f32 v12, v12
    v_exp_f32 v13, v13
    v_fma_f32 v10, v10, v15, v15
    s_waitcnt lgkmcnt(6)
    v_mfma_f32_32x32x16_bf16 v[80:95], v[40:43], v[164:167], v[80:95]
    ds_read_b64_tr_b16 v[36:37], v6 offset:43008
    ds_read_b64_tr_b16 v[38:39], v6 offset:43520
    v_fma_f32 v11, v11, v15, v15
    v_fma_f32 v12, v12, v15, v15
    s_waitcnt lgkmcnt(6)
    v_mfma_f32_32x32x16_bf16 v[80:95], v[44:47], v[168:171], v[80:95]
    ds_read_b64_tr_b16 v[40:41], v6 offset:45056
    ds_read_b64_tr_b16 v[42:43], v6 offset:45568
    v_fma_f32 v13, v13, v15, v15
    v_rcp_f32 v10, v10
    v_rcp_f32 v11, v11
    s_waitcnt lgkmcnt(6)
    v_mfma_f32_32x32x16_bf16 v[80:95], v[20:23], v[172:175], v[80:95]
    ds_read_b64_tr_b16 v[44:45], v6 offset:47104
    ds_read_b64_tr_b16 v[46:47], v6 offset:47616
    v_rcp_f32 v12, v12
    v_rcp_f32 v13, v13
    v_mul_f32 v68, v68, v10
    s_waitcnt lgkmcnt(6)
    v_mfma_f32_32x32x16_bf16 v[80:95], v[32:35], v[176:179], v[80:95]
    ds_read_b64_tr_b16 v[20:21], v6 offset:49152
    ds_read_b64_tr_b16 v[22:23], v6 offset:49664
    v_add_f32 v28, v28, v29
    v_mul_f32 v69, v69, v11
    v_mul_f32 v70, v70, v12
    v_mul_f32 v71, v71, v13
    s_waitcnt lgkmcnt(6)
    v_mfma_f32_32x32x16_bf16 v[80:95], v[36:39], v[180:183], v[80:95]
    ds_read_b64_tr_b16 v[32:33], v6 offset:51200
    ds_read_b64_tr_b16 v[34:35], v6 offset:51712
    v_add_f32 v30, v30, v31
    v_cvt_pk_bf16_f32 v66, v68, v69
    v_cvt_pk_bf16_f32 v67, v70, v71
    buffer_store_dwordx4 v[64:67], v18, s[24:27], s61 offen offset:0 sc1
    s_waitcnt lgkmcnt(6)
    v_mfma_f32_32x32x16_bf16 v[80:95], v[40:43], v[184:187], v[80:95]
    ds_read_b64_tr_b16 v[36:37], v6 offset:53248
    ds_read_b64_tr_b16 v[38:39], v6 offset:53760
    v_add_f32 v28, v28, v30
    v_mul_f32 v10, v72, v72
    v_mul_f32 v11, v73, v73
    s_waitcnt lgkmcnt(6)
    v_mfma_f32_32x32x16_bf16 v[80:95], v[44:47], v[188:191], v[80:95]
    ds_read_b64_tr_b16 v[40:41], v6 offset:55296
    ds_read_b64_tr_b16 v[42:43], v6 offset:55808
    v_cvt_pk_bf16_f32 v29, v28, v28
    v_mul_f32 v12, v74, v74
    v_mul_f32 v13, v75, v75
    v_fma_f32 v10, v10, v17, v16
    s_waitcnt lgkmcnt(6)
    v_mfma_f32_32x32x16_bf16 v[80:95], v[20:23], v[192:195], v[80:95]
    ds_read_b64_tr_b16 v[44:45], v6 offset:57344
    ds_read_b64_tr_b16 v[46:47], v6 offset:57856
    v_and_b32 v30, 0xffff0000, v29
    v_fma_f32 v11, v11, v17, v16
    v_fma_f32 v12, v12, v17, v16
    v_fma_f32 v13, v13, v17, v16
    s_waitcnt lgkmcnt(6)
    v_mfma_f32_32x32x16_bf16 v[80:95], v[32:35], v[196:199], v[80:95]
    ds_read_b64_tr_b16 v[20:21], v6 offset:59392
    ds_read_b64_tr_b16 v[22:23], v6 offset:59904
    v_sub_f32 v30, v28, v30
    v_mul_f32 v10, v10, v72
    v_mul_f32 v11, v11, v73
    v_mul_f32 v12, v12, v74
    s_waitcnt lgkmcnt(6)
    v_mfma_f32_32x32x16_bf16 v[80:95], v[36:39], v[200:203], v[80:95]
    ds_read_b64_tr_b16 v[32:33], v6 offset:61440
    ds_read_b64_tr_b16 v[34:35], v6 offset:61952
    v_cvt_pk_bf16_f32 v28, v28, v30
    v_mul_f32 v13, v13, v75
    v_exp_f32 v10, v10
    s_waitcnt lgkmcnt(6)
    v_mfma_f32_32x32x16_bf16 v[80:95], v[40:43], v[204:207], v[80:95]
    ds_read_b64_tr_b16 v[36:37], v6 offset:63488
    ds_read_b64_tr_b16 v[38:39], v6 offset:64000
    v_perm_b32 v29, v26, v29, v8
    v_exp_f32 v11, v11
    v_exp_f32 v12, v12
    v_exp_f32 v13, v13
    s_barrier
    s_waitcnt lgkmcnt(6)
    v_mfma_f32_32x32x16_bf16 v[80:95], v[44:47], v[208:211], v[80:95]
    v_add_u32 v6, 65536, v6
    ds_read_b64_tr_b16 v[40:41], v6 offset:0
    ds_read_b64_tr_b16 v[42:43], v6 offset:512
    v_mov_b32 v30, v26
    v_fma_f32 v10, v10, v15, v15
    v_fma_f32 v11, v11, v15, v15
    v_fma_f32 v12, v12, v15, v15
    s_waitcnt lgkmcnt(6)
    v_mfma_f32_32x32x16_bf16 v[80:95], v[20:23], v[212:215], v[80:95]
    ds_read_b64_tr_b16 v[44:45], v6 offset:2048
    ds_read_b64_tr_b16 v[46:47], v6 offset:2560
    v_mov_b32 v31, 0
    v_fma_f32 v13, v13, v15, v15
    v_rcp_f32 v10, v10
    v_rcp_f32 v11, v11
    s_waitcnt lgkmcnt(6)
    v_mfma_f32_32x32x16_bf16 v[80:95], v[32:35], v[216:219], v[80:95]
    ds_read_b64_tr_b16 v[20:21], v6 offset:4096
    ds_read_b64_tr_b16 v[22:23], v6 offset:4608
    v_rcp_f32 v12, v12
    v_rcp_f32 v13, v13
    s_waitcnt lgkmcnt(6)
    v_mfma_f32_32x32x16_bf16 v[80:95], v[36:39], v[220:223], v[80:95]
    ds_read_b64_tr_b16 v[32:33], v6 offset:6144
    ds_read_b64_tr_b16 v[34:35], v6 offset:6656
    v_mul_f32 v72, v72, v10
    v_mul_f32 v73, v73, v11
    v_mul_f32 v74, v74, v12
    s_waitcnt lgkmcnt(6)
    v_mfma_f32_32x32x16_bf16 v[80:95], v[40:43], v[224:227], v[80:95]
    ds_read_b64_tr_b16 v[36:37], v6 offset:8192
    ds_read_b64_tr_b16 v[38:39], v6 offset:8704
    v_mul_f32 v75, v75, v13
    v_cvt_pk_bf16_f32 v72, v72, v73
    v_cvt_pk_bf16_f32 v73, v74, v75
    s_waitcnt lgkmcnt(6)
    v_mfma_f32_32x32x16_bf16 v[80:95], v[44:47], v[228:231], v[80:95]
    ds_read_b64_tr_b16 v[40:41], v6 offset:10240
    ds_read_b64_tr_b16 v[42:43], v6 offset:10752
    v_mul_f32 v10, v76, v76
    v_mul_f32 v11, v77, v77
    v_mul_f32 v12, v78, v78
    s_waitcnt lgkmcnt(6)
    v_mfma_f32_32x32x16_bf16 v[80:95], v[20:23], v[232:235], v[80:95]
    ds_read_b64_tr_b16 v[44:45], v6 offset:12288
    ds_read_b64_tr_b16 v[46:47], v6 offset:12800
    v_mul_f32 v13, v79, v79
    v_fma_f32 v10, v10, v17, v16
    v_fma_f32 v11, v11, v17, v16
    s_waitcnt lgkmcnt(6)
    v_mfma_f32_32x32x16_bf16 v[80:95], v[32:35], v[236:239], v[80:95]
    ds_read_b64_tr_b16 v[20:21], v6 offset:14336
    ds_read_b64_tr_b16 v[22:23], v6 offset:14848
    v_fma_f32 v12, v12, v17, v16
    v_fma_f32 v13, v13, v17, v16
    s_waitcnt lgkmcnt(6)
    v_mfma_f32_32x32x16_bf16 v[80:95], v[36:39], v[240:243], v[80:95]
    ds_read_b64_tr_b16 v[32:33], v7 offset:0
    ds_read_b64_tr_b16 v[34:35], v7 offset:512
    v_mul_f32 v10, v10, v76
    v_mul_f32 v11, v11, v77
    v_mul_f32 v12, v12, v78
    s_waitcnt lgkmcnt(6)
    v_mfma_f32_32x32x16_bf16 v[80:95], v[40:43], v[244:247], v[80:95]
    ds_read_b64_tr_b16 v[36:37], v7 offset:2048
    ds_read_b64_tr_b16 v[38:39], v7 offset:2560
    v_mul_f32 v13, v13, v79
    v_exp_f32 v10, v10
    v_exp_f32 v11, v11
    s_waitcnt lgkmcnt(6)
    v_mfma_f32_32x32x16_bf16 v[80:95], v[44:47], v[248:251], v[80:95]
    ds_read_b64_tr_b16 v[40:41], v7 offset:4096
    ds_read_b64_tr_b16 v[42:43], v7 offset:4608
    v_exp_f32 v12, v12
    v_exp_f32 v13, v13
    v_fma_f32 v10, v10, v15, v15
    s_waitcnt lgkmcnt(6)
    v_mfma_f32_32x32x16_bf16 v[80:95], v[20:23], v[252:255], v[80:95]
    ds_read_b64_tr_b16 v[44:45], v7 offset:6144
    ds_read_b64_tr_b16 v[46:47], v7 offset:6656
    v_fma_f32 v11, v11, v15, v15
    v_fma_f32 v12, v12, v15, v15
    v_mfma_f32_32x32x16_bf16 v[48:63], v[28:31], v[2:5], 0
    s_waitcnt lgkmcnt(6)
    v_mfma_f32_32x32x16_bf16 v[48:63], v[32:35], v[96:99], v[48:63]
    ds_read_b64_tr_b16 v[20:21], v7 offset:8192
    ds_read_b64_tr_b16 v[22:23], v7 offset:8704
    v_fma_f32 v13, v13, v15, v15
    v_rcp_f32 v10, v10
    v_rcp_f32 v11, v11
    s_waitcnt lgkmcnt(6)
    v_mfma_f32_32x32x16_bf16 v[48:63], v[36:39], v[100:103], v[48:63]
    ds_read_b64_tr_b16 v[32:33], v7 offset:10240
    ds_read_b64_tr_b16 v[34:35], v7 offset:10752
    v_rcp_f32 v12, v12
    v_rcp_f32 v13, v13
    v_mul_f32 v76, v76, v10
    s_waitcnt lgkmcnt(6)
    v_mfma_f32_32x32x16_bf16 v[48:63], v[40:43], v[104:107], v[48:63]
    ds_read_b64_tr_b16 v[36:37], v7 offset:12288
    ds_read_b64_tr_b16 v[38:39], v7 offset:12800
    v_mul_f32 v77, v77, v11
    v_mul_f32 v78, v78, v12
    v_mul_f32 v79, v79, v13
    s_waitcnt lgkmcnt(6)
    v_mfma_f32_32x32x16_bf16 v[48:63], v[44:47], v[108:111], v[48:63]
    ds_read_b64_tr_b16 v[40:41], v7 offset:14336
    ds_read_b64_tr_b16 v[42:43], v7 offset:14848
    v_cvt_pk_bf16_f32 v74, v76, v77
    v_cvt_pk_bf16_f32 v75, v78, v79
    buffer_store_dwordx4 v[72:75], v18, s[24:27], s61 offen offset:1024 sc1
    s_waitcnt lgkmcnt(6)
    v_mfma_f32_32x32x16_bf16 v[48:63], v[20:23], v[112:115], v[48:63]
    ds_read_b64_tr_b16 v[44:45], v7 offset:16384
    ds_read_b64_tr_b16 v[46:47], v7 offset:16896
    ds_write_b128 v14, v[80:83] offset:8192
    s_waitcnt lgkmcnt(7)
    v_mfma_f32_32x32x16_bf16 v[48:63], v[32:35], v[116:119], v[48:63]
    ds_read_b64_tr_b16 v[20:21], v7 offset:18432
    ds_read_b64_tr_b16 v[22:23], v7 offset:18944
    ds_write_b128 v14, v[84:87] offset:9216
    s_waitcnt lgkmcnt(8)
    v_mfma_f32_32x32x16_bf16 v[48:63], v[36:39], v[120:123], v[48:63]
    ds_read_b64_tr_b16 v[32:33], v7 offset:20480
    ds_read_b64_tr_b16 v[34:35], v7 offset:20992
    ds_write_b128 v14, v[88:91] offset:10240
    s_waitcnt lgkmcnt(9)
    v_mfma_f32_32x32x16_bf16 v[48:63], v[40:43], v[124:127], v[48:63]
    ds_read_b64_tr_b16 v[36:37], v7 offset:22528
    ds_read_b64_tr_b16 v[38:39], v7 offset:23040
    ds_write_b128 v14, v[92:95] offset:11264
    s_waitcnt lgkmcnt(10)
    v_mfma_f32_32x32x16_bf16 v[48:63], v[44:47], v[128:131], v[48:63]
    ds_read_b64_tr_b16 v[40:41], v7 offset:24576
    ds_read_b64_tr_b16 v[42:43], v7 offset:25088
    s_waitcnt lgkmcnt(9)
    v_mfma_f32_32x32x16_bf16 v[48:63], v[20:23], v[132:135], v[48:63]
    ds_read_b64_tr_b16 v[44:45], v7 offset:26624
    ds_read_b64_tr_b16 v[46:47], v7 offset:27136
    s_waitcnt lgkmcnt(8)
    v_mfma_f32_32x32x16_bf16 v[48:63], v[32:35], v[136:139], v[48:63]
    ds_read_b64_tr_b16 v[20:21], v7 offset:28672
    ds_read_b64_tr_b16 v[22:23], v7 offset:29184
    s_waitcnt lgkmcnt(7)
    v_mfma_f32_32x32x16_bf16 v[48:63], v[36:39], v[140:143], v[48:63]
    ds_read_b64_tr_b16 v[32:33], v7 offset:30720
    ds_read_b64_tr_b16 v[34:35], v7 offset:31232
    s_waitcnt lgkmcnt(8)
    s_barrier
    s_waitcnt lgkmcnt(6)
    v_mfma_f32_32x32x16_bf16 v[48:63], v[40:43], v[144:147], v[48:63]
    ds_read_b64_tr_b16 v[36:37], v7 offset:32768
    ds_read_b64_tr_b16 v[38:39], v7 offset:33280
    s_waitcnt lgkmcnt(6)
    v_mfma_f32_32x32x16_bf16 v[48:63], v[44:47], v[148:151], v[48:63]
    ds_read_b64_tr_b16 v[40:41], v7 offset:34816
    ds_read_b64_tr_b16 v[42:43], v7 offset:35328
    s_waitcnt lgkmcnt(6)
    v_mfma_f32_32x32x16_bf16 v[48:63], v[20:23], v[152:155], v[48:63]
    ds_read_b64_tr_b16 v[44:45], v7 offset:36864
    ds_read_b64_tr_b16 v[46:47], v7 offset:37376
    s_waitcnt lgkmcnt(6)
    v_mfma_f32_32x32x16_bf16 v[48:63], v[32:35], v[156:159], v[48:63]
    ds_read_b64_tr_b16 v[20:21], v7 offset:38912
    ds_read_b64_tr_b16 v[22:23], v7 offset:39424
    s_waitcnt lgkmcnt(6)
    v_mfma_f32_32x32x16_bf16 v[48:63], v[36:39], v[160:163], v[48:63]
    ds_read_b64_tr_b16 v[32:33], v7 offset:40960
    ds_read_b64_tr_b16 v[34:35], v7 offset:41472
    ds_read_b128 v[28:31], v19 offset:2048
    ds_read_u16 v26, v9 offset:2816
    s_waitcnt lgkmcnt(8)
    v_mfma_f32_32x32x16_bf16 v[48:63], v[40:43], v[164:167], v[48:63]
    ds_read_b64_tr_b16 v[36:37], v7 offset:43008
    ds_read_b64_tr_b16 v[38:39], v7 offset:43520
    s_waitcnt lgkmcnt(8)
    v_mfma_f32_32x32x16_bf16 v[48:63], v[44:47], v[168:171], v[48:63]
    ds_read_b64_tr_b16 v[40:41], v7 offset:45056
    ds_read_b64_tr_b16 v[42:43], v7 offset:45568
    s_waitcnt lgkmcnt(8)
    v_mfma_f32_32x32x16_bf16 v[48:63], v[20:23], v[172:175], v[48:63]
    ds_read_b64_tr_b16 v[44:45], v7 offset:47104
    ds_read_b64_tr_b16 v[46:47], v7 offset:47616
    s_waitcnt lgkmcnt(8)
    v_mfma_f32_32x32x16_bf16 v[48:63], v[32:35], v[176:179], v[48:63]
    ds_read_b64_tr_b16 v[20:21], v7 offset:49152
    ds_read_b64_tr_b16 v[22:23], v7 offset:49664
    s_waitcnt lgkmcnt(8)
    v_add_f32 v28, v28, v29
    s_waitcnt lgkmcnt(6)
    v_mfma_f32_32x32x16_bf16 v[48:63], v[36:39], v[180:183], v[48:63]
    ds_read_b64_tr_b16 v[32:33], v7 offset:51200
    ds_read_b64_tr_b16 v[34:35], v7 offset:51712
    v_add_f32 v30, v30, v31
    s_waitcnt lgkmcnt(6)
    v_mfma_f32_32x32x16_bf16 v[48:63], v[40:43], v[184:187], v[48:63]
    ds_read_b64_tr_b16 v[36:37], v7 offset:53248
    ds_read_b64_tr_b16 v[38:39], v7 offset:53760
    v_add_f32 v28, v28, v30
    s_waitcnt lgkmcnt(6)
    v_mfma_f32_32x32x16_bf16 v[48:63], v[44:47], v[188:191], v[48:63]
    ds_read_b64_tr_b16 v[40:41], v7 offset:55296
    ds_read_b64_tr_b16 v[42:43], v7 offset:55808
    v_cvt_pk_bf16_f32 v29, v28, v28
    s_waitcnt lgkmcnt(6)
    v_mfma_f32_32x32x16_bf16 v[48:63], v[20:23], v[192:195], v[48:63]
    ds_read_b64_tr_b16 v[44:45], v7 offset:57344
    ds_read_b64_tr_b16 v[46:47], v7 offset:57856
    v_and_b32 v30, 0xffff0000, v29
    s_waitcnt lgkmcnt(6)
    v_mfma_f32_32x32x16_bf16 v[48:63], v[32:35], v[196:199], v[48:63]
    ds_read_b64_tr_b16 v[20:21], v7 offset:59392
    ds_read_b64_tr_b16 v[22:23], v7 offset:59904
    v_sub_f32 v30, v28, v30
    s_waitcnt lgkmcnt(6)
    v_mfma_f32_32x32x16_bf16 v[48:63], v[36:39], v[200:203], v[48:63]
    ds_read_b64_tr_b16 v[32:33], v7 offset:61440
    ds_read_b64_tr_b16 v[34:35], v7 offset:61952
    v_cvt_pk_bf16_f32 v28, v28, v30
    s_waitcnt lgkmcnt(6)
    v_mfma_f32_32x32x16_bf16 v[48:63], v[40:43], v[204:207], v[48:63]
    ds_read_b64_tr_b16 v[36:37], v7 offset:63488
    ds_read_b64_tr_b16 v[38:39], v7 offset:64000
    v_perm_b32 v29, v26, v29, v8
    s_waitcnt lgkmcnt(6)
    v_mfma_f32_32x32x16_bf16 v[48:63], v[44:47], v[208:211], v[48:63]
    v_add_u32 v7, 65536, v7
    ds_read_b64_tr_b16 v[40:41], v7 offset:0
    ds_read_b64_tr_b16 v[42:43], v7 offset:512
    v_mov_b32 v30, v26
    s_waitcnt lgkmcnt(6)
    v_mfma_f32_32x32x16_bf16 v[48:63], v[20:23], v[212:215], v[48:63]
    ds_read_b64_tr_b16 v[44:45], v7 offset:2048
    ds_read_b64_tr_b16 v[46:47], v7 offset:2560
    v_mov_b32 v31, 0
    s_waitcnt lgkmcnt(6)
    v_mfma_f32_32x32x16_bf16 v[48:63], v[32:35], v[216:219], v[48:63]
    ds_read_b64_tr_b16 v[20:21], v7 offset:4096
    ds_read_b64_tr_b16 v[22:23], v7 offset:4608
    s_waitcnt lgkmcnt(6)
    v_mfma_f32_32x32x16_bf16 v[48:63], v[36:39], v[220:223], v[48:63]
    ds_read_b64_tr_b16 v[32:33], v7 offset:6144
    ds_read_b64_tr_b16 v[34:35], v7 offset:6656
    s_waitcnt lgkmcnt(6)
    v_mfma_f32_32x32x16_bf16 v[48:63], v[40:43], v[224:227], v[48:63]
    ds_read_b64_tr_b16 v[36:37], v7 offset:8192
    ds_read_b64_tr_b16 v[38:39], v7 offset:8704
    s_waitcnt lgkmcnt(6)
    v_mfma_f32_32x32x16_bf16 v[48:63], v[44:47], v[228:231], v[48:63]
    ds_read_b64_tr_b16 v[40:41], v7 offset:10240
    ds_read_b64_tr_b16 v[42:43], v7 offset:10752
    s_waitcnt lgkmcnt(6)
    v_mfma_f32_32x32x16_bf16 v[48:63], v[20:23], v[232:235], v[48:63]
    ds_read_b64_tr_b16 v[44:45], v7 offset:12288
    ds_read_b64_tr_b16 v[46:47], v7 offset:12800
    s_waitcnt lgkmcnt(6)
    v_mfma_f32_32x32x16_bf16 v[48:63], v[32:35], v[236:239], v[48:63]
    ds_read_b64_tr_b16 v[20:21], v7 offset:14336
    ds_read_b64_tr_b16 v[22:23], v7 offset:14848
    s_waitcnt vmcnt(0)
    s_barrier
    s_waitcnt lgkmcnt(6)
    v_mfma_f32_32x32x16_bf16 v[48:63], v[36:39], v[240:243], v[48:63]
    ds_read_b64_tr_b16 v[32:33], v24 offset:0
    ds_read_b64_tr_b16 v[34:35], v24 offset:256
    s_waitcnt lgkmcnt(6)
    v_mfma_f32_32x32x16_bf16 v[48:63], v[40:43], v[244:247], v[48:63]
    ds_read_b64_tr_b16 v[36:37], v24 offset:1024
    ds_read_b64_tr_b16 v[38:39], v24 offset:1280
    s_waitcnt lgkmcnt(6)
    v_mfma_f32_32x32x16_bf16 v[48:63], v[44:47], v[248:251], v[48:63]
    ds_read_b64_tr_b16 v[40:41], v24 offset:2048
    ds_read_b64_tr_b16 v[42:43], v24 offset:2304
    s_waitcnt lgkmcnt(6)
    v_mfma_f32_32x32x16_bf16 v[48:63], v[20:23], v[252:255], v[48:63]
    ds_read_b64_tr_b16 v[44:45], v24 offset:3072
    ds_read_b64_tr_b16 v[46:47], v24 offset:3328
    s_cmp_eq_u32 s71, 4
    s_cbranch_scc1 L_np4
    v_mfma_f32_32x32x16_bf16 v[64:79], v[28:31], v[2:5], 0
    s_waitcnt lgkmcnt(6)
    v_mfma_f32_32x32x16_bf16 v[64:79], v[32:35], v[96:99], v[64:79]
    ds_read_b64_tr_b16 v[20:21], v24 offset:4096
    ds_read_b64_tr_b16 v[22:23], v24 offset:4352
    s_waitcnt lgkmcnt(6)
    v_mfma_f32_32x32x16_bf16 v[64:79], v[36:39], v[100:103], v[64:79]
    ds_read_b64_tr_b16 v[32:33], v24 offset:5120
    ds_read_b64_tr_b16 v[34:35], v24 offset:5376
    s_waitcnt lgkmcnt(6)
    v_mfma_f32_32x32x16_bf16 v[64:79], v[40:43], v[104:107], v[64:79]
    ds_read_b64_tr_b16 v[36:37], v24 offset:6144
    ds_read_b64_tr_b16 v[38:39], v24 offset:6400
    s_waitcnt lgkmcnt(6)
    v_mfma_f32_32x32x16_bf16 v[64:79], v[44:47], v[108:111], v[64:79]
    ds_read_b64_tr_b16 v[40:41], v24 offset:7168
    ds_read_b64_tr_b16 v[42:43], v24 offset:7424
    ds_write_b128 v14, v[56:59] offset:26624
    s_waitcnt lgkmcnt(7)
    v_mfma_f32_32x32x16_bf16 v[64:79], v[20:23], v[112:115], v[64:79]
    ds_read_b64_tr_b16 v[44:45], v24 offset:8192
    ds_read_b64_tr_b16 v[46:47], v24 offset:8448
    ds_write_b128 v14, v[60:63] offset:27648
    s_waitcnt lgkmcnt(8)
    v_mfma_f32_32x32x16_bf16 v[64:79], v[32:35], v[116:119], v[64:79]
    ds_read_b64_tr_b16 v[20:21], v24 offset:9216
    ds_read_b64_tr_b16 v[22:23], v24 offset:9472
    v_mul_f32 v10, v48, v48
    s_waitcnt lgkmcnt(8)
    v_mfma_f32_32x32x16_bf16 v[64:79], v[36:39], v[120:123], v[64:79]
    ds_read_b64_tr_b16 v[32:33], v24 offset:10240
    ds_read_b64_tr_b16 v[34:35], v24 offset:10496
    v_mul_f32 v11, v49, v49
    v_mul_f32 v12, v50, v50
    s_waitcnt lgkmcnt(8)
    v_mfma_f32_32x32x16_bf16 v[64:79], v[40:43], v[124:127], v[64:79]
    ds_read_b64_tr_b16 v[36:37], v24 offset:11264
    ds_read_b64_tr_b16 v[38:39], v24 offset:11520
    v_mul_f32 v13, v51, v51
    v_fma_f32 v10, v10, v17, v16
    s_waitcnt lgkmcnt(7)
    v_mfma_f32_32x32x16_bf16 v[64:79], v[44:47], v[128:131], v[64:79]
    ds_read_b64_tr_b16 v[40:41], v24 offset:12288
    ds_read_b64_tr_b16 v[42:43], v24 offset:12544
    s_waitcnt lgkmcnt(8)
    s_barrier
    v_fma_f32 v11, v11, v17, v16
    v_fma_f32 v12, v12, v17, v16
    s_waitcnt lgkmcnt(6)
    v_mfma_f32_32x32x16_bf16 v[64:79], v[20:23], v[132:135], v[64:79]
    ds_read_b64_tr_b16 v[44:45], v24 offset:13312
    ds_read_b64_tr_b16 v[46:47], v24 offset:13568
    v_fma_f32 v13, v13, v17, v16
    v_mul_f32 v10, v10, v48
    s_waitcnt lgkmcnt(6)
    v_mfma_f32_32x32x16_bf16 v[64:79], v[32:35], v[136:139], v[64:79]
    ds_read_b64_tr_b16 v[20:21], v24 offset:14336
    ds_read_b64_tr_b16 v[22:23], v24 offset:14592
    v_mul_f32 v11, v11, v49
    v_mul_f32 v12, v12, v50
    s_waitcnt lgkmcnt(6)
    v_mfma_f32_32x32x16_bf16 v[64:79], v[36:39], v[140:143], v[64:79]
    ds_read_b64_tr_b16 v[32:33], v24 offset:15360
    ds_read_b64_tr_b16 v[34:35], v24 offset:15616
    v_mul_f32 v13, v13, v51
    v_exp_f32 v10, v10
    s_waitcnt lgkmcnt(6)
    v_mfma_f32_32x32x16_bf16 v[64:79], v[40:43], v[144:147], v[64:79]
    ds_read_b64_tr_b16 v[36:37], v24 offset:16384
    ds_read_b64_tr_b16 v[38:39], v24 offset:16640
    v_exp_f32 v11, v11
    v_exp_f32 v12, v12
    s_waitcnt lgkmcnt(6)
    v_mfma_f32_32x32x16_bf16 v[64:79], v[44:47], v[148:151], v[64:79]
    ds_read_b64_tr_b16 v[40:41], v24 offset:17408
    ds_read_b64_tr_b16 v[42:43], v24 offset:17664
    v_exp_f32 v13, v13
    v_fma_f32 v10, v10, v15, v15
    s_waitcnt lgkmcnt(6)
    v_mfma_f32_32x32x16_bf16 v[64:79], v[20:23], v[152:155], v[64:79]
    ds_read_b64_tr_b16 v[44:45], v24 offset:18432
    ds_read_b64_tr_b16 v[46:47], v24 offset:18688
    v_fma_f32 v11, v11, v15, v15
    v_fma_f32 v12, v12, v15, v15
    s_waitcnt lgkmcnt(6)
    v_mfma_f32_32x32x16_bf16 v[64:79], v[32:35], v[156:159], v[64:79]
    ds_read_b64_tr_b16 v[20:21], v24 offset:19456
    ds_read_b64_tr_b16 v[22:23], v24 offset:19712
    v_fma_f32 v13, v13, v15, v15
    s_waitcnt lgkmcnt(6)
    v_mfma_f32_32x32x16_bf16 v[64:79], v[36:39], v[160:163], v[64:79]
    ds_read_b64_tr_b16 v[32:33], v24 offset:20480
    ds_read_b64_tr_b16 v[34:35], v24 offset:20736
    v_rcp_f32 v10, v10
    v_rcp_f32 v11, v11
    s_waitcnt lgkmcnt(6)
    v_mfma_f32_32x32x16_bf16 v[64:79], v[40:43], v[164:167], v[64:79]
    ds_read_b64_tr_b16 v[36:37], v24 offset:21504
    ds_read_b64_tr_b16 v[38:39], v24 offset:21760
    v_rcp_f32 v12, v12
    v_rcp_f32 v13, v13
    s_waitcnt lgkmcnt(6)
    v_mfma_f32_32x32x16_bf16 v[64:79], v[44:47], v[168:171], v[64:79]
    ds_read_b64_tr_b16 v[40:41], v24 offset:22528
    ds_read_b64_tr_b16 v[42:43], v24 offset:22784
    v_mul_f32 v48, v48, v10
    v_mul_f32 v49, v49, v11
    s_waitcnt lgkmcnt(6)
    v_mfma_f32_32x32x16_bf16 v[64:79], v[20:23], v[172:175], v[64:79]
    ds_read_b64_tr_b16 v[44:45], v24 offset:23552
    ds_read_b64_tr_b16 v[46:47], v24 offset:23808
    v_mul_f32 v50, v50, v12
    v_mul_f32 v51, v51, v13
    s_waitcnt lgkmcnt(6)
    v_mfma_f32_32x32x16_bf16 v[64:79], v[32:35], v[176:179], v[64:79]
    ds_read_b64_tr_b16 v[20:21], v24 offset:24576
    ds_read_b64_tr_b16 v[22:23], v24 offset:24832
    v_cvt_pk_bf16_f32 v48, v48, v49
    v_cvt_pk_bf16_f32 v49, v50, v51
    s_waitcnt lgkmcnt(6)
    v_mfma_f32_32x32x16_bf16 v[64:79], v[36:39], v[180:183], v[64:79]
    ds_read_b64_tr_b16 v[32:33], v24 offset:25600
    ds_read_b64_tr_b16 v[34:35], v24 offset:25856
    v_mul_f32 v10, v52, v52
    v_mul_f32 v11, v53, v53
    s_waitcnt lgkmcnt(6)
    v_mfma_f32_32x32x16_bf16 v[64:79], v[40:43], v[184:187], v[64:79]
    ds_read_b64_tr_b16 v[36:37], v24 offset:26624
    ds_read_b64_tr_b16 v[38:39], v24 offset:26880
    v_mul_f32 v12, v54, v54
    v_mul_f32 v13, v55, v55
    s_waitcnt lgkmcnt(6)
    v_mfma_f32_32x32x16_bf16 v[64:79], v[44:47], v[188:191], v[64:79]
    ds_read_b64_tr_b16 v[40:41], v24 offset:27648
    ds_read_b64_tr_b16 v[42:43], v24 offset:27904
    v_fma_f32 v10, v10, v17, v16
    v_fma_f32 v11, v11, v17, v16
    s_waitcnt lgkmcnt(6)
    v_mfma_f32_32x32x16_bf16 v[64:79], v[20:23], v[192:195], v[64:79]
    ds_read_b64_tr_b16 v[44:45], v24 offset:28672
    ds_read_b64_tr_b16 v[46:47], v24 offset:28928
    v_fma_f32 v12, v12, v17, v16
    v_fma_f32 v13, v13, v17, v16
    s_waitcnt lgkmcnt(6)
    v_mfma_f32_32x32x16_bf16 v[64:79], v[32:35], v[196:199], v[64:79]
    ds_read_b64_tr_b16 v[20:21], v24 offset:29696
    ds_read_b64_tr_b16 v[22:23], v24 offset:29952
    v_mul_f32 v10, v10, v52
    v_mul_f32 v11, v11, v53
    s_waitcnt lgkmcnt(6)
    v_mfma_f32_32x32x16_bf16 v[64:79], v[36:39], v[200:203], v[64:79]
    ds_read_b64_tr_b16 v[32:33], v24 offset:30720
    ds_read_b64_tr_b16 v[34:35], v24 offset:30976
    v_mul_f32 v12, v12, v54
    s_waitcnt lgkmcnt(6)
    v_mfma_f32_32x32x16_bf16 v[64:79], v[40:43], v[204:207], v[64:79]
    ds_read_b64_tr_b16 v[36:37], v24 offset:31744
    ds_read_b64_tr_b16 v[38:39], v24 offset:32000
    v_mul_f32 v13, v13, v55
    v_exp_f32 v10, v10
    s_waitcnt lgkmcnt(6)
    v_mfma_f32_32x32x16_bf16 v[64:79], v[44:47], v[208:211], v[64:79]
    ds_read_b64_tr_b16 v[40:41], v24 offset:32768
    ds_read_b64_tr_b16 v[42:43], v24 offset:33024
    v_exp_f32 v11, v11
    v_exp_f32 v12, v12
    s_waitcnt lgkmcnt(6)
    v_mfma_f32_32x32x16_bf16 v[64:79], v[20:23], v[212:215], v[64:79]
    ds_read_b64_tr_b16 v[44:45], v24 offset:33792
    ds_read_b64_tr_b16 v[46:47], v24 offset:34048
    v_exp_f32 v13, v13
    v_fma_f32 v10, v10, v15, v15
    s_waitcnt lgkmcnt(6)
    v_mfma_f32_32x32x16_bf16 v[64:79], v[32:35], v[216:219], v[64:79]
    ds_read_b64_tr_b16 v[20:21], v24 offset:34816
    ds_read_b64_tr_b16 v[22:23], v24 offset:35072
    v_fma_f32 v11, v11, v15, v15
    v_fma_f32 v12, v12, v15, v15
    s_waitcnt lgkmcnt(6)
    v_mfma_f32_32x32x16_bf16 v[64:79], v[36:39], v[220:223], v[64:79]
    ds_read_b64_tr_b16 v[32:33], v24 offset:35840
    ds_read_b64_tr_b16 v[34:35], v24 offset:36096
    v_fma_f32 v13, v13, v15, v15
    v_rcp_f32 v10, v10
    s_waitcnt lgkmcnt(6)
    v_mfma_f32_32x32x16_bf16 v[64:79], v[40:43], v[224:227], v[64:79]
    ds_read_b64_tr_b16 v[36:37], v24 offset:36864
    ds_read_b64_tr_b16 v[38:39], v24 offset:37120
    v_rcp_f32 v11, v11
    v_rcp_f32 v12, v12
    s_waitcnt lgkmcnt(6)
    v_mfma_f32_32x32x16_bf16 v[64:79], v[44:47], v[228:231], v[64:79]
    ds_read_b64_tr_b16 v[40:41], v24 offset:37888
    ds_read_b64_tr_b16 v[42:43], v24 offset:38144
    v_rcp_f32 v13, v13
    v_mul_f32 v52, v52, v10
    s_waitcnt lgkmcnt(6)
    v_mfma_f32_32x32x16_bf16 v[64:79], v[20:23], v[232:235], v[64:79]
    ds_read_b64_tr_b16 v[44:45], v24 offset:38912
    ds_read_b64_tr_b16 v[46:47], v24 offset:39168
    v_mul_f32 v53, v53, v11
    v_mul_f32 v54, v54, v12
    s_waitcnt lgkmcnt(6)
    v_mfma_f32_32x32x16_bf16 v[64:79], v[32:35], v[236:239], v[64:79]
    ds_read_b64_tr_b16 v[20:21], v24 offset:39936
    ds_read_b64_tr_b16 v[22:23], v24 offset:40192
    v_mul_f32 v55, v55, v13
    v_cvt_pk_bf16_f32 v50, v52, v53
    s_waitcnt lgkmcnt(6)
    v_mfma_f32_32x32x16_bf16 v[64:79], v[36:39], v[240:243], v[64:79]
    v_cvt_pk_bf16_f32 v51, v54, v55
    buffer_store_dwordx4 v[48:51], v18, s[24:27], s64 offen offset:0 sc1
    s_waitcnt lgkmcnt(4)
    v_mfma_f32_32x32x16_bf16 v[64:79], v[40:43], v[244:247], v[64:79]
    s_waitcnt lgkmcnt(2)
    v_mfma_f32_32x32x16_bf16 v[64:79], v[44:47], v[248:251], v[64:79]
    s_waitcnt lgkmcnt(0)
    v_mfma_f32_32x32x16_bf16 v[64:79], v[20:23], v[252:255], v[64:79]
    s_nop 11
    ds_write_b128 v14, v[72:75] offset:10240
    ds_write_b128 v14, v[76:79] offset:11264
    s_waitcnt lgkmcnt(0)
    s_barrier
    v_mul_f32 v10, v64, v64
    v_mul_f32 v11, v65, v65
    v_mul_f32 v12, v66, v66
    v_mul_f32 v13, v67, v67
    v_fma_f32 v10, v10, v17, v16
    v_fma_f32 v11, v11, v17, v16
    v_fma_f32 v12, v12, v17, v16
    v_fma_f32 v13, v13, v17, v16
    v_mul_f32 v10, v10, v64
    v_mul_f32 v11, v11, v65
    v_mul_f32 v12, v12, v66
    v_mul_f32 v13, v13, v67
    v_exp_f32 v10, v10
    v_exp_f32 v11, v11
    v_exp_f32 v12, v12
    v_exp_f32 v13, v13
    v_fma_f32 v10, v10, v15, v15
    v_fma_f32 v11, v11, v15, v15
    v_fma_f32 v12, v12, v15, v15
    v_fma_f32 v13, v13, v15, v15
    v_rcp_f32 v10, v10
    v_rcp_f32 v11, v11
    v_rcp_f32 v12, v12
    v_rcp_f32 v13, v13
    v_mul_f32 v64, v64, v10
    v_mul_f32 v65, v65, v11
    v_mul_f32 v66, v66, v12
    v_mul_f32 v67, v67, v13
    v_cvt_pk_bf16_f32 v64, v64, v65
    v_cvt_pk_bf16_f32 v65, v66, v67
    v_mul_f32 v10, v68, v68
    v_mul_f32 v11, v69, v69
    v_mul_f32 v12, v70, v70
    v_mul_f32 v13, v71, v71
    v_fma_f32 v10, v10, v17, v16
    v_fma_f32 v11, v11, v17, v16
    v_fma_f32 v12, v12, v17, v16
    v_fma_f32 v13, v13, v17, v16
    v_mul_f32 v10, v10, v68
    v_mul_f32 v11, v11, v69
    v_mul_f32 v12, v12, v70
    v_mul_f32 v13, v13, v71
    v_exp_f32 v10, v10
    v_exp_f32 v11, v11
    v_exp_f32 v12, v12
    v_exp_f32 v13, v13
    v_fma_f32 v10, v10, v15, v15
    v_fma_f32 v11, v11, v15, v15
    v_fma_f32 v12, v12, v15, v15
    v_fma_f32 v13, v13, v15, v15
    v_rcp_f32 v10, v10
    v_rcp_f32 v11, v11
    v_rcp_f32 v12, v12
    v_rcp_f32 v13, v13
    v_mul_f32 v68, v68, v10
    v_mul_f32 v69, v69, v11
    v_mul_f32 v70, v70, v12
    v_mul_f32 v71, v71, v13
    v_cvt_pk_bf16_f32 v66, v68, v69
    v_cvt_pk_bf16_f32 v67, v70, v71
    buffer_store_dwordx4 v[64:67], v18, s[24:27], s65 offen offset:0 sc1
    s_mov_b32 s59, s58
    s_waitcnt vmcnt(1)
    s_branch L_CA
L_np4:
    s_nop 15
    ds_write_b128 v14, v[56:59] offset:26624
    ds_write_b128 v14, v[60:63] offset:27648
    s_waitcnt lgkmcnt(0)
    s_barrier
    v_mul_f32 v10, v48, v48
    v_mul_f32 v11, v49, v49
    v_mul_f32 v12, v50, v50
    v_mul_f32 v13, v51, v51
    v_fma_f32 v10, v10, v17, v16
    v_fma_f32 v11, v11, v17, v16
    v_fma_f32 v12, v12, v17, v16
    v_fma_f32 v13, v13, v17, v16
    v_mul_f32 v10, v10, v48
    v_mul_f32 v11, v11, v49
    v_mul_f32 v12, v12, v50
    v_mul_f32 v13, v13, v51
    v_exp_f32 v10, v10
    v_exp_f32 v11, v11
    v_exp_f32 v12, v12
    v_exp_f32 v13, v13
    v_fma_f32 v10, v10, v15, v15
    v_fma_f32 v11, v11, v15, v15
    v_fma_f32 v12, v12, v15, v15
    v_fma_f32 v13, v13, v15, v15
    v_rcp_f32 v10, v10
    v_rcp_f32 v11, v11
    v_rcp_f32 v12, v12
    v_rcp_f32 v13, v13
    v_mul_f32 v48, v48, v10
    v_mul_f32 v49, v49, v11
    v_mul_f32 v50, v50, v12
    v_mul_f32 v51, v51, v13
    v_cvt_pk_bf16_f32 v48, v48, v49
    v_cvt_pk_bf16_f32 v49, v50, v51
    v_mul_f32 v10, v52, v52
    v_mul_f32 v11, v53, v53
    v_mul_f32 v12, v54, v54
    v_mul_f32 v13, v55, v55
    v_fma_f32 v10, v10, v17, v16
    v_fma_f32 v11, v11, v17, v16
    v_fma_f32 v12, v12, v17, v16
    v_fma_f32 v13, v13, v17, v16
    v_mul_f32 v10, v10, v52
    v_mul_f32 v11, v11, v53
    v_mul_f32 v12, v12, v54
    v_mul_f32 v13, v13, v55
    v_exp_f32 v10, v10
    v_exp_f32 v11, v11
    v_exp_f32 v12, v12
    v_exp_f32 v13, v13
    v_fma_f32 v10, v10, v15, v15
    v_fma_f32 v11, v11, v15, v15
    v_fma_f32 v12, v12, v15, v15
    v_fma_f32 v13, v13, v15, v15
    v_rcp_f32 v10, v10
    v_rcp_f32 v11, v11
    v_rcp_f32 v12, v12
    v_rcp_f32 v13, v13
    v_mul_f32 v52, v52, v10
    v_mul_f32 v53, v53, v11
    v_mul_f32 v54, v54, v12
    v_mul_f32 v55, v55, v13
    v_cvt_pk_bf16_f32 v50, v52, v53
    v_cvt_pk_bf16_f32 v51, v54, v55
    buffer_store_dwordx4 v[48:51], v18, s[24:27], s64 offen offset:0 sc1
    s_mov_b32 s59, s58
    s_waitcnt vmcnt(0)
    s_barrier
    s_branch L_CA
L_dft:
    s_cmp_eq_u32 s53, 0
    s_cselect_b64 vcc, -1, 0
    v_cndmask_b32 v2, v4, v2, vcc
    v_cndmask_b32 v3, v5, v3, vcc
    s_lshl_b32 s54, s53, 11
    s_add_u32 s59, s72, s54
    s_waitcnt lgkmcnt(0)
    s_add_u32 m0, s59, 81920
    s_nop 0
    buffer_load_dwordx4 v2, s[12:15], s32 offen  lds
    s_add_u32 m0, s59, 82944
    s_nop 0
    buffer_load_dwordx4 v3, s[12:15], s32 offen  lds
    s_add_u32 s33, s32, 128
    s_cmp_eq_u32 s33, 1280
    s_cselect_b32 s33, 0, s33
    s_add_u32 s34, s33, 128
    s_cmp_eq_u32 s34, 1280
    s_cselect_b32 s34, 0, s34
    s_add_u32 s35, s34, 128
    s_cmp_eq_u32 s35, 1280
    s_cselect_b32 s35, 0, s35
    s_add_u32 s36, s35, 128
    s_cmp_eq_u32 s36, 1280
    s_cselect_b32 s36, 0, s36
    s_add_u32 s37, s36, 128
    s_cmp_eq_u32 s37, 1280
    s_cselect_b32 s37, 0, s37
    s_add_u32 s38, s37, 128
    s_cmp_eq_u32 s38, 1280
    s_cselect_b32 s38, 0, s38
    s_add_u32 s39, s38, 128
    s_cmp_eq_u32 s39, 1280
    s_cselect_b32 s39, 0, s39
    s_add_u32 s40, s39, 128
    s_cmp_eq_u32 s40, 1280
    s_cselect_b32 s40, 0, s40
    s_add_u32 s41, s40, 128
    s_cmp_eq_u32 s41, 1280
    s_cselect_b32 s41, 0, s41
    s_add_u32 m0, s59, 98304
    s_nop 0
    buffer_load_dwordx4 v2, s[12:15], s33 offen  lds
    s_add_u32 m0, s59, 99328
    s_nop 0
    buffer_load_dwordx4 v3, s[12:15], s33 offen  lds
    s_add_u32 m0, s59, 114688
    s_nop 0
    buffer_load_dwordx4 v2, s[12:15], s34 offen  lds
    s_add_u32 m0, s59, 115712
    s_nop 0
    buffer_load_dwordx4 v3, s[12:15], s34 offen  lds
    s_load_dwordx4 s[68:71], s[0:1], 8
    s_lshl_b32 s54, s30, 1
    s_add_u32 s58, s54, s53
    s_lshl_b32 s54, s58, 4
    v_and_b32 v12, 15, v1
    v_add_u32 v12, s54, v12
    v_cmp_eq_u32 vcc, 0, v12
    v_mov_b32 v13, 160
    s_nop 0
    v_cndmask_b32 v13, v12, v13, vcc
    s_mov_b64 s[74:75], vcc
    v_cvt_f32_u32 v6, v12
    v_cvt_f32_u32 v7, v13
    v_mul_f32 v6, 0x3acccccd, v6
    v_mul_f32 v7, 0xbacccccd, v7
    s_and_b32 s54, s28, 1
    s_bfe_u32 s55, s28, 0x10001
    s_cmp_eq_u32 s55, 0
    s_cselect_b32 s56, s32, s37
    s_lshr_b32 s56, s56, 1
    s_add_u32 s56, s56, s54
    v_lshrrev_b32 v8, 4, v1
    v_lshlrev_b32 v8, 3, v8
    v_add_u32 v8, s56, v8
    v_cvt_f32_u32 v8, v8
    v_add_f32 v8, 0.5, v8
    s_mul_i32 s56, s53, 40968
    s_mul_i32 s55, s55, 20480
    s_add_u32 s56, s56, s55
    s_lshl_b32 s54, s54, 11
    s_add_u32 s56, s56, s54
    v_lshl_add_u32 v11, v1, 4, s56
    v_xor_b32 v14, 8, v11
    v_mul_f32 v9, 0x42000000, v6
    v_mul_f32 v10, 0x42000000, v7
    v_cos_f32 v9, v9
    v_cos_f32 v10, v10
    v_mul_f32 v12, v8, v6
    v_mul_f32 v13, v8, v7
    v_add_f32 v9, v9, v9
    v_add_f32 v10, v10, v10
    v_cos_f32 v64, v12
    v_sin_f32 v80, v13
    v_fmamk_f32 v65, v6, 0x40000000, v12
    v_fmamk_f32 v81, v7, 0x40000000, v13
    v_cos_f32 v65, v65
    v_sin_f32 v81, v81
    v_fmamk_f32 v66, v6, 0x40800000, v12
    v_fmamk_f32 v82, v7, 0x40800000, v13
    v_cos_f32 v66, v66
    v_sin_f32 v82, v82
    v_fmamk_f32 v67, v6, 0x40c00000, v12
    v_fmamk_f32 v83, v7, 0x40c00000, v13
    v_cos_f32 v67, v67
    v_sin_f32 v83, v83
    v_fmamk_f32 v68, v6, 0x42000000, v12
    v_fmamk_f32 v84, v7, 0x42000000, v13
    v_cos_f32 v68, v68
    v_sin_f32 v84, v84
    v_fmamk_f32 v69, v6, 0x42080000, v12
    v_fmamk_f32 v85, v7, 0x42080000, v13
    v_cos_f32 v69, v69
    v_sin_f32 v85, v85
    v_fmamk_f32 v70, v6, 0x42100000, v12
    v_fmamk_f32 v86, v7, 0x42100000, v13
    v_cos_f32 v70, v70
    v_sin_f32 v86, v86
    v_fmamk_f32 v71, v6, 0x42180000, v12
    v_fmamk_f32 v87, v7, 0x42180000, v13
    v_cos_f32 v71, v71
    v_sin_f32 v87, v87
    v_cvt_pk_bf16_f32 v96, v64, v65
    v_cvt_pk_bf16_f32 v100, v80, v81
    v_cvt_pk_bf16_f32 v97, v66, v67
    v_cvt_pk_bf16_f32 v101, v82, v83
    v_cvt_pk_bf16_f32 v98, v68, v69
    v_cvt_pk_bf16_f32 v102, v84, v85
    v_cvt_pk_bf16_f32 v99, v70, v71
    v_cvt_pk_bf16_f32 v103, v86, v87
    ds_write2st64_b64 v11, v[96:97], v[100:101] offset0:0 offset1:2
    ds_write2st64_b64 v14, v[98:99], v[102:103] offset0:0 offset1:2
    v_fma_f32 v64, v9, v68, -v64
    v_fma_f32 v80, v10, v84, -v80
    v_fma_f32 v65, v9, v69, -v65
    v_fma_f32 v81, v10, v85, -v81
    v_fma_f32 v66, v9, v70, -v66
    v_fma_f32 v82, v10, v86, -v82
    v_fma_f32 v67, v9, v71, -v67
    v_fma_f32 v83, v10, v87, -v83
    v_fma_f32 v68, v9, v64, -v68
    v_fma_f32 v84, v10, v80, -v84
    v_fma_f32 v69, v9, v65, -v69
    v_fma_f32 v85, v10, v81, -v85
    v_fma_f32 v70, v9, v66, -v70
    v_fma_f32 v86, v10, v82, -v86
    v_fma_f32 v71, v9, v67, -v71
    v_fma_f32 v87, v10, v83, -v87
    v_cvt_pk_bf16_f32 v104, v64, v65
    v_cvt_pk_bf16_f32 v108, v80, v81
    v_cvt_pk_bf16_f32 v105, v66, v67
    v_cvt_pk_bf16_f32 v109, v82, v83
    v_cvt_pk_bf16_f32 v106, v68, v69
    v_cvt_pk_bf16_f32 v110, v84, v85
    v_cvt_pk_bf16_f32 v107, v70, v71
    v_cvt_pk_bf16_f32 v111, v86, v87
    ds_write2st64_b64 v11, v[104:105], v[108:109] offset0:8 offset1:10
    ds_write2st64_b64 v14, v[106:107], v[110:111] offset0:8 offset1:10
    v_fma_f32 v64, v9, v68, -v64
    v_fma_f32 v80, v10, v84, -v80
    v_fma_f32 v65, v9, v69, -v65
    v_fma_f32 v81, v10, v85, -v81
    v_fma_f32 v66, v9, v70, -v66
    v_fma_f32 v82, v10, v86, -v82
    v_fma_f32 v67, v9, v71, -v67
    v_fma_f32 v83, v10, v87, -v83
    v_fma_f32 v68, v9, v64, -v68
    v_fma_f32 v84, v10, v80, -v84
    v_fma_f32 v69, v9, v65, -v69
    v_fma_f32 v85, v10, v81, -v85
    v_fma_f32 v70, v9, v66, -v70
    v_fma_f32 v86, v10, v82, -v86
    v_fma_f32 v71, v9, v67, -v71
    v_fma_f32 v87, v10, v83, -v87
    v_cvt_pk_bf16_f32 v96, v64, v65
    v_cvt_pk_bf16_f32 v100, v80, v81
    v_cvt_pk_bf16_f32 v97, v66, v67
    v_cvt_pk_bf16_f32 v101, v82, v83
    v_cvt_pk_bf16_f32 v98, v68, v69
    v_cvt_pk_bf16_f32 v102, v84, v85
    v_cvt_pk_bf16_f32 v99, v70, v71
    v_cvt_pk_bf16_f32 v103, v86, v87
    ds_write2st64_b64 v11, v[96:97], v[100:101] offset0:16 offset1:18
    ds_write2st64_b64 v14, v[98:99], v[102:103] offset0:16 offset1:18
    v_fma_f32 v64, v9, v68, -v64
    v_fma_f32 v80, v10, v84, -v80
    v_fma_f32 v65, v9, v69, -v65
    v_fma_f32 v81, v10, v85, -v81
    v_fma_f32 v66, v9, v70, -v66
    v_fma_f32 v82, v10, v86, -v82
    v_fma_f32 v67, v9, v71, -v67
    v_fma_f32 v83, v10, v87, -v83
    v_fma_f32 v68, v9, v64, -v68
    v_fma_f32 v84, v10, v80, -v84
    v_fma_f32 v69, v9, v65, -v69
    v_fma_f32 v85, v10, v81, -v85
    v_fma_f32 v70, v9, v66, -v70
    v_fma_f32 v86, v10, v82, -v86
    v_fma_f32 v71, v9, v67, -v71
    v_fma_f32 v87, v10, v83, -v87
    v_cvt_pk_bf16_f32 v104, v64, v65
    v_cvt_pk_bf16_f32 v108, v80, v81
    v_cvt_pk_bf16_f32 v105, v66, v67
    v_cvt_pk_bf16_f32 v109, v82, v83
    v_cvt_pk_bf16_f32 v106, v68, v69
    v_cvt_pk_bf16_f32 v110, v84, v85
    v_cvt_pk_bf16_f32 v107, v70, v71
    v_cvt_pk_bf16_f32 v111, v86, v87
    ds_write2st64_b64 v11, v[104:105], v[108:109] offset0:24 offset1:26
    ds_write2st64_b64 v14, v[106:107], v[110:111] offset0:24 offset1:26
    v_fma_f32 v64, v9, v68, -v64
    v_fma_f32 v80, v10, v84, -v80
    v_fma_f32 v65, v9, v69, -v65
    v_fma_f32 v81, v10, v85, -v81
    v_fma_f32 v66, v9, v70, -v66
    v_fma_f32 v82, v10, v86, -v82
    v_fma_f32 v67, v9, v71, -v67
    v_fma_f32 v83, v10, v87, -v83
    v_fma_f32 v68, v9, v64, -v68
    v_fma_f32 v84, v10, v80, -v84
    v_fma_f32 v69, v9, v65, -v69
    v_fma_f32 v85, v10, v81, -v85
    v_fma_f32 v70, v9, v66, -v70
    v_fma_f32 v86, v10, v82, -v86
    v_fma_f32 v71, v9, v67, -v71
    v_fma_f32 v87, v10, v83, -v87
    v_cvt_pk_bf16_f32 v96, v64, v65
    v_cvt_pk_bf16_f32 v100, v80, v81
    v_cvt_pk_bf16_f32 v97, v66, v67
    v_cvt_pk_bf16_f32 v101, v82, v83
    v_cvt_pk_bf16_f32 v98, v68, v69
    v_cvt_pk_bf16_f32 v102, v84, v85
    v_cvt_pk_bf16_f32 v99, v70, v71
    v_cvt_pk_bf16_f32 v103, v86, v87
    ds_write2st64_b64 v11, v[96:97], v[100:101] offset0:32 offset1:34
    ds_write2st64_b64 v14, v[98:99], v[102:103] offset0:32 offset1:34
    v_and_b32 v18, 15, v1
    v_lshrrev_b32 v19, 4, v1
    v_bfe_u32 v20, v1, 1, 3
    v_xor_b32 v20, v20, v19
    s_lshl_b32 s54, s53, 2
    v_xor_b32 v20, s54, v20
    s_lshl_b32 s54, s52, 5
    v_add_u32 v18, s54, v18
    v_lshlrev_b32 v18, 7, v18
    v_lshl_add_u32 v6, v20, 4, v18
    v_add_u32 v6, 81920, v6
    v_xor_b32 v7, 64, v6
    v_add_u32 v8, 2048, v6
    v_add_u32 v9, 2048, v7
    s_mul_i32 s54, s53, 40960
    v_lshl_add_u32 v10, v1, 4, s54
    v_mov_b32 v11, 0x05040100
    v_mov_b32 v12, 0x07060302
    s_lshl_b32 s54, s29, 2
    s_add_u32 s60, s54, s52
    s_lshl_b32 s54, s29, 11
    s_lshl_b32 s55, s52, 9
    s_add_u32 s54, s54, s55
    s_add_u32 s54, s54, 28835840
    v_and_b32 v16, 31, v1
    v_lshl_add_u32 v16, v16, 4, s54
    s_waitcnt lgkmcnt(0)
    s_waitcnt vmcnt(4)
    s_barrier
    ds_read_b128 v[64:67], v6 offset:0
    ds_read_b128 v[68:71], v7 offset:0
    ds_read_b128 v[72:75], v8 offset:0
    ds_read_b128 v[76:79], v9 offset:0
    s_add_u32 m0, s59, 131072
    s_nop 0
    buffer_load_dwordx4 v2, s[12:15], s35 offen  lds
    s_add_u32 m0, s59, 132096
    s_nop 0
    buffer_load_dwordx4 v3, s[12:15], s35 offen  lds
    s_add_u32 m0, s59, 147456
    s_nop 0
    buffer_load_dwordx4 v2, s[12:15], s36 offen  lds
    s_add_u32 m0, s59, 148480
    s_nop 0
    buffer_load_dwordx4 v3, s[12:15], s36 offen  lds
    v_lshrrev_b32 v20, 4, v1
    v_lshlrev_b32 v20, 8, v20
    v_add_u32 v20, s60, v20
    v_cvt_f32_u32 v20, v20
    v_and_b32 v21, 1, v1
    s_lshl_b32 s54, s53, 4
    v_and_b32 v22, 15, v1
    v_add_u32 v22, s54, v22
    v_lshrrev_b32 v23, 1, v22
    v_cvt_f32_u32 v23, v23
    v_cmp_eq_u32 vcc, 1, v21
    v_sub_f32 v21, 0, v23
    s_nop 0
    v_cndmask_b32 v23, v21, v23, vcc
    v_mov_b32 v21, 0.25
    v_cndmask_b32 v21, 0, v21, vcc
    v_cmp_eq_u32 vcc, 1, v22
    v_mov_b32 v22, 0xc1800000
    s_nop 0
    v_cndmask_b32 v23, v23, v22, vcc
    v_mov_b32 v22, 0
    v_cndmask_b32 v21, v21, v22, vcc
    v_mul_f32 v23, 0x3a000000, v23
    v_fma_f32 v21, v23, v20, v21
    v_mov_b32 v24, v21
    v_fmamk_f32 v25, v23, 0x42800000, v21
    v_fmamk_f32 v26, v23, 0x43000000, v21
    v_fmamk_f32 v27, v23, 0x43400000, v21
    v_fmamk_f32 v28, v23, 0x44800000, v21
    v_fmamk_f32 v29, v23, 0x44880000, v21
    v_fmamk_f32 v30, v23, 0x44900000, v21
    v_fmamk_f32 v31, v23, 0x44980000, v21
    s_waitcnt lgkmcnt(0)
    s_waitcnt vmcnt(6)
    s_barrier
    ds_read_b128 v[80:83], v6 offset:16384
    ds_read_b128 v[84:87], v7 offset:16384
    ds_read_b128 v[88:91], v8 offset:16384
    ds_read_b128 v[92:95], v9 offset:16384
    ds_read_b128 v[96:99], v10 offset:0
    ds_read_b128 v[100:103], v10 offset:1024
    ds_read_b128 v[104:107], v10 offset:2048
    ds_read_b128 v[108:111], v10 offset:3072
    s_add_u32 m0, s59, 81920
    s_nop 0
    buffer_load_dwordx4 v2, s[12:15], s37 offen  lds
    s_add_u32 m0, s59, 82944
    s_nop 0
    buffer_load_dwordx4 v3, s[12:15], s37 offen  lds
    v_perm_b32 v128, v65, v64, v11
    v_perm_b32 v132, v65, v64, v12
    v_perm_b32 v129, v67, v66, v11
    v_perm_b32 v133, v67, v66, v12
    v_perm_b32 v130, v69, v68, v11
    v_perm_b32 v134, v69, v68, v12
    v_perm_b32 v131, v71, v70, v11
    v_perm_b32 v135, v71, v70, v12
    v_perm_b32 v136, v73, v72, v11
    v_perm_b32 v140, v73, v72, v12
    v_perm_b32 v137, v75, v74, v11
    v_perm_b32 v141, v75, v74, v12
    v_perm_b32 v138, v77, v76, v11
    v_perm_b32 v142, v77, v76, v12
    v_perm_b32 v139, v79, v78, v11
    v_perm_b32 v143, v79, v78, v12
    v_sin_f32 v32, v24
    v_cos_f32 v24, v24
    v_sin_f32 v33, v25
    v_cos_f32 v25, v25
    v_sin_f32 v34, v26
    v_cos_f32 v26, v26
    v_sin_f32 v35, v27
    v_cos_f32 v27, v27
    v_sin_f32 v36, v28
    v_cos_f32 v28, v28
    v_sin_f32 v37, v29
    v_cos_f32 v29, v29
    v_sin_f32 v38, v30
    v_cos_f32 v30, v30
    v_sin_f32 v39, v31
    v_cos_f32 v31, v31
    v_cvt_pk_bf16_f32 v40, v24, v25
    v_cvt_pk_bf16_f32 v44, v32, v33
    v_cvt_pk_bf16_f32 v41, v26, v27
    v_cvt_pk_bf16_f32 v45, v34, v35
    v_cvt_pk_bf16_f32 v42, v28, v29
    v_cvt_pk_bf16_f32 v46, v36, v37
    v_cvt_pk_bf16_f32 v43, v30, v31
    v_cvt_pk_bf16_f32 v47, v38, v39
    s_waitcnt lgkmcnt(0)
    s_waitcnt vmcnt(6)
    s_barrier
    v_mfma_f32_16x16x32_bf16 v[160:163], v[128:131], v[96:99], 0
    ds_read_b128 v[64:67], v6 offset:32768
    v_perm_b32 v144, v81, v80, v11
    v_perm_b32 v148, v81, v80, v12
    v_mfma_f32_16x16x32_bf16 v[168:171], v[128:131], v[100:103], 0
    ds_read_b128 v[68:71], v7 offset:32768
    v_perm_b32 v145, v83, v82, v11
    v_perm_b32 v149, v83, v82, v12
    v_mfma_f32_16x16x32_bf16 v[176:179], v[132:135], v[104:107], 0
    ds_read_b128 v[72:75], v8 offset:32768
    v_perm_b32 v146, v85, v84, v11
    v_perm_b32 v150, v85, v84, v12
    v_mfma_f32_16x16x32_bf16 v[184:187], v[132:135], v[108:111], 0
    ds_read_b128 v[76:79], v9 offset:32768
    v_perm_b32 v147, v87, v86, v11
    v_perm_b32 v151, v87, v86, v12
    v_mfma_f32_16x16x32_bf16 v[164:167], v[136:139], v[96:99], 0
    ds_read_b128 v[112:115], v10 offset:4096
    v_perm_b32 v152, v89, v88, v11
    v_perm_b32 v156, v89, v88, v12
    v_mfma_f32_16x16x32_bf16 v[172:175], v[136:139], v[100:103], 0
    ds_read_b128 v[116:119], v10 offset:5120
    v_perm_b32 v153, v91, v90, v11
    v_perm_b32 v157, v91, v90, v12
    v_mfma_f32_16x16x32_bf16 v[180:183], v[140:143], v[104:107], 0
    ds_read_b128 v[120:123], v10 offset:6144
    v_perm_b32 v154, v93, v92, v11
    v_perm_b32 v158, v93, v92, v12
    v_mfma_f32_16x16x32_bf16 v[188:191], v[140:143], v[108:111], 0
    ds_read_b128 v[124:127], v10 offset:7168
    s_add_u32 m0, s59, 98304
    s_nop 0
    buffer_load_dwordx4 v2, s[12:15], s38 offen  lds
    s_add_u32 m0, s59, 99328
    s_nop 0
    buffer_load_dwordx4 v3, s[12:15], s38 offen  lds
    v_perm_b32 v155, v95, v94, v11
    v_perm_b32 v159, v95, v94, v12
    s_cmp_lt_u32 s52, 2
    s_cselect_b32 s16, s68, s70
    s_cselect_b32 s17, s69, s71
    s_mov_b32 s18, 1314816
    s_and_b32 s65, s30, 1
    s_lshl_b32 s62, s65, 6
    s_lshl_b32 s65, s65, 2
    s_add_u32 s65, s65, s52
    s_lshr_b32 s64, s30, 1
    s_sub_u32 s56, 257, s62
    s_cmp_eq_u32 s64, 0
    s_cselect_b32 s62, s62, s56
    s_waitcnt lgkmcnt(0)
    s_waitcnt vmcnt(6)
    s_barrier
    v_mfma_f32_16x16x32_bf16 v[160:163], v[144:147], v[112:115], v[160:163]
    ds_read_b128 v[80:83], v6 offset:49152
    v_perm_b32 v128, v65, v64, v11
    v_perm_b32 v132, v65, v64, v12
    v_mfma_f32_16x16x32_bf16 v[168:171], v[144:147], v[116:119], v[168:171]
    ds_read_b128 v[84:87], v7 offset:49152
    v_perm_b32 v129, v67, v66, v11
    v_perm_b32 v133, v67, v66, v12
    v_mfma_f32_16x16x32_bf16 v[176:179], v[148:151], v[120:123], v[176:179]
    ds_read_b128 v[88:91], v8 offset:49152
    v_perm_b32 v130, v69, v68, v11
    v_perm_b32 v134, v69, v68, v12
    v_mfma_f32_16x16x32_bf16 v[184:187], v[148:151], v[124:127], v[184:187]
    ds_read_b128 v[92:95], v9 offset:49152
    v_perm_b32 v131, v71, v70, v11
    v_perm_b32 v135, v71, v70, v12
    v_mfma_f32_16x16x32_bf16 v[164:167], v[152:155], v[112:115], v[164:167]
    ds_read_b128 v[96:99], v10 offset:8192
    v_perm_b32 v136, v73, v72, v11
    v_perm_b32 v140, v73, v72, v12
    v_mfma_f32_16x16x32_bf16 v[172:175], v[152:155], v[116:119], v[172:175]
    ds_read_b128 v[100:103], v10 offset:9216
    v_perm_b32 v137, v75, v74, v11
    v_perm_b32 v141, v75, v74, v12
    v_mfma_f32_16x16x32_bf16 v[180:183], v[156:159], v[120:123], v[180:183]
    ds_read_b128 v[104:107], v10 offset:10240
    v_perm_b32 v138, v77, v76, v11
    v_perm_b32 v142, v77, v76, v12
    v_mfma_f32_16x16x32_bf16 v[188:191], v[156:159], v[124:127], v[188:191]
    ds_read_b128 v[108:111], v10 offset:11264
    s_add_u32 m0, s59, 114688
    s_nop 0
    buffer_load_dwordx4 v2, s[12:15], s39 offen  lds
    s_add_u32 m0, s59, 115712
    s_nop 0
    buffer_load_dwordx4 v3, s[12:15], s39 offen  lds
    v_perm_b32 v139, v79, v78, v11
    v_perm_b32 v143, v79, v78, v12
    s_and_b32 s54, s52, 1
    s_add_u32 s55, s54, 8
    s_lshr_b32 s56, s52, 1
    s_cmp_eq_u32 s30, 4
    s_cselect_b32 s65, s55, s65
    s_cselect_b32 s64, s56, s64
    s_cselect_b32 s62, 128, s62
    s_lshl_b32 s61, s65, 1
    s_add_u32 s61, s61, s64
    s_sub_u32 s56, 0, s29
    s_cmp_eq_u32 s29, 0
    s_cselect_b32 s66, 16, s56
    s_cmp_eq_u32 s54, 0
    s_cselect_b32 s63, s29, s66
    s_waitcnt lgkmcnt(0)
    s_waitcnt vmcnt(6)
    s_barrier
    v_mfma_f32_16x16x32_bf16 v[160:163], v[128:131], v[96:99], v[160:163]
    v_add_u32 v6, 16384, v6
    ds_read_b128 v[64:67], v6 offset:49152
    v_subrev_u32 v6, 16384, v6
    v_perm_b32 v144, v81, v80, v11
    v_perm_b32 v148, v81, v80, v12
    v_mfma_f32_16x16x32_bf16 v[168:171], v[128:131], v[100:103], v[168:171]
    v_add_u32 v7, 16384, v7
    ds_read_b128 v[68:71], v7 offset:49152
    v_subrev_u32 v7, 16384, v7
    v_perm_b32 v145, v83, v82, v11
    v_perm_b32 v149, v83, v82, v12
    v_mfma_f32_16x16x32_bf16 v[176:179], v[132:135], v[104:107], v[176:179]
    v_add_u32 v8, 16384, v8
    ds_read_b128 v[72:75], v8 offset:49152
    v_subrev_u32 v8, 16384, v8
    v_perm_b32 v146, v85, v84, v11
    v_perm_b32 v150, v85, v84, v12
    v_mfma_f32_16x16x32_bf16 v[184:187], v[132:135], v[108:111], v[184:187]
    v_add_u32 v9, 16384, v9
    ds_read_b128 v[76:79], v9 offset:49152
    v_subrev_u32 v9, 16384, v9
    v_perm_b32 v147, v87, v86, v11
    v_perm_b32 v151, v87, v86, v12
    v_mfma_f32_16x16x32_bf16 v[164:167], v[136:139], v[96:99], v[164:167]
    ds_read_b128 v[112:115], v10 offset:12288
    v_perm_b32 v152, v89, v88, v11
    v_perm_b32 v156, v89, v88, v12
    v_mfma_f32_16x16x32_bf16 v[172:175], v[136:139], v[100:103], v[172:175]
    ds_read_b128 v[116:119], v10 offset:13312
    v_perm_b32 v153, v91, v90, v11
    v_perm_b32 v157, v91, v90, v12
    v_mfma_f32_16x16x32_bf16 v[180:183], v[140:143], v[104:107], v[180:183]
    ds_read_b128 v[120:123], v10 offset:14336
    v_perm_b32 v154, v93, v92, v11
    v_perm_b32 v158, v93, v92, v12
    v_mfma_f32_16x16x32_bf16 v[188:191], v[140:143], v[108:111], v[188:191]
    ds_read_b128 v[124:127], v10 offset:15360
    s_add_u32 m0, s59, 131072
    s_nop 0
    buffer_load_dwordx4 v2, s[12:15], s40 offen  lds
    s_add_u32 m0, s59, 132096
    s_nop 0
    buffer_load_dwordx4 v3, s[12:15], s40 offen  lds
    v_perm_b32 v155, v95, v94, v11
    v_perm_b32 v159, v95, v94, v12
    s_mul_i32 s54, s63, 642
    s_lshl_b32 s55, s62, 1
    s_add_u32 s55, s55, s54
    s_and_b32 s55, s55, -16
    s_add_u32 s54, s54, 320
    s_and_b32 s54, s54, -16
    s_sub_u32 s54, s54, s55
    s_sub_u32 s68, s54, 144
    s_mul_i32 s54, s53, 657408
    s_add_u32 s69, s55, s54
    s_lshl_b32 s54, s53, 7
    s_add_u32 s96, s55, s54
    s_waitcnt lgkmcnt(0)
    s_waitcnt vmcnt(6)
    s_barrier
    v_mfma_f32_16x16x32_bf16 v[160:163], v[144:147], v[112:115], v[160:163]
    ds_read_b128 v[80:83], v6 offset:0
    v_perm_b32 v128, v65, v64, v11
    v_perm_b32 v132, v65, v64, v12
    v_mfma_f32_16x16x32_bf16 v[168:171], v[144:147], v[116:119], v[168:171]
    ds_read_b128 v[84:87], v7 offset:0
    v_perm_b32 v129, v67, v66, v11
    v_perm_b32 v133, v67, v66, v12
    v_mfma_f32_16x16x32_bf16 v[176:179], v[148:151], v[120:123], v[176:179]
    ds_read_b128 v[88:91], v8 offset:0
    v_perm_b32 v130, v69, v68, v11
    v_perm_b32 v134, v69, v68, v12
    v_mfma_f32_16x16x32_bf16 v[184:187], v[148:151], v[124:127], v[184:187]
    ds_read_b128 v[92:95], v9 offset:0
    v_perm_b32 v131, v71, v70, v11
    v_perm_b32 v135, v71, v70, v12
    v_mfma_f32_16x16x32_bf16 v[164:167], v[152:155], v[112:115], v[164:167]
    ds_read_b128 v[96:99], v10 offset:16384
    v_perm_b32 v136, v73, v72, v11
    v_perm_b32 v140, v73, v72, v12
    v_mfma_f32_16x16x32_bf16 v[172:175], v[152:155], v[116:119], v[172:175]
    ds_read_b128 v[100:103], v10 offset:17408
    v_perm_b32 v137, v75, v74, v11
    v_perm_b32 v141, v75, v74, v12
    v_mfma_f32_16x16x32_bf16 v[180:183], v[156:159], v[120:123], v[180:183]
    ds_read_b128 v[104:107], v10 offset:18432
    v_perm_b32 v138, v77, v76, v11
    v_perm_b32 v142, v77, v76, v12
    v_mfma_f32_16x16x32_bf16 v[188:191], v[156:159], v[124:127], v[188:191]
    ds_read_b128 v[108:111], v10 offset:19456
    s_add_u32 m0, s59, 147456
    s_nop 0
    buffer_load_dwordx4 v2, s[12:15], s41 offen  lds
    s_add_u32 m0, s59, 148480
    s_nop 0
    buffer_load_dwordx4 v3, s[12:15], s41 offen  lds
    v_perm_b32 v139, v79, v78, v11
    v_perm_b32 v143, v79, v78, v12
    s_cmp_lt_i32 s63, 0
    s_cselect_b32 s97, 1314816, 0
    s_cmp_eq_u32 s53, 0
    s_cselect_b32 s70, s97, 0
    s_mul_i32 s71, s52, 10240
    s_mul_i32 s54, s53, 5120
    s_add_u32 s71, s71, s54
    s_mov_b32 s67, 20544
    v_mov_b32 v56, s96
    v_mad_u32_u24 v56, v1, s67, v56
    v_add_u32 v57, s97, v56
    v_cmp_eq_u32 vcc, 0, v1
    s_nop 1
    v_cndmask_b32 v56, v56, v57, vcc
    s_waitcnt lgkmcnt(0)
    s_waitcnt vmcnt(6)
    s_barrier
    v_mfma_f32_16x16x32_bf16 v[160:163], v[128:131], v[96:99], v[160:163]
    ds_read_b128 v[64:67], v6 offset:16384
    v_perm_b32 v144, v81, v80, v11
    v_perm_b32 v148, v81, v80, v12
    v_mfma_f32_16x16x32_bf16 v[168:171], v[128:131], v[100:103], v[168:171]
    ds_read_b128 v[68:71], v7 offset:16384
    v_perm_b32 v145, v83, v82, v11
    v_perm_b32 v149, v83, v82, v12
    v_mfma_f32_16x16x32_bf16 v[176:179], v[132:135], v[104:107], v[176:179]
    ds_read_b128 v[72:75], v8 offset:16384
    v_perm_b32 v146, v85, v84, v11
    v_perm_b32 v150, v85, v84, v12
    v_mfma_f32_16x16x32_bf16 v[184:187], v[132:135], v[108:111], v[184:187]
    ds_read_b128 v[76:79], v9 offset:16384
    v_perm_b32 v147, v87, v86, v11
    v_perm_b32 v151, v87, v86, v12
    v_mfma_f32_16x16x32_bf16 v[164:167], v[136:139], v[96:99], v[164:167]
    ds_read_b128 v[112:115], v10 offset:20480
    v_perm_b32 v152, v89, v88, v11
    v_perm_b32 v156, v89, v88, v12
    v_mfma_f32_16x16x32_bf16 v[172:175], v[136:139], v[100:103], v[172:175]
    ds_read_b128 v[116:119], v10 offset:21504
    v_perm_b32 v153, v91, v90, v11
    v_perm_b32 v157, v91, v90, v12
    v_mfma_f32_16x16x32_bf16 v[180:183], v[140:143], v[104:107], v[180:183]
    ds_read_b128 v[120:123], v10 offset:22528
    v_perm_b32 v154, v93, v92, v11
    v_perm_b32 v158, v93, v92, v12
    v_mfma_f32_16x16x32_bf16 v[188:191], v[140:143], v[108:111], v[188:191]
    ds_read_b128 v[124:127], v10 offset:23552
    v_mov_b32 v5, 0
    global_load_dword v4, v5, s[100:101] sc1
    v_perm_b32 v155, v95, v94, v11
    v_perm_b32 v159, v95, v94, v12
    s_waitcnt lgkmcnt(0)
    s_waitcnt vmcnt(5)
    s_barrier
    v_mfma_f32_16x16x32_bf16 v[160:163], v[144:147], v[112:115], v[160:163]
    ds_read_b128 v[80:83], v6 offset:32768
    v_perm_b32 v128, v65, v64, v11
    v_perm_b32 v132, v65, v64, v12
    v_mfma_f32_16x16x32_bf16 v[168:171], v[144:147], v[116:119], v[168:171]
    ds_read_b128 v[84:87], v7 offset:32768
    v_perm_b32 v129, v67, v66, v11
    v_perm_b32 v133, v67, v66, v12
    v_mfma_f32_16x16x32_bf16 v[176:179], v[148:151], v[120:123], v[176:179]
    ds_read_b128 v[88:91], v8 offset:32768
    v_perm_b32 v130, v69, v68, v11
    v_perm_b32 v134, v69, v68, v12
    v_mfma_f32_16x16x32_bf16 v[184:187], v[148:151], v[124:127], v[184:187]
    ds_read_b128 v[92:95], v9 offset:32768
    v_perm_b32 v131, v71, v70, v11
    v_perm_b32 v135, v71, v70, v12
    v_mfma_f32_16x16x32_bf16 v[164:167], v[152:155], v[112:115], v[164:167]
    ds_read_b128 v[96:99], v10 offset:24576
    v_perm_b32 v136, v73, v72, v11
    v_perm_b32 v140, v73, v72, v12
    v_mfma_f32_16x16x32_bf16 v[172:175], v[152:155], v[116:119], v[172:175]
    ds_read_b128 v[100:103], v10 offset:25600
    v_perm_b32 v137, v75, v74, v11
    v_perm_b32 v141, v75, v74, v12
    v_mfma_f32_16x16x32_bf16 v[180:183], v[156:159], v[120:123], v[180:183]
    ds_read_b128 v[104:107], v10 offset:26624
    v_perm_b32 v138, v77, v76, v11
    v_perm_b32 v142, v77, v76, v12
    v_mfma_f32_16x16x32_bf16 v[188:191], v[156:159], v[124:127], v[188:191]
    ds_read_b128 v[108:111], v10 offset:27648
    buffer_load_dwordx4 v[20:23], v16, s[24:27], 0 offen sc1
    buffer_load_dword v0, v56, s[16:19], 0 offen
    v_perm_b32 v139, v79, v78, v11
    v_perm_b32 v143, v79, v78, v12
    s_waitcnt lgkmcnt(0)
    s_waitcnt vmcnt(5)
    s_barrier
    v_mfma_f32_16x16x32_bf16 v[160:163], v[128:131], v[96:99], v[160:163]
    ds_read_b128 v[64:67], v6 offset:49152
    v_perm_b32 v144, v81, v80, v11
    v_perm_b32 v148, v81, v80, v12
    v_mfma_f32_16x16x32_bf16 v[168:171], v[128:131], v[100:103], v[168:171]
    ds_read_b128 v[68:71], v7 offset:49152
    v_perm_b32 v145, v83, v82, v11
    v_perm_b32 v149, v83, v82, v12
    v_mfma_f32_16x16x32_bf16 v[176:179], v[132:135], v[104:107], v[176:179]
    ds_read_b128 v[72:75], v8 offset:49152
    v_perm_b32 v146, v85, v84, v11
    v_perm_b32 v150, v85, v84, v12
    v_mfma_f32_16x16x32_bf16 v[184:187], v[132:135], v[108:111], v[184:187]
    ds_read_b128 v[76:79], v9 offset:49152
    v_perm_b32 v147, v87, v86, v11
    v_perm_b32 v151, v87, v86, v12
    v_mfma_f32_16x16x32_bf16 v[164:167], v[136:139], v[96:99], v[164:167]
    ds_read_b128 v[112:115], v10 offset:28672
    v_perm_b32 v152, v89, v88, v11
    v_perm_b32 v156, v89, v88, v12
    v_mfma_f32_16x16x32_bf16 v[172:175], v[136:139], v[100:103], v[172:175]
    ds_read_b128 v[116:119], v10 offset:29696
    v_perm_b32 v153, v91, v90, v11
    v_perm_b32 v157, v91, v90, v12
    v_mfma_f32_16x16x32_bf16 v[180:183], v[140:143], v[104:107], v[180:183]
    ds_read_b128 v[120:123], v10 offset:30720
    v_perm_b32 v154, v93, v92, v11
    v_perm_b32 v158, v93, v92, v12
    v_mfma_f32_16x16x32_bf16 v[188:191], v[140:143], v[108:111], v[188:191]
    ds_read_b128 v[124:127], v10 offset:31744
    v_perm_b32 v155, v95, v94, v11
    v_perm_b32 v159, v95, v94, v12
    s_waitcnt lgkmcnt(0)
    s_waitcnt vmcnt(3)
    s_barrier
    v_mfma_f32_16x16x32_bf16 v[160:163], v[144:147], v[112:115], v[160:163]
    v_add_u32 v6, 16384, v6
    ds_read_b128 v[80:83], v6 offset:49152
    v_subrev_u32 v6, 16384, v6
    v_perm_b32 v128, v65, v64, v11
    v_perm_b32 v132, v65, v64, v12
    v_mfma_f32_16x16x32_bf16 v[168:171], v[144:147], v[116:119], v[168:171]
    v_add_u32 v7, 16384, v7
    ds_read_b128 v[84:87], v7 offset:49152
    v_subrev_u32 v7, 16384, v7
    v_perm_b32 v129, v67, v66, v11
    v_perm_b32 v133, v67, v66, v12
    v_mfma_f32_16x16x32_bf16 v[176:179], v[148:151], v[120:123], v[176:179]
    v_add_u32 v8, 16384, v8
    ds_read_b128 v[88:91], v8 offset:49152
    v_subrev_u32 v8, 16384, v8
    v_perm_b32 v130, v69, v68, v11
    v_perm_b32 v134, v69, v68, v12
    v_mfma_f32_16x16x32_bf16 v[184:187], v[148:151], v[124:127], v[184:187]
    v_add_u32 v9, 16384, v9
    ds_read_b128 v[92:95], v9 offset:49152
    v_subrev_u32 v9, 16384, v9
    v_perm_b32 v131, v71, v70, v11
    v_perm_b32 v135, v71, v70, v12
    v_mfma_f32_16x16x32_bf16 v[164:167], v[152:155], v[112:115], v[164:167]
    ds_read_b128 v[96:99], v10 offset:32768
    v_perm_b32 v136, v73, v72, v11
    v_perm_b32 v140, v73, v72, v12
    v_mfma_f32_16x16x32_bf16 v[172:175], v[152:155], v[116:119], v[172:175]
    ds_read_b128 v[100:103], v10 offset:33792
    v_perm_b32 v137, v75, v74, v11
    v_perm_b32 v141, v75, v74, v12
    v_mfma_f32_16x16x32_bf16 v[180:183], v[156:159], v[120:123], v[180:183]
    ds_read_b128 v[104:107], v10 offset:34816
    v_perm_b32 v138, v77, v76, v11
    v_perm_b32 v142, v77, v76, v12
    v_mfma_f32_16x16x32_bf16 v[188:191], v[156:159], v[124:127], v[188:191]
    ds_read_b128 v[108:111], v10 offset:35840
    v_perm_b32 v139, v79, v78, v11
    v_perm_b32 v143, v79, v78, v12
    s_waitcnt lgkmcnt(0)
    v_mfma_f32_16x16x32_bf16 v[160:163], v[128:131], v[96:99], v[160:163]
    ds_read_b128 v[112:115], v10 offset:36864
    v_perm_b32 v144, v81, v80, v11
    v_perm_b32 v148, v81, v80, v12
    v_mfma_f32_16x16x32_bf16 v[168:171], v[128:131], v[100:103], v[168:171]
    ds_read_b128 v[116:119], v10 offset:37888
    v_perm_b32 v145, v83, v82, v11
    v_perm_b32 v149, v83, v82, v12
    v_mfma_f32_16x16x32_bf16 v[176:179], v[132:135], v[104:107], v[176:179]
    ds_read_b128 v[120:123], v10 offset:38912
    v_perm_b32 v146, v85, v84, v11
    v_perm_b32 v150, v85, v84, v12
    v_mfma_f32_16x16x32_bf16 v[184:187], v[132:135], v[108:111], v[184:187]
    ds_read_b128 v[124:127], v10 offset:39936
    v_perm_b32 v147, v87, v86, v11
    v_perm_b32 v151, v87, v86, v12
    v_mfma_f32_16x16x32_bf16 v[164:167], v[136:139], v[96:99], v[164:167]
    v_perm_b32 v152, v89, v88, v11
    v_perm_b32 v156, v89, v88, v12
    v_mfma_f32_16x16x32_bf16 v[172:175], v[136:139], v[100:103], v[172:175]
    v_perm_b32 v153, v91, v90, v11
    v_perm_b32 v157, v91, v90, v12
    v_mfma_f32_16x16x32_bf16 v[180:183], v[140:143], v[104:107], v[180:183]
    v_perm_b32 v154, v93, v92, v11
    v_perm_b32 v158, v93, v92, v12
    v_mfma_f32_16x16x32_bf16 v[188:191], v[140:143], v[108:111], v[188:191]
    v_perm_b32 v155, v95, v94, v11
    v_perm_b32 v159, v95, v94, v12
    s_lshl_b32 s54, s28, 11
    s_add_u32 s54, s54, 131072
    v_lshl_add_u32 v18, v1, 4, s54
    ds_write_b128 v18, v[40:43]
    ds_write_b128 v18, v[44:47] offset:1024
    v_xor_b32 v18, 8192, v18
    s_lshl_b32 s54, s28, 7
    s_add_u32 s54, s54, 122880
    v_and_b32 v17, 31, v1
    v_lshl_add_u32 v17, v17, 2, s54
    v_lshrrev_b32 v19, 4, v1
    v_lshl_add_u32 v19, v19, 4, s54
    s_waitcnt vmcnt(2)
    s_mov_b32 s57, 0
Ltag_8:
    v_readfirstlane_b32 s3, v4
    s_add_u32 s57, s57, 1
    s_cmp_lg_u32 s3, 0
    s_cbranch_scc1 Ltag_8d
    s_cmp_ge_u32 s57, 40000
    s_cbranch_scc1 Ltag_8d
    s_sleep 2
    global_load_dword v4, v5, s[100:101] sc1
    s_waitcnt vmcnt(0)
    s_branch Ltag_8
Ltag_8d:
    s_and_b32 s3, s3, -8
    s_waitcnt lgkmcnt(0)
    s_barrier
    ds_read_b128 v[48:51], v18
    ds_read_b128 v[52:55], v18 offset:1024
    s_waitcnt vmcnt(1)
    s_mov_b32 s56, 0
    s_or_b32 s57, s3, 7
Lrec_9:
    v_cmp_ne_u32 vcc, s57, v23
    s_add_u32 s56, s56, 1
    s_cbranch_vccz Lrec_9d
    s_cmp_ge_u32 s56, 40000
    s_cbranch_scc1 Lrec_9d
    s_sleep 2
    buffer_load_dwordx4 v[20:23], v16, s[24:27], 0 offen sc1
    s_waitcnt vmcnt(0)
    s_branch Lrec_9
Lrec_9d:
    ds_write_b32 v17, v22
    ds_read_b128 v[24:27], v19
    ds_read_b128 v[28:31], v19 offset:64
    v_mfma_f32_16x16x32_bf16 v[160:163], v[144:147], v[112:115], v[160:163]
    v_mfma_f32_16x16x32_bf16 v[168:171], v[144:147], v[116:119], v[168:171]
    v_mfma_f32_16x16x32_bf16 v[176:179], v[148:151], v[120:123], v[176:179]
    v_mfma_f32_16x16x32_bf16 v[184:187], v[148:151], v[124:127], v[184:187]
    v_mfma_f32_16x16x32_bf16 v[164:167], v[152:155], v[112:115], v[164:167]
    v_mfma_f32_16x16x32_bf16 v[172:175], v[152:155], v[116:119], v[172:175]
    v_mfma_f32_16x16x32_bf16 v[180:183], v[156:159], v[120:123], v[180:183]
    v_mfma_f32_16x16x32_bf16 v[188:191], v[156:159], v[124:127], v[188:191]
    s_setprio 1
    s_waitcnt lgkmcnt(3)
    v_xor_b32 v56, 0x80008000, v44
    v_xor_b32 v57, 0x80008000, v45
    v_xor_b32 v58, 0x80008000, v46
    v_xor_b32 v59, 0x80008000, v47
    v_xor_b32 v60, 0x80008000, v52
    v_xor_b32 v61, 0x80008000, v53
    v_xor_b32 v62, 0x80008000, v54
    v_xor_b32 v63, 0x80008000, v55
    s_lshl_b32 s54, s28, 12
    v_lshrrev_b32 v14, 4, v1
    v_lshlrev_b32 v14, 8, v14
    v_and_b32 v15, 15, v1
    v_lshl_add_u32 v14, v15, 2, v14
    s_lshl_b32 s55, s53, 10
    s_add_u32 s55, s55, s54
    s_bfe_u32 s56, s60, 0x10001
    s_lshl_b32 s56, s56, 6
    s_add_u32 s55, s55, s56
    v_add_u32 v10, s55, v14
    v_xor_b32 v11, 1024, v10
    v_xor_b32 v12, 64, v10
    v_xor_b32 v13, 1088, v10
    v_lshl_add_u32 v15, v1, 4, s54
    v_lshrrev_b32 v16, 3, v1
    v_mul_u32_u24 v16, 166016, v16
    v_and_b32 v17, 7, v1
    v_lshl_add_u32 v16, v17, 4, v16
    s_lshl_b32 s54, s58, 14
    s_lshl_b32 s55, s60, 7
    s_add_u32 s54, s54, s55
    s_add_u32 s54, s54, 8388608
    s_waitcnt lgkmcnt(0)
    v_mul_f32 v20, v176, v24
    v_mul_f32 v21, v184, v24
    v_fma_f32 v184, -v160, v24, v20
    v_fma_f32 v160, v160, v24, v20
    v_fma_f32 v176, -v168, v24, v21
    v_fma_f32 v168, v168, v24, v21
    v_mul_f32 v20, v177, v25
    v_mul_f32 v21, v185, v25
    v_fma_f32 v185, -v161, v25, v20
    v_fma_f32 v161, v161, v25, v20
    v_fma_f32 v177, -v169, v25, v21
    v_fma_f32 v169, v169, v25, v21
    v_mul_f32 v20, v178, v26
    v_mul_f32 v21, v186, v26
    v_fma_f32 v186, -v162, v26, v20
    v_fma_f32 v162, v162, v26, v20
    v_fma_f32 v178, -v170, v26, v21
    v_fma_f32 v170, v170, v26, v21
    v_mul_f32 v20, v179, v27
    v_mul_f32 v21, v187, v27
    v_fma_f32 v187, -v163, v27, v20
    v_fma_f32 v163, v163, v27, v20
    v_fma_f32 v179, -v171, v27, v21
    v_fma_f32 v171, v171, v27, v21
    v_mul_f32 v20, v180, v28
    v_mul_f32 v21, v188, v28
    v_fma_f32 v188, -v164, v28, v20
    v_fma_f32 v164, v164, v28, v20
    v_fma_f32 v180, -v172, v28, v21
    v_fma_f32 v172, v172, v28, v21
    v_mul_f32 v20, v181, v29
    v_mul_f32 v21, v189, v29
    v_fma_f32 v189, -v165, v29, v20
    v_fma_f32 v165, v165, v29, v20
    v_fma_f32 v181, -v173, v29, v21
    v_fma_f32 v173, v173, v29, v21
    v_mul_f32 v20, v182, v30
    v_mul_f32 v21, v190, v30
    v_fma_f32 v190, -v166, v30, v20
    v_fma_f32 v166, v166, v30, v20
    v_fma_f32 v182, -v174, v30, v21
    v_fma_f32 v174, v174, v30, v21
    v_mul_f32 v20, v183, v31
    v_mul_f32 v21, v191, v31
    v_fma_f32 v191, -v167, v31, v20
    v_fma_f32 v167, v167, v31, v20
    v_fma_f32 v183, -v175, v31, v21
    v_fma_f32 v175, v175, v31, v21
    s_cmp_lg_u32 s58, 0
    s_cbranch_scc1 L_dnsp
    v_cndmask_b32 v160, v160, v176, s[74:75]
    v_cndmask_b32 v176, v176, 0, s[74:75]
    v_cndmask_b32 v161, v161, v177, s[74:75]
    v_cndmask_b32 v177, v177, 0, s[74:75]
    v_cndmask_b32 v162, v162, v178, s[74:75]
    v_cndmask_b32 v178, v178, 0, s[74:75]
    v_cndmask_b32 v163, v163, v179, s[74:75]
    v_cndmask_b32 v179, v179, 0, s[74:75]
    v_cndmask_b32 v164, v164, v180, s[74:75]
    v_cndmask_b32 v180, v180, 0, s[74:75]
    v_cndmask_b32 v165, v165, v181, s[74:75]
    v_cndmask_b32 v181, v181, 0, s[74:75]
    v_cndmask_b32 v166, v166, v182, s[74:75]
    v_cndmask_b32 v182, v182, 0, s[74:75]
    v_cndmask_b32 v167, v167, v183, s[74:75]
    v_cndmask_b32 v183, v183, 0, s[74:75]
L_dnsp:
    v_cvt_pk_bf16_f32 v64, v160, v161
    v_cvt_pk_bf16_f32 v65, v162, v163
    v_cvt_pk_bf16_f32 v66, v164, v165
    v_cvt_pk_bf16_f32 v67, v166, v167
    v_cvt_pk_bf16_f32 v68, v168, v169
    v_cvt_pk_bf16_f32 v69, v170, v171
    v_cvt_pk_bf16_f32 v70, v172, v173
    v_cvt_pk_bf16_f32 v71, v174, v175
    v_mfma_f32_16x16x32_bf16 v[80:83], v[40:43], v[64:67], 0
    v_mfma_f32_16x16x32_bf16 v[88:91], v[44:47], v[64:67], 0
    v_mfma_f32_16x16x32_bf16 v[84:87], v[48:51], v[64:67], 0
    v_mfma_f32_16x16x32_bf16 v[92:95], v[52:55], v[64:67], 0
    v_mfma_f32_16x16x32_bf16 v[80:83], v[56:59], v[68:71], v[80:83]
    v_mfma_f32_16x16x32_bf16 v[88:91], v[40:43], v[68:71], v[88:91]
    v_mfma_f32_16x16x32_bf16 v[84:87], v[60:63], v[68:71], v[84:87]
    v_mfma_f32_16x16x32_bf16 v[92:95], v[48:51], v[68:71], v[92:95]
    v_cvt_pk_bf16_f32 v72, v176, v177
    v_cvt_pk_bf16_f32 v73, v178, v179
    v_cvt_pk_bf16_f32 v74, v180, v181
    v_cvt_pk_bf16_f32 v75, v182, v183
    v_cvt_pk_bf16_f32 v76, v184, v185
    v_cvt_pk_bf16_f32 v77, v186, v187
    v_cvt_pk_bf16_f32 v78, v188, v189
    v_cvt_pk_bf16_f32 v79, v190, v191
    v_mfma_f32_16x16x32_bf16 v[96:99], v[40:43], v[72:75], 0
    v_mfma_f32_16x16x32_bf16 v[104:107], v[44:47], v[72:75], 0
    v_mfma_f32_16x16x32_bf16 v[100:103], v[48:51], v[72:75], 0
    v_mfma_f32_16x16x32_bf16 v[108:111], v[52:55], v[72:75], 0
    v_mfma_f32_16x16x32_bf16 v[96:99], v[56:59], v[76:79], v[96:99]
    v_mfma_f32_16x16x32_bf16 v[104:107], v[40:43], v[76:79], v[104:107]
    v_mfma_f32_16x16x32_bf16 v[100:103], v[60:63], v[76:79], v[100:103]
    v_mfma_f32_16x16x32_bf16 v[108:111], v[48:51], v[76:79], v[108:111]
    v_cvt_pk_bf16_f32 v80, v80, v81
    v_cvt_pk_bf16_f32 v81, v82, v83
    ds_write_b32 v10, v80 offset:0
    ds_write_b32 v10, v81 offset:128
    v_cvt_pk_bf16_f32 v84, v84, v85
    v_cvt_pk_bf16_f32 v85, v86, v87
    ds_write_b32 v11, v84 offset:0
    ds_write_b32 v11, v85 offset:128
    v_cvt_pk_bf16_f32 v88, v88, v89
    v_cvt_pk_bf16_f32 v89, v90, v91
    ds_write_b32 v12, v88 offset:0
    ds_write_b32 v12, v89 offset:128
    v_cvt_pk_bf16_f32 v92, v92, v93
    v_cvt_pk_bf16_f32 v93, v94, v95
    ds_write_b32 v13, v92 offset:0
    ds_write_b32 v13, v93 offset:128
    ds_read_b128 v[128:131], v15 offset:0
    ds_read_b128 v[132:135], v15 offset:1024
    v_cvt_pk_bf16_f32 v96, v96, v97
    v_cvt_pk_bf16_f32 v97, v98, v99
    ds_write_b32 v10, v96 offset:2048
    ds_write_b32 v10, v97 offset:2176
    v_cvt_pk_bf16_f32 v100, v100, v101
    v_cvt_pk_bf16_f32 v101, v102, v103
    ds_write_b32 v11, v100 offset:2048
    ds_write_b32 v11, v101 offset:2176
    v_cvt_pk_bf16_f32 v104, v104, v105
    v_cvt_pk_bf16_f32 v105, v106, v107
    ds_write_b32 v12, v104 offset:2048
    ds_write_b32 v12, v105 offset:2176
    v_cvt_pk_bf16_f32 v108, v108, v109
    v_cvt_pk_bf16_f32 v109, v110, v111
    ds_write_b32 v13, v108 offset:2048
    ds_write_b32 v13, v109 offset:2176
    ds_read_b128 v[136:139], v15 offset:2048
    ds_read_b128 v[140:143], v15 offset:3072
    s_waitcnt lgkmcnt(11)
    s_add_u32 s55, s54, 0
    buffer_store_dwordx4 v[128:131], v16, s[24:27], s55 offen sc1
    s_waitcnt lgkmcnt(10)
    s_add_u32 s55, s54, 1328128
    buffer_store_dwordx4 v[132:135], v16, s[24:27], s55 offen sc1
    s_waitcnt lgkmcnt(1)
    s_add_u32 s55, s54, 8192
    buffer_store_dwordx4 v[136:139], v16, s[24:27], s55 offen sc1
    s_waitcnt lgkmcnt(0)
    s_add_u32 s55, s54, 1336320
    buffer_store_dwordx4 v[140:143], v16, s[24:27], s55 offen sc1
    s_setprio 0
    s_lshl_b32 s58, s30, 4
    s_add_u32 s58, s58, s29
    s_lshl_b32 s58, s58, 7
    s_add_u32 s58, s58, 28315648
    v_and_b32 v6, 31, v1
    s_lshl_b32 s54, s53, 5
    v_add_u32 v7, s54, v6
    v_cvt_f32_u32 v7, v7
    v_mul_f32 v7, 0x3c800000, v7
    v_lshrrev_b32 v8, 5, v1
    v_lshl_add_u32 v8, v8, 2, s54
    v_cvt_f32_u32 v8, v8
    v_mul_f32 v8, v8, v7
    v_and_b32 v6, 1, v6
    v_mov_b32 v9, 0x80008000
    v_cmp_eq_u32 vcc, 1, v6
    s_nop 1
    v_cndmask_b32 v9, 0, v9, vcc
    v_mov_b32 v128, v8
    v_fmamk_f32 v129, v7, 0x3f800000, v8
    v_fmamk_f32 v130, v7, 0x40000000, v8
    v_fmamk_f32 v131, v7, 0x40400000, v8
    v_fmamk_f32 v132, v7, 0x41000000, v8
    v_fmamk_f32 v133, v7, 0x41100000, v8
    v_fmamk_f32 v134, v7, 0x41200000, v8
    v_fmamk_f32 v135, v7, 0x41300000, v8
    v_sin_f32 v136, v128
    v_cos_f32 v128, v128
    v_sin_f32 v137, v129
    v_cos_f32 v129, v129
    v_sin_f32 v138, v130
    v_cos_f32 v130, v130
    v_sin_f32 v139, v131
    v_cos_f32 v131, v131
    v_sin_f32 v140, v132
    v_cos_f32 v132, v132
    v_sin_f32 v141, v133
    v_cos_f32 v133, v133
    v_sin_f32 v142, v134
    v_cos_f32 v134, v134
    v_sin_f32 v143, v135
    v_cos_f32 v135, v135
    v_cvt_pk_bf16_f32 v16, v128, v129
    v_cvt_pk_bf16_f32 v32, v136, v137
    v_cvt_pk_bf16_f32 v17, v130, v131
    v_cvt_pk_bf16_f32 v33, v138, v139
    v_cvt_pk_bf16_f32 v18, v132, v133
    v_cvt_pk_bf16_f32 v34, v140, v141
    v_cvt_pk_bf16_f32 v19, v134, v135
    v_cvt_pk_bf16_f32 v35, v142, v143
    v_fmamk_f32 v128, v7, 0x41800000, v8
    v_fmamk_f32 v129, v7, 0x41880000, v8
    v_fmamk_f32 v130, v7, 0x41900000, v8
    v_fmamk_f32 v131, v7, 0x41980000, v8
    v_fmamk_f32 v132, v7, 0x41c00000, v8
    v_fmamk_f32 v133, v7, 0x41c80000, v8
    v_fmamk_f32 v134, v7, 0x41d00000, v8
    v_fmamk_f32 v135, v7, 0x41d80000, v8
    v_sin_f32 v136, v128
    v_cos_f32 v128, v128
    v_sin_f32 v137, v129
    v_cos_f32 v129, v129
    v_sin_f32 v138, v130
    v_cos_f32 v130, v130
    v_sin_f32 v139, v131
    v_cos_f32 v131, v131
    v_sin_f32 v140, v132
    v_cos_f32 v132, v132
    v_sin_f32 v141, v133
    v_cos_f32 v133, v133
    v_sin_f32 v142, v134
    v_cos_f32 v134, v134
    v_sin_f32 v143, v135
    v_cos_f32 v135, v135
    v_cvt_pk_bf16_f32 v20, v128, v129
    v_cvt_pk_bf16_f32 v36, v136, v137
    v_cvt_pk_bf16_f32 v21, v130, v131
    v_cvt_pk_bf16_f32 v37, v138, v139
    v_cvt_pk_bf16_f32 v22, v132, v133
    v_cvt_pk_bf16_f32 v38, v140, v141
    v_cvt_pk_bf16_f32 v23, v134, v135
    v_cvt_pk_bf16_f32 v39, v142, v143
    v_xor_b32 v24, v9, v16
    v_xor_b32 v25, v9, v17
    v_xor_b32 v26, v9, v18
    v_xor_b32 v27, v9, v19
    v_xor_b32 v28, v9, v20
    v_xor_b32 v29, v9, v21
    v_xor_b32 v30, v9, v22
    v_xor_b32 v31, v9, v23
    v_xor_b32 v40, v9, v32
    v_xor_b32 v41, v9, v33
    v_xor_b32 v42, v9, v34
    v_xor_b32 v43, v9, v35
    v_xor_b32 v44, v9, v36
    v_xor_b32 v45, v9, v37
    v_xor_b32 v46, v9, v38
    v_xor_b32 v47, v9, v39
    s_lshl_b32 s55, s52, 13
    s_lshl_b32 s56, s53, 12
    v_lshrrev_b32 v6, 5, v1
    v_bfe_u32 v7, v1, 2, 2
    v_lshl_add_u32 v7, v6, 2, v7
    v_lshlrev_b32 v7, 7, v7
    v_bfe_u32 v8, v1, 3, 2
    v_lshrrev_b32 v9, 1, v8
    v_and_b32 v8, 1, v8
    v_lshl_add_u32 v7, v8, 6, v7
    v_lshl_add_u32 v7, v9, 5, v7
    v_and_b32 v8, 3, v1
    v_lshl_add_u32 v7, v8, 3, v7
    v_add_u32 v7, s55, v7
    v_add_u32 v2, s56, v7
    v_xor_b32 v3, 4096, v2
    v_xor_b32 v4, 64, v2
    v_xor_b32 v5, 4160, v2
    s_lshr_b32 s36, s29, 1
    s_and_b32 s36, s36, 2
    s_lshl_b32 s56, s53, 12
    s_add_u32 s55, s55, s56
    v_and_b32 v7, 7, v1
    v_xor_b32 v7, v7, v6
    v_xor_b32 v7, s36, v7
    v_and_b32 v8, 31, v1
    v_lshlrev_b32 v8, 7, v8
    v_lshl_add_u32 v50, v7, 4, v8
    v_add_u32 v50, s55, v50
    v_xor_b32 v51, 32, v50
    v_xor_b32 v52, 64, v50
    v_xor_b32 v53, 96, v50
    v_lshrrev_b32 v7, 3, v1
    v_and_b32 v8, 7, v1
    v_xor_b32 v54, v7, v8
    v_lshlrev_b32 v54, 4, v54
    v_lshl_add_u32 v54, v7, 7, v54
    v_add_u32 v54, s55, v54
    v_mul_u32_u24 v55, 41344, v7
    v_lshl_add_u32 v55, v8, 4, v55
    v_lshlrev_b32 v56, 4, v1
    s_lshl_b32 s54, s28, 12
    s_add_u32 s54, s54, 32768
    v_add_u32 v57, s54, v56
    v_xor_b32 v58, 16384, v57
    v_lshlrev_b32 v59, 7, v1
    s_and_b32 s54, s30, 1
    s_lshl_b32 s54, s54, 12
    s_cmp_eq_u32 s30, 4
    s_cselect_b32 s54, 8192, s54
    s_cselect_b32 s34, 0xffff, -1
    s_mov_b32 s35, 0
    s_add_u32 s33, s54, 28315648
    s_mov_b32 s32, s55
    s_getpc_b64 s[96:97]
Lot_10:
    s_lshr_b32 s54, s2, 5
    s_lshl_b32 s55, s29, 1
    s_add_u32 s54, s54, s55
    s_and_b32 s54, s54, 7
    s_lshl_b32 s54, s54, 1
    s_and_b32 s55, s2, 1
    s_add_u32 s54, s54, s55
    s_lshl_b32 s54, s54, 5
    s_add_u32 s54, s54, ORDER_TAB - Lot_10
    s_add_u32 s96, s96, s54
    s_addc_u32 s97, s97, 0
    s_load_dwordx4 s[44:47], s[96:97], 0
    s_load_dwordx2 s[48:49], s[96:97], 16
    s_and_b32 s55, s2, 1
    s_mul_i32 s98, s55, 640
    s_lshl_b32 s54, s29, 2
    s_add_u32 s54, s54, s52
    s_lshl_b32 s55, s54, 11
    s_add_u32 s98, s98, s55
    s_add_u32 s99, s98, 28573696
    s_add_u32 s98, s98, 28442624
    s_mul_i32 s54, s54, 110592
    v_lshlrev_b32 v245, 4, v1
    v_add_u32 v240, s54, v245
    s_lshr_b32 s54, s2, 5
    s_mul_i32 s54, s54, 276480
    s_add_u32 s54, s54, 20971520
    v_add_u32 v245, s54, v245
    s_add_u32 s54, s52, 0
    s_mul_i32 s55, s54, 52
    s_lshr_b32 s55, s55, 8
    s_mul_i32 s55, s55, 5
    s_sub_u32 s55, s54, s55
    s_lshl_b32 s55, s55, 10
    v_add_u32 v241, s55, v245
    s_add_u32 s54, s52, 4
    s_mul_i32 s55, s54, 52
    s_lshr_b32 s55, s55, 8
    s_mul_i32 s55, s55, 5
    s_sub_u32 s55, s54, s55
    s_lshl_b32 s55, s55, 10
    v_add_u32 v242, s55, v245
    s_add_u32 s54, s52, 8
    s_mul_i32 s55, s54, 52
    s_lshr_b32 s55, s55, 8
    s_mul_i32 s55, s55, 5
    s_sub_u32 s55, s54, s55
    s_lshl_b32 s55, s55, 10
    v_add_u32 v243, s55, v245
    s_add_u32 s54, s52, 12
    s_mul_i32 s55, s54, 52
    s_lshr_b32 s55, s55, 8
    s_mul_i32 s55, s55, 5
    s_sub_u32 s55, s54, s55
    s_lshl_b32 s55, s55, 10
    s_cmp_eq_u32 s54, 15
    s_cselect_b32 s55, 2130706432, s55
    v_add_u32 v244, s55, v245
    s_mul_i32 s97, s52, 6144
    s_lshl_b32 s7, s52, 10
    s_add_u32 s6, s7, 12288
    s_cmp_eq_u32 s52, 3
    s_cselect_b32 s6, 39936, s6
    s_add_u32 s8, s24, s98
    s_addc_u32 s9, s25, 0
    s_waitcnt vmcnt(0)
    s_barrier
    s_cmp_lg_u32 s28, 4
    s_cbranch_scc1 L_dnp
    s_or_b32 s57, s3, 5
    v_mov_b32 v61, s57
    v_mov_b32 v62, 0
    s_mov_b64 exec, 1
    buffer_store_dword v61, v62, s[24:27], s58 offen sc1
    s_mov_b64 exec, -1
L_dnp:
    v_add_u32 v152, 0, v1
    v_mul_u32_u24 v153, 6554, v152
    v_lshrrev_b32 v153, 16, v153
    v_mul_u32_u24 v154, 10, v153
    v_sub_u32 v154, v152, v154
    v_cmp_eq_u32 vcc, 9, v154
    v_lshl_add_u32 v154, v154, 4, s69
    v_mad_u32_u24 v144, v153, s67, v154
    v_mov_b32 v152, s68
    v_cndmask_b32 v152, 0, v152, vcc
    v_add_u32 v144, v144, v152
    v_add_u32 v152, 64, v1
    v_mul_u32_u24 v153, 6554, v152
    v_lshrrev_b32 v153, 16, v153
    v_mul_u32_u24 v154, 10, v153
    v_sub_u32 v154, v152, v154
    v_cmp_eq_u32 vcc, 9, v154
    v_lshl_add_u32 v154, v154, 4, s69
    v_mad_u32_u24 v145, v153, s67, v154
    v_mov_b32 v152, s68
    v_cndmask_b32 v152, 0, v152, vcc
    v_add_u32 v145, v145, v152
    v_add_u32 v152, 128, v1
    v_mul_u32_u24 v153, 6554, v152
    v_lshrrev_b32 v153, 16, v153
    v_mul_u32_u24 v154, 10, v153
    v_sub_u32 v154, v152, v154
    v_cmp_eq_u32 vcc, 9, v154
    v_lshl_add_u32 v154, v154, 4, s69
    v_mad_u32_u24 v146, v153, s67, v154
    v_mov_b32 v152, s68
    v_cndmask_b32 v152, 0, v152, vcc
    v_add_u32 v146, v146, v152
    v_add_u32 v152, 192, v1
    v_mul_u32_u24 v153, 6554, v152
    v_lshrrev_b32 v153, 16, v153
    v_mul_u32_u24 v154, 10, v153
    v_sub_u32 v154, v152, v154
    v_cmp_eq_u32 vcc, 9, v154
    v_lshl_add_u32 v154, v154, 4, s69
    v_mad_u32_u24 v147, v153, s67, v154
    v_mov_b32 v152, s68
    v_cndmask_b32 v152, 0, v152, vcc
    v_add_u32 v147, v147, v152
    v_add_u32 v152, 256, v1
    v_mul_u32_u24 v153, 6554, v152
    v_lshrrev_b32 v153, 16, v153
    v_mul_u32_u24 v154, 10, v153
    v_sub_u32 v154, v152, v154
    v_cmp_eq_u32 vcc, 9, v154
    v_lshl_add_u32 v154, v154, 4, s69
    v_mad_u32_u24 v148, v153, s67, v154
    v_mov_b32 v152, s68
    v_cndmask_b32 v152, 0, v152, vcc
    v_add_u32 v148, v148, v152
    v_add_u32 v152, s70, v144
    v_cmp_gt_u32 vcc, 10, v1
    s_nop 1
    v_cndmask_b32 v144, v144, v152, vcc
    s_add_u32 m0, s71, 81920
    s_nop 0
    buffer_load_dwordx4 v144, s[16:19], 0 offen lds
    s_add_u32 m0, s71, 82944
    s_nop 0
    buffer_load_dwordx4 v145, s[16:19], 0 offen lds
    s_add_u32 m0, s71, 83968
    s_nop 0
    buffer_load_dwordx4 v146, s[16:19], 0 offen lds
    s_add_u32 m0, s71, 84992
    s_nop 0
    buffer_load_dwordx4 v147, s[16:19], 0 offen lds
    s_add_u32 m0, s71, 86016
    s_nop 0
    buffer_load_dwordx4 v148, s[16:19], 0 offen lds
    v_and_b32 v60, 1, v1
    v_bfe_u32 v61, v1, 1, 4
    s_lshl_b32 s54, s65, 4
    v_add_u32 v61, s54, v61
    v_cmp_eq_u32 vcc, 0, v61
    s_cmp_eq_u32 s64, 0
    s_cselect_b64 s[38:39], vcc, 0
    v_sub_u32 v6, 320, v61
    s_cselect_b64 vcc, -1, 0
    v_cndmask_b32 v61, v6, v61, vcc
    v_subrev_u32 v61, s62, v61
    v_lshlrev_b32 v61, 1, v61
    v_mov_b32 v6, s29
    v_mov_b32 v7, s66
    v_cmp_eq_u32 vcc, 1, v60
    s_nop 1
    v_cndmask_b32 v6, v6, v7, vcc
    v_add_u32 v7, s62, v6
    v_lshlrev_b32 v7, 1, v7
    v_and_b32 v7, 15, v7
    v_add_u32 v61, v61, v7
    v_lshlrev_b32 v6, 1, v6
    v_and_b32 v6, 15, v6
    v_add_u32 v6, 144, v6
    v_cndmask_b32 v61, v61, v6, s[38:39]
    v_mul_u32_u24 v60, 10240, v60
    v_lshrrev_b32 v6, 5, v1
    v_mul_u32_u24 v6, 640, v6
    v_add3_u32 v15, v60, v61, v6
    s_mul_i32 s54, s53, 5120
    s_add_u32 s54, s54, 81920
    v_add_u32 v15, s54, v15
    s_cmp_lg_u32 s28, 0
    s_cbranch_scc1 L_fnp
    s_mov_b64 exec, s[34:35]
    buffer_load_dword v60, v59, s[24:27], s33 offen offset:0 sc1
    s_mov_b64 exec, -1
    s_waitcnt vmcnt(0)
    s_mov_b32 s56, 0
    s_add_u32 s57, s3, 5
    s_mov_b64 exec, s[34:35]
Lpoll_11:
    v_subrev_u32 v60, s57, v60
    v_cmp_lt_u32 vcc, 2, v60
    s_add_u32 s56, s56, 1
    s_cbranch_vccz Lpoll_11d
    s_cmp_ge_u32 s56, 40000
    s_cbranch_scc1 Lpoll_11d
    s_sleep 2
    buffer_load_dword v60, v59, s[24:27], s33 offen offset:0 sc1
    s_waitcnt vmcnt(0)
    s_branch Lpoll_11
Lpoll_11d:
    s_mov_b64 exec, -1
L_fnp:
    s_mul_i32 s54, s29, 166016
    s_lshl_b32 s56, s61, 13
    s_add_u32 s54, s54, s56
    s_lshl_b32 s56, s53, 12
    s_add_u32 s54, s54, s56
    s_add_u32 s54, s54, 8388608
    s_mov_b32 m0, s32
    s_barrier
    buffer_load_dwordx4 v56, s[24:27], s54 offen offset:0 sc1 lds
    buffer_load_dwordx4 v56, s[24:27], s54 offen offset:1024 sc1 lds
    buffer_load_dwordx4 v56, s[24:27], s54 offen offset:2048 sc1 lds
    buffer_load_dwordx4 v56, s[24:27], s54 offen offset:3072 sc1 lds
    s_cmp_lg_u32 s53, 0
    s_cbranch_scc1 L_fnc
    s_setprio 1
L_fnc:
    s_waitcnt vmcnt(0)
    s_barrier
    ds_read_b64_tr_b16 v[64:65], v2 offset:0
    ds_read_b64_tr_b16 v[66:67], v2 offset:1024
    ds_read_b64_tr_b16 v[80:81], v4 offset:0
    ds_read_b64_tr_b16 v[82:83], v4 offset:1024
    ds_read_b64_tr_b16 v[68:69], v2 offset:2048
    ds_read_b64_tr_b16 v[70:71], v2 offset:3072
    ds_read_b64_tr_b16 v[84:85], v4 offset:2048
    ds_read_b64_tr_b16 v[86:87], v4 offset:3072
    ds_read_b64_tr_b16 v[72:73], v3 offset:0
    ds_read_b64_tr_b16 v[74:75], v3 offset:1024
    ds_read_b64_tr_b16 v[88:89], v5 offset:0
    ds_read_b64_tr_b16 v[90:91], v5 offset:1024
    ds_read_b64_tr_b16 v[76:77], v3 offset:2048
    ds_read_b64_tr_b16 v[78:79], v3 offset:3072
    ds_read_b64_tr_b16 v[92:93], v5 offset:2048
    ds_read_b64_tr_b16 v[94:95], v5 offset:3072
    s_waitcnt lgkmcnt(12)
    v_mfma_f32_32x32x16_bf16 v[176:191], v[16:19], v[64:67], 0
    v_xor_b32 v128, 0x80008000, v64
    v_xor_b32 v129, 0x80008000, v65
    v_xor_b32 v130, 0x80008000, v66
    v_xor_b32 v131, 0x80008000, v67
    v_mfma_f32_32x32x16_bf16 v[192:207], v[16:19], v[80:83], 0
    ds_read_u16_d16_hi v144, v15 offset:0
    ds_read_u16_d16_hi v160, v15 offset:20480
    ds_read_u16_d16_hi v145, v15 offset:160
    ds_read_u16_d16_hi v161, v15 offset:20640
    v_mfma_f32_32x32x16_bf16 v[176:191], v[32:35], v[80:83], v[176:191]
    ds_read_u16_d16_hi v146, v15 offset:320
    ds_read_u16_d16_hi v162, v15 offset:20800
    ds_read_u16_d16_hi v147, v15 offset:480
    ds_read_u16_d16_hi v163, v15 offset:20960
    v_mfma_f32_32x32x16_bf16 v[192:207], v[32:35], v[128:131], v[192:207]
    s_waitcnt lgkmcnt(15)
    v_mfma_f32_32x32x16_bf16 v[176:191], v[20:23], v[68:71], v[176:191]
    v_xor_b32 v132, 0x80008000, v68
    v_xor_b32 v133, 0x80008000, v69
    v_xor_b32 v134, 0x80008000, v70
    v_xor_b32 v135, 0x80008000, v71
    v_mfma_f32_32x32x16_bf16 v[192:207], v[20:23], v[84:87], v[192:207]
    ds_read_u16_d16_hi v148, v15 offset:1280
    ds_read_u16_d16_hi v164, v15 offset:21760
    ds_read_u16_d16_hi v149, v15 offset:1440
    ds_read_u16_d16_hi v165, v15 offset:21920
    v_mfma_f32_32x32x16_bf16 v[176:191], v[36:39], v[84:87], v[176:191]
    ds_read_u16_d16_hi v150, v15 offset:1600
    ds_read_u16_d16_hi v166, v15 offset:22080
    ds_read_u16_d16_hi v151, v15 offset:1760
    ds_read_u16_d16_hi v167, v15 offset:22240
    v_mfma_f32_32x32x16_bf16 v[192:207], v[36:39], v[132:135], v[192:207]
    s_waitcnt lgkmcnt(15)
    v_mfma_f32_32x32x16_bf16 v[176:191], v[24:27], v[72:75], v[176:191]
    v_xor_b32 v136, 0x80008000, v72
    v_xor_b32 v137, 0x80008000, v73
    v_xor_b32 v138, 0x80008000, v74
    v_xor_b32 v139, 0x80008000, v75
    v_mfma_f32_32x32x16_bf16 v[192:207], v[24:27], v[88:91], v[192:207]
    ds_read_u16_d16_hi v152, v15 offset:2560
    ds_read_u16_d16_hi v168, v15 offset:23040
    ds_read_u16_d16_hi v153, v15 offset:2720
    ds_read_u16_d16_hi v169, v15 offset:23200
    v_mfma_f32_32x32x16_bf16 v[176:191], v[40:43], v[88:91], v[176:191]
    ds_read_u16_d16_hi v154, v15 offset:2880
    ds_read_u16_d16_hi v170, v15 offset:23360
    ds_read_u16_d16_hi v155, v15 offset:3040
    ds_read_u16_d16_hi v171, v15 offset:23520
    v_mfma_f32_32x32x16_bf16 v[192:207], v[40:43], v[136:139], v[192:207]
    v_mfma_f32_32x32x16_bf16 v[176:191], v[28:31], v[76:79], v[176:191]
    v_xor_b32 v140, 0x80008000, v76
    v_xor_b32 v141, 0x80008000, v77
    v_xor_b32 v142, 0x80008000, v78
    v_xor_b32 v143, 0x80008000, v79
    v_mfma_f32_32x32x16_bf16 v[192:207], v[28:31], v[92:95], v[192:207]
    ds_read_u16_d16_hi v156, v15 offset:3840
    ds_read_u16_d16_hi v172, v15 offset:24320
    ds_read_u16_d16_hi v157, v15 offset:4000
    ds_read_u16_d16_hi v173, v15 offset:24480
    v_mfma_f32_32x32x16_bf16 v[176:191], v[44:47], v[92:95], v[176:191]
    ds_read_u16_d16_hi v158, v15 offset:4160
    ds_read_u16_d16_hi v174, v15 offset:24640
    ds_read_u16_d16_hi v159, v15 offset:4320
    ds_read_u16_d16_hi v175, v15 offset:24800
    v_mfma_f32_32x32x16_bf16 v[192:207], v[44:47], v[140:143], v[192:207]
    s_waitcnt lgkmcnt(0)
    s_load_dword s10, s[8:9], 0 glc
    s_load_dword s11, s[8:9], 128 glc
    s_load_dword s42, s[8:9], 256 glc
    s_load_dword s43, s[8:9], 384 glc
    s_load_dword s50, s[8:9], 512 glc
    s_load_dword s51, s[8:9], 640 glc
    v_mul_f32 v6, v176, v144
    v_mul_f32 v7, v177, v145
    v_mul_f32 v8, v178, v146
    v_mul_f32 v9, v179, v147
    v_mul_f32 v176, v176, v160
    v_mul_f32 v177, v177, v161
    v_mul_f32 v178, v178, v162
    v_mul_f32 v179, v179, v163
    v_fma_f32 v6, -v192, v160, v6
    v_fma_f32 v7, -v193, v161, v7
    v_fma_f32 v8, -v194, v162, v8
    v_fma_f32 v9, -v195, v163, v9
    v_fmac_f32 v176, v192, v144
    v_fmac_f32 v177, v193, v145
    v_fmac_f32 v178, v194, v146
    v_fmac_f32 v179, v195, v147
    v_subrev_f32_dpp v192, v6, v176 quad_perm:[1,0,3,2] row_mask:0xf bank_mask:0xf
    v_subrev_f32_dpp v193, v7, v177 quad_perm:[1,0,3,2] row_mask:0xf bank_mask:0xf
    v_subrev_f32_dpp v194, v8, v178 quad_perm:[1,0,3,2] row_mask:0xf bank_mask:0xf
    v_subrev_f32_dpp v195, v9, v179 quad_perm:[1,0,3,2] row_mask:0xf bank_mask:0xf
    v_add_f32_dpp v6, v176, v6 quad_perm:[1,0,3,2] row_mask:0xf bank_mask:0xf
    v_add_f32_dpp v7, v177, v7 quad_perm:[1,0,3,2] row_mask:0xf bank_mask:0xf
    v_add_f32_dpp v8, v178, v8 quad_perm:[1,0,3,2] row_mask:0xf bank_mask:0xf
    v_add_f32_dpp v9, v179, v9 quad_perm:[1,0,3,2] row_mask:0xf bank_mask:0xf
    v_cvt_pk_bf16_f32 v80, v192, v193
    v_cvt_pk_bf16_f32 v81, v194, v195
    v_cvt_pk_bf16_f32 v64, v6, v7
    v_cvt_pk_bf16_f32 v65, v8, v9
    v_mul_f32 v6, v180, v148
    v_mul_f32 v7, v181, v149
    v_mul_f32 v8, v182, v150
    v_mul_f32 v9, v183, v151
    v_mul_f32 v180, v180, v164
    v_mul_f32 v181, v181, v165
    v_mul_f32 v182, v182, v166
    v_mul_f32 v183, v183, v167
    v_fma_f32 v6, -v196, v164, v6
    v_fma_f32 v7, -v197, v165, v7
    v_fma_f32 v8, -v198, v166, v8
    v_fma_f32 v9, -v199, v167, v9
    v_fmac_f32 v180, v196, v148
    v_fmac_f32 v181, v197, v149
    v_fmac_f32 v182, v198, v150
    v_fmac_f32 v183, v199, v151
    v_subrev_f32_dpp v196, v6, v180 quad_perm:[1,0,3,2] row_mask:0xf bank_mask:0xf
    v_subrev_f32_dpp v197, v7, v181 quad_perm:[1,0,3,2] row_mask:0xf bank_mask:0xf
    v_subrev_f32_dpp v198, v8, v182 quad_perm:[1,0,3,2] row_mask:0xf bank_mask:0xf
    v_subrev_f32_dpp v199, v9, v183 quad_perm:[1,0,3,2] row_mask:0xf bank_mask:0xf
    v_add_f32_dpp v6, v180, v6 quad_perm:[1,0,3,2] row_mask:0xf bank_mask:0xf
    v_add_f32_dpp v7, v181, v7 quad_perm:[1,0,3,2] row_mask:0xf bank_mask:0xf
    v_add_f32_dpp v8, v182, v8 quad_perm:[1,0,3,2] row_mask:0xf bank_mask:0xf
    v_add_f32_dpp v9, v183, v9 quad_perm:[1,0,3,2] row_mask:0xf bank_mask:0xf
    v_cvt_pk_bf16_f32 v82, v196, v197
    v_cvt_pk_bf16_f32 v83, v198, v199
    v_cvt_pk_bf16_f32 v66, v6, v7
    v_cvt_pk_bf16_f32 v67, v8, v9
    ds_write_b128 v57, v[64:67] offset:0
    ds_write_b128 v57, v[80:83] offset:2048
    v_mul_f32 v6, v184, v152
    v_mul_f32 v7, v185, v153
    v_mul_f32 v8, v186, v154
    v_mul_f32 v9, v187, v155
    v_mul_f32 v184, v184, v168
    v_mul_f32 v185, v185, v169
    v_mul_f32 v186, v186, v170
    v_mul_f32 v187, v187, v171
    v_fma_f32 v6, -v200, v168, v6
    v_fma_f32 v7, -v201, v169, v7
    v_fma_f32 v8, -v202, v170, v8
    v_fma_f32 v9, -v203, v171, v9
    v_fmac_f32 v184, v200, v152
    v_fmac_f32 v185, v201, v153
    v_fmac_f32 v186, v202, v154
    v_fmac_f32 v187, v203, v155
    v_subrev_f32_dpp v200, v6, v184 quad_perm:[1,0,3,2] row_mask:0xf bank_mask:0xf
    v_subrev_f32_dpp v201, v7, v185 quad_perm:[1,0,3,2] row_mask:0xf bank_mask:0xf
    v_subrev_f32_dpp v202, v8, v186 quad_perm:[1,0,3,2] row_mask:0xf bank_mask:0xf
    v_subrev_f32_dpp v203, v9, v187 quad_perm:[1,0,3,2] row_mask:0xf bank_mask:0xf
    v_add_f32_dpp v6, v184, v6 quad_perm:[1,0,3,2] row_mask:0xf bank_mask:0xf
    v_add_f32_dpp v7, v185, v7 quad_perm:[1,0,3,2] row_mask:0xf bank_mask:0xf
    v_add_f32_dpp v8, v186, v8 quad_perm:[1,0,3,2] row_mask:0xf bank_mask:0xf
    v_add_f32_dpp v9, v187, v9 quad_perm:[1,0,3,2] row_mask:0xf bank_mask:0xf
    v_cvt_pk_bf16_f32 v84, v200, v201
    v_cvt_pk_bf16_f32 v85, v202, v203
    v_cvt_pk_bf16_f32 v68, v6, v7
    v_cvt_pk_bf16_f32 v69, v8, v9
    v_mul_f32 v6, v188, v156
    v_mul_f32 v7, v189, v157
    v_mul_f32 v8, v190, v158
    v_mul_f32 v9, v191, v159
    v_mul_f32 v188, v188, v172
    v_mul_f32 v189, v189, v173
    v_mul_f32 v190, v190, v174
    v_mul_f32 v191, v191, v175
    v_fma_f32 v6, -v204, v172, v6
    v_fma_f32 v7, -v205, v173, v7
    v_fma_f32 v8, -v206, v174, v8
    v_fma_f32 v9, -v207, v175, v9
    v_fmac_f32 v188, v204, v156
    v_fmac_f32 v189, v205, v157
    v_fmac_f32 v190, v206, v158
    v_fmac_f32 v191, v207, v159
    v_subrev_f32_dpp v204, v6, v188 quad_perm:[1,0,3,2] row_mask:0xf bank_mask:0xf
    v_subrev_f32_dpp v205, v7, v189 quad_perm:[1,0,3,2] row_mask:0xf bank_mask:0xf
    v_subrev_f32_dpp v206, v8, v190 quad_perm:[1,0,3,2] row_mask:0xf bank_mask:0xf
    v_subrev_f32_dpp v207, v9, v191 quad_perm:[1,0,3,2] row_mask:0xf bank_mask:0xf
    v_add_f32_dpp v6, v188, v6 quad_perm:[1,0,3,2] row_mask:0xf bank_mask:0xf
    v_add_f32_dpp v7, v189, v7 quad_perm:[1,0,3,2] row_mask:0xf bank_mask:0xf
    v_add_f32_dpp v8, v190, v8 quad_perm:[1,0,3,2] row_mask:0xf bank_mask:0xf
    v_add_f32_dpp v9, v191, v9 quad_perm:[1,0,3,2] row_mask:0xf bank_mask:0xf
    v_cvt_pk_bf16_f32 v86, v204, v205
    v_cvt_pk_bf16_f32 v87, v206, v207
    v_cvt_pk_bf16_f32 v70, v6, v7
    v_cvt_pk_bf16_f32 v71, v8, v9
    ds_write_b128 v57, v[68:71] offset:1024
    ds_write_b128 v57, v[84:87] offset:3072
    v_mfma_f32_32x32x16_bf16 v[144:159], v[64:67], v[16:19], 0
    v_xor_b32 v208, 0x80008000, v80
    v_xor_b32 v209, 0x80008000, v81
    v_xor_b32 v210, 0x80008000, v82
    v_xor_b32 v211, 0x80008000, v83
    v_mfma_f32_32x32x16_bf16 v[160:175], v[80:83], v[16:19], 0
    v_mfma_f32_32x32x16_bf16 v[160:175], v[64:67], v[32:35], v[160:175]
    v_mfma_f32_32x32x16_bf16 v[144:159], v[208:211], v[32:35], v[144:159]
    s_waitcnt lgkmcnt(0)
    s_barrier
    ds_read_b128 v[72:75], v58 offset:0
    ds_read_b128 v[88:91], v58 offset:2048
    ds_read_b128 v[76:79], v58 offset:1024
    ds_read_b128 v[92:95], v58 offset:3072
    s_mov_b32 s56, 0
    s_add_u32 s57, s3, 2
Lsp_12:
    s_waitcnt lgkmcnt(0)
    s_sub_u32 s10, s10, s57
    s_sub_u32 s11, s11, s57
    s_sub_u32 s42, s42, s57
    s_sub_u32 s43, s43, s57
    s_sub_u32 s50, s50, s57
    s_sub_u32 s51, s51, s57
    s_max_u32 s10, s10, s11
    s_max_u32 s10, s10, s42
    s_max_u32 s10, s10, s43
    s_max_u32 s10, s10, s50
    s_max_u32 s10, s10, s51
    s_cmp_le_u32 s10, 5
    s_cbranch_scc1 Lsp_12d
    s_add_u32 s56, s56, 1
    s_cmp_ge_u32 s56, 40000
    s_cbranch_scc1 Lsp_12d
    s_sleep 2
    s_load_dword s10, s[8:9], 0 glc
    s_load_dword s11, s[8:9], 128 glc
    s_load_dword s42, s[8:9], 256 glc
    s_load_dword s43, s[8:9], 384 glc
    s_load_dword s50, s[8:9], 512 glc
    s_load_dword s51, s[8:9], 640 glc
    s_branch Lsp_12
Lsp_12d:
    s_cmp_eq_u32 s53, 0
    s_cbranch_scc1 L_fw0
    s_bfe_u32 s55, s44, 393216
    s_add_u32 m0, s97, 138240
    s_lshl_b32 s55, s55, 11
    buffer_load_dwordx4 v240, s[24:27], s55 offen offset:0 sc1 lds
    buffer_load_dwordx4 v240, s[24:27], s55 offen offset:1024 sc1 lds
    s_bfe_u32 s55, s44, 393222
    s_add_u32 m0, s97, 140288
    s_lshl_b32 s55, s55, 11
    buffer_load_dwordx4 v240, s[24:27], s55 offen offset:0 sc1 lds
    buffer_load_dwordx4 v240, s[24:27], s55 offen offset:1024 sc1 lds
    s_bfe_u32 s55, s44, 393228
    s_add_u32 m0, s97, 142336
    s_lshl_b32 s55, s55, 11
    buffer_load_dwordx4 v240, s[24:27], s55 offen offset:0 sc1 lds
    buffer_load_dwordx4 v240, s[24:27], s55 offen offset:1024 sc1 lds
    s_branch L_fw1
L_fw0:
    s_bfe_u32 s54, s44, 393216
    s_mul_i32 s54, s54, 5120
    s_bfe_u32 s55, s44, 393222
    s_mul_i32 s55, s55, 5120
    s_bfe_u32 s56, s44, 393228
    s_mul_i32 s56, s56, 5120
    s_add_u32 m0, s7, 122880
    s_nop 0
    buffer_load_dwordx4 v241, s[24:27], s54 offen sc1 lds
    s_add_u32 m0, s7, 126976
    s_cmp_eq_u32 s52, 0
    s_cselect_b32 s57, s54, s55
    buffer_load_dwordx4 v242, s[24:27], s57 offen sc1 lds
    s_add_u32 m0, s7, 131072
    s_cmp_lt_u32 s52, 2
    s_cselect_b32 s57, s55, s56
    buffer_load_dwordx4 v243, s[24:27], s57 offen sc1 lds
    s_add_u32 m0, s6, 122880
    s_nop 0
    buffer_load_dwordx4 v244, s[24:27], s56 offen sc1 lds
L_fw1:
    v_mfma_f32_32x32x16_bf16 v[144:159], v[68:71], v[20:23], v[144:159]
    v_xor_b32 v212, 0x80008000, v84
    v_xor_b32 v213, 0x80008000, v85
    v_xor_b32 v214, 0x80008000, v86
    v_xor_b32 v215, 0x80008000, v87
    v_mfma_f32_32x32x16_bf16 v[160:175], v[84:87], v[20:23], v[160:175]
    v_mfma_f32_32x32x16_bf16 v[160:175], v[68:71], v[36:39], v[160:175]
    v_mfma_f32_32x32x16_bf16 v[144:159], v[212:215], v[36:39], v[144:159]
    v_mfma_f32_32x32x16_bf16 v[144:159], v[72:75], v[24:27], v[144:159]
    v_xor_b32 v216, 0x80008000, v88
    v_xor_b32 v217, 0x80008000, v89
    v_xor_b32 v218, 0x80008000, v90
    v_xor_b32 v219, 0x80008000, v91
    v_mfma_f32_32x32x16_bf16 v[160:175], v[88:91], v[24:27], v[160:175]
    v_mfma_f32_32x32x16_bf16 v[160:175], v[72:75], v[40:43], v[160:175]
    v_mfma_f32_32x32x16_bf16 v[144:159], v[216:219], v[40:43], v[144:159]
    v_mfma_f32_32x32x16_bf16 v[144:159], v[76:79], v[28:31], v[144:159]
    v_xor_b32 v220, 0x80008000, v92
    v_xor_b32 v221, 0x80008000, v93
    v_xor_b32 v222, 0x80008000, v94
    v_xor_b32 v223, 0x80008000, v95
    v_mfma_f32_32x32x16_bf16 v[160:175], v[92:95], v[28:31], v[160:175]
    v_mfma_f32_32x32x16_bf16 v[160:175], v[76:79], v[44:47], v[160:175]
    v_mfma_f32_32x32x16_bf16 v[144:159], v[220:223], v[44:47], v[144:159]
    s_cmp_lg_u32 s29, 0
    s_cbranch_scc1 L_fns
    v_and_b32 v6, 31, v1
    s_lshl_b32 s54, s53, 5
    v_add_u32 v6, s54, v6
    v_cvt_f32_u32 v6, v6
    v_mul_f32 v6, 0x3c000000, v6
    v_cos_f32 v7, v6
    v_sin_f32 v8, v6
    s_nop 7
    v_mul_f32 v7, 0.5, v7
    v_mul_f32 v8, 0.5, v8
    v_sub_f32 v6, v145, v160
    v_add_f32 v9, v161, v144
    v_sub_f32 v144, v144, v161
    v_add_f32 v160, v160, v145
    v_mul_f32 v145, v7, v6
    v_mul_f32 v161, v8, v6
    v_mul_f32 v144, 0.5, v144
    v_mul_f32 v160, 0.5, v160
    v_fma_f32 v145, -v8, v9, v145
    v_fmac_f32 v161, v7, v9
    v_sub_f32 v6, v147, v162
    v_add_f32 v9, v163, v146
    v_sub_f32 v146, v146, v163
    v_add_f32 v162, v162, v147
    v_mul_f32 v147, v7, v6
    v_mul_f32 v163, v8, v6
    v_mul_f32 v146, 0.5, v146
    v_mul_f32 v162, 0.5, v162
    v_fma_f32 v147, -v8, v9, v147
    v_fmac_f32 v163, v7, v9
    v_sub_f32 v6, v149, v164
    v_add_f32 v9, v165, v148
    v_sub_f32 v148, v148, v165
    v_add_f32 v164, v164, v149
    v_mul_f32 v149, v7, v6
    v_mul_f32 v165, v8, v6
    v_mul_f32 v148, 0.5, v148
    v_mul_f32 v164, 0.5, v164
    v_fma_f32 v149, -v8, v9, v149
    v_fmac_f32 v165, v7, v9
    v_sub_f32 v6, v151, v166
    v_add_f32 v9, v167, v150
    v_sub_f32 v150, v150, v167
    v_add_f32 v166, v166, v151
    v_mul_f32 v151, v7, v6
    v_mul_f32 v167, v8, v6
    v_mul_f32 v150, 0.5, v150
    v_mul_f32 v166, 0.5, v166
    v_fma_f32 v151, -v8, v9, v151
    v_fmac_f32 v167, v7, v9
    v_sub_f32 v6, v153, v168
    v_add_f32 v9, v169, v152
    v_sub_f32 v152, v152, v169
    v_add_f32 v168, v168, v153
    v_mul_f32 v153, v7, v6
    v_mul_f32 v169, v8, v6
    v_mul_f32 v152, 0.5, v152
    v_mul_f32 v168, 0.5, v168
    v_fma_f32 v153, -v8, v9, v153
    v_fmac_f32 v169, v7, v9
    v_sub_f32 v6, v155, v170
    v_add_f32 v9, v171, v154
    v_sub_f32 v154, v154, v171
    v_add_f32 v170, v170, v155
    v_mul_f32 v155, v7, v6
    v_mul_f32 v171, v8, v6
    v_mul_f32 v154, 0.5, v154
    v_mul_f32 v170, 0.5, v170
    v_fma_f32 v155, -v8, v9, v155
    v_fmac_f32 v171, v7, v9
    v_sub_f32 v6, v157, v172
    v_add_f32 v9, v173, v156
    v_sub_f32 v156, v156, v173
    v_add_f32 v172, v172, v157
    v_mul_f32 v157, v7, v6
    v_mul_f32 v173, v8, v6
    v_mul_f32 v156, 0.5, v156
    v_mul_f32 v172, 0.5, v172
    v_fma_f32 v157, -v8, v9, v157
    v_fmac_f32 v173, v7, v9
    v_sub_f32 v6, v159, v174
    v_add_f32 v9, v175, v158
    v_sub_f32 v158, v158, v175
    v_add_f32 v174, v174, v159
    v_mul_f32 v159, v7, v6
    v_mul_f32 v175, v8, v6
    v_mul_f32 v158, 0.5, v158
    v_mul_f32 v174, 0.5, v174
    v_fma_f32 v159, -v8, v9, v159
    v_fmac_f32 v175, v7, v9
L_fns:
    s_lshl_b32 s54, s61, 11
    s_lshl_b32 s55, s29, 7
    s_add_u32 s54, s54, s55
    s_mul_i32 s55, s53, 1323008
    s_add_u32 s54, s54, s55
    s_add_u32 s54, s54, 12582912
    s_nop 7
    v_cvt_pk_bf16_f32 v176, v160, v162
    v_cvt_pk_bf16_f32 v177, v164, v166
    v_cvt_pk_bf16_f32 v178, v168, v170
    v_cvt_pk_bf16_f32 v179, v172, v174
    ds_write_b128 v51, v[176:179]
    v_cvt_pk_bf16_f32 v180, v161, v163
    v_cvt_pk_bf16_f32 v181, v165, v167
    v_cvt_pk_bf16_f32 v182, v169, v171
    v_cvt_pk_bf16_f32 v183, v173, v175
    ds_write_b128 v53, v[180:183]
    v_cvt_pk_bf16_f32 v184, v144, v146
    v_cvt_pk_bf16_f32 v185, v148, v150
    v_cvt_pk_bf16_f32 v186, v152, v154
    v_cvt_pk_bf16_f32 v187, v156, v158
    ds_write_b128 v50, v[184:187]
    v_cvt_pk_bf16_f32 v188, v145, v147
    v_cvt_pk_bf16_f32 v189, v149, v151
    v_cvt_pk_bf16_f32 v190, v153, v155
    v_cvt_pk_bf16_f32 v191, v157, v159
    ds_write_b128 v52, v[188:191]
    ds_read_b128 v[16:19], v54 offset:0
    ds_read_b128 v[20:23], v54 offset:1024
    ds_read_b128 v[24:27], v54 offset:2048
    ds_read_b128 v[28:31], v54 offset:3072
    s_mov_b32 s60, s54
    s_waitcnt lgkmcnt(0)
    s_mov_b32 s58, 2130706432
    s_mov_b32 s64, 2130706432
    s_mov_b32 s65, 2130706432
    s_cmp_eq_u32 s53, 0
    s_cbranch_scc1 L_fa
    buffer_store_dwordx4 v[16:19], v55, s[24:27], s60 offen sc1
    s_add_u32 s60, s60, 330752
    buffer_store_dwordx4 v[20:23], v55, s[24:27], s60 offen sc1
    s_add_u32 s60, s60, 330752
    buffer_store_dwordx4 v[24:27], v55, s[24:27], s60 offen sc1
    s_add_u32 s60, s60, 330752
    buffer_store_dwordx4 v[28:31], v55, s[24:27], s60 offen sc1
    s_bfe_u32 s55, s44, 393234
    s_add_u32 m0, s97, 97280
    s_lshl_b32 s55, s55, 11
    buffer_load_dwordx4 v240, s[24:27], s55 offen offset:0 sc1 lds
    buffer_load_dwordx4 v240, s[24:27], s55 offen offset:1024 sc1 lds
    s_bfe_u32 s55, s44, 393240
    s_add_u32 m0, s97, 99328
    s_lshl_b32 s55, s55, 11
    buffer_load_dwordx4 v240, s[24:27], s55 offen offset:0 sc1 lds
    buffer_load_dwordx4 v240, s[24:27], s55 offen offset:1024 sc1 lds
    s_bfe_u32 s55, s45, 393216
    s_add_u32 m0, s97, 101376
    s_lshl_b32 s55, s55, 11
    buffer_load_dwordx4 v240, s[24:27], s55 offen offset:0 sc1 lds
    buffer_load_dwordx4 v240, s[24:27], s55 offen offset:1024 sc1 lds
    s_waitcnt vmcnt(10)
    s_branch L_CB2
L_fa:
    buffer_store_dwordx4 v[16:19], v55, s[24:27], s60 offen sc1
    s_add_u32 s60, s60, 330752
    buffer_store_dwordx4 v[20:23], v55, s[24:27], s60 offen sc1
    s_add_u32 s60, s60, 330752
    buffer_store_dwordx4 v[24:27], v55, s[24:27], s60 offen sc1
    s_add_u32 s60, s60, 330752
    buffer_store_dwordx4 v[28:31], v55, s[24:27], s60 offen sc1
    s_mul_i32 s59, s29, 5
    s_add_u32 s59, s59, s30
    s_lshl_b32 s59, s59, 7
    s_add_u32 s59, s59, 28327936
    s_cmp_eq_u32 s28, 0
    s_cselect_b32 s59, s59, 2130706432
    s_branch L_CA2
L_CA:
    s_or_b32 s57, s3, 4
    v_mov_b32 v6, s57
    v_mov_b32 v7, 0
    s_mov_b64 exec, 1
    buffer_store_dword v6, v7, s[24:27], s58 offen sc1
    s_mov_b64 exec, -1
    s_and_b32 s55, s2, 1
    s_mul_i32 s98, s55, 640
    s_lshl_b32 s54, s29, 2
    s_add_u32 s54, s54, s52
    s_lshl_b32 s55, s54, 11
    s_add_u32 s98, s98, s55
    s_add_u32 s99, s98, 28573696
    s_add_u32 s98, s98, 28442624
    s_mul_i32 s54, s54, 110592
    v_lshlrev_b32 v245, 4, v1
    v_add_u32 v240, s54, v245
    s_lshr_b32 s54, s2, 5
    s_mul_i32 s54, s54, 276480
    s_add_u32 s54, s54, 20971520
    v_add_u32 v245, s54, v245
    s_add_u32 s54, s52, 0
    s_mul_i32 s55, s54, 52
    s_lshr_b32 s55, s55, 8
    s_mul_i32 s55, s55, 5
    s_sub_u32 s55, s54, s55
    s_lshl_b32 s55, s55, 10
    v_add_u32 v241, s55, v245
    s_add_u32 s54, s52, 4
    s_mul_i32 s55, s54, 52
    s_lshr_b32 s55, s55, 8
    s_mul_i32 s55, s55, 5
    s_sub_u32 s55, s54, s55
    s_lshl_b32 s55, s55, 10
    v_add_u32 v242, s55, v245
    s_add_u32 s54, s52, 8
    s_mul_i32 s55, s54, 52
    s_lshr_b32 s55, s55, 8
    s_mul_i32 s55, s55, 5
    s_sub_u32 s55, s54, s55
    s_lshl_b32 s55, s55, 10
    v_add_u32 v243, s55, v245
    s_add_u32 s54, s52, 12
    s_mul_i32 s55, s54, 52
    s_lshr_b32 s55, s55, 8
    s_mul_i32 s55, s55, 5
    s_sub_u32 s55, s54, s55
    s_lshl_b32 s55, s55, 10
    s_cmp_eq_u32 s54, 15
    s_cselect_b32 s55, 2130706432, s55
    v_add_u32 v244, s55, v245
    s_mul_i32 s97, s52, 6144
    s_lshl_b32 s7, s52, 10
    s_add_u32 s6, s7, 12288
    s_cmp_eq_u32 s52, 3
    s_cselect_b32 s6, 39936, s6
L_CA2:
    s_load_dwordx2 s[8:9], s[0:1], 56
    s_bfe_u32 s54, s44, 393234
    s_mul_i32 s54, s54, 5120
    s_bfe_u32 s55, s44, 393240
    s_mul_i32 s55, s55, 5120
    s_bfe_u32 s56, s45, 393216
    s_mul_i32 s56, s56, 5120
    s_add_u32 m0, s7, 81920
    s_nop 0
    buffer_load_dwordx4 v241, s[24:27], s54 offen sc1 lds
    s_add_u32 m0, s7, 86016
    s_cmp_eq_u32 s52, 0
    s_cselect_b32 s57, s54, s55
    buffer_load_dwordx4 v242, s[24:27], s57 offen sc1 lds
    s_add_u32 m0, s7, 90112
    s_cmp_lt_u32 s52, 2
    s_cselect_b32 s57, s55, s56
    buffer_load_dwordx4 v243, s[24:27], s57 offen sc1 lds
    s_add_u32 m0, s6, 81920
    s_nop 0
    buffer_load_dwordx4 v244, s[24:27], s56 offen sc1 lds
    v_lshrrev_b32 v210, 4, v1
    v_and_b32 v211, 15, v1
    v_lshrrev_b32 v2, 5, v1
    v_lshlrev_b32 v2, 4, v2
    v_bfe_u32 v3, v1, 4, 1
    v_lshl_add_u32 v2, v3, 2, v2
    v_bfe_u32 v3, v1, 2, 2
    v_add_u32 v2, v2, v3
    v_mul_u32_u24 v2, 160, v2
    v_and_b32 v3, 3, v1
    v_lshl_add_u32 v10, v3, 3, v2
    v_add_u32 v9, 81920, v10
    v_add_u32 v8, 122880, v10
    s_mul_i32 s54, s52, 6144
    s_add_u32 s54, s54, 15360
    v_lshlrev_b32 v2, 9, v210
    v_lshl_add_u32 v2, v211, 4, v2
    v_add_u32 v13, s54, v2
    v_add_u32 v12, 81920, v13
    v_add_u32 v11, 122880, v13
    s_lshr_b32 s60, s2, 5
    s_and_b32 s61, s2, 1
    s_waitcnt lgkmcnt(0)
    s_waitcnt vmcnt(8)
    s_barrier
    ds_read_b128 v[16:19], v11 offset:0
    ds_read_b128 v[20:23], v11 offset:256
    ds_read_b64_tr_b16 v[32:33], v8 offset:0
    ds_read_b64_tr_b16 v[34:35], v8 offset:1280
    ds_read_b64_tr_b16 v[36:37], v8 offset:32
    ds_read_b64_tr_b16 v[38:39], v8 offset:1312
    ds_read_b64_tr_b16 v[40:41], v8 offset:64
    ds_read_b64_tr_b16 v[42:43], v8 offset:1344
    ds_read_b64_tr_b16 v[44:45], v8 offset:96
    ds_read_b64_tr_b16 v[46:47], v8 offset:1376
    ds_read_b64_tr_b16 v[48:49], v8 offset:128
    ds_read_b64_tr_b16 v[50:51], v8 offset:1408
    s_waitcnt lgkmcnt(6)
    v_mfma_f32_16x16x32_bf16 v[80:83], v[32:35], v[16:19], 0
    ds_read_b128 v[24:27], v11 offset:2048
    v_mfma_f32_16x16x32_bf16 v[84:87], v[32:35], v[20:23], 0
    ds_read_b128 v[28:31], v11 offset:2304
    s_bfe_u32 s54, s45, 393222
    s_mul_i32 s54, s54, 5120
    s_bfe_u32 s55, s45, 393228
    s_mul_i32 s55, s55, 5120
    s_bfe_u32 s56, s45, 393234
    s_mul_i32 s56, s56, 5120
    s_add_u32 m0, s7, 0
    s_nop 0
    buffer_load_dwordx4 v241, s[24:27], s54 offen sc1 lds
    v_mfma_f32_16x16x32_bf16 v[88:91], v[36:39], v[16:19], 0
    ds_read_b64_tr_b16 v[52:53], v8 offset:5120
    v_mfma_f32_16x16x32_bf16 v[92:95], v[36:39], v[20:23], 0
    ds_read_b64_tr_b16 v[54:55], v8 offset:6400
    s_waitcnt lgkmcnt(6)
    v_mfma_f32_16x16x32_bf16 v[96:99], v[40:43], v[16:19], 0
    ds_read_b64_tr_b16 v[56:57], v8 offset:5152
    ds_read_b64_tr_b16 v[58:59], v8 offset:6432
    s_add_u32 m0, s7, 4096
    s_cmp_eq_u32 s52, 0
    s_cselect_b32 s57, s54, s55
    buffer_load_dwordx4 v242, s[24:27], s57 offen sc1 lds
    v_mfma_f32_16x16x32_bf16 v[100:103], v[40:43], v[20:23], 0
    ds_read_b64_tr_b16 v[60:61], v8 offset:5184
    v_mfma_f32_16x16x32_bf16 v[104:107], v[44:47], v[16:19], 0
    ds_read_b64_tr_b16 v[62:63], v8 offset:6464
    v_mfma_f32_16x16x32_bf16 v[108:111], v[44:47], v[20:23], 0
    ds_read_b64_tr_b16 v[64:65], v8 offset:5216
    s_add_u32 m0, s7, 8192
    s_cmp_lt_u32 s52, 2
    s_cselect_b32 s57, s55, s56
    buffer_load_dwordx4 v243, s[24:27], s57 offen sc1 lds
    s_waitcnt lgkmcnt(9)
    v_mfma_f32_16x16x32_bf16 v[112:115], v[48:51], v[16:19], 0
    ds_read_b64_tr_b16 v[66:67], v8 offset:6496
    v_mfma_f32_16x16x32_bf16 v[116:119], v[48:51], v[20:23], 0
    ds_read_b64_tr_b16 v[68:69], v8 offset:5248
    ds_read_b64_tr_b16 v[70:71], v8 offset:6528
    s_waitcnt lgkmcnt(6)
    v_mfma_f32_16x16x32_bf16 v[80:83], v[52:55], v[24:27], v[80:83]
    ds_read_b128 v[16:19], v11 offset:4096
    v_mfma_f32_16x16x32_bf16 v[84:87], v[52:55], v[28:31], v[84:87]
    ds_read_b128 v[20:23], v11 offset:4352
    s_add_u32 m0, s6, 0
    s_nop 0
    buffer_load_dwordx4 v244, s[24:27], s56 offen sc1 lds
    v_mfma_f32_16x16x32_bf16 v[88:91], v[56:59], v[24:27], v[88:91]
    ds_read_b64_tr_b16 v[32:33], v8 offset:10240
    v_mfma_f32_16x16x32_bf16 v[92:95], v[56:59], v[28:31], v[92:95]
    ds_read_b64_tr_b16 v[34:35], v8 offset:11520
    s_waitcnt lgkmcnt(6)
    v_mfma_f32_16x16x32_bf16 v[96:99], v[60:63], v[24:27], v[96:99]
    ds_read_b64_tr_b16 v[36:37], v8 offset:10272
    ds_read_b64_tr_b16 v[38:39], v8 offset:11552
    v_mfma_f32_16x16x32_bf16 v[100:103], v[60:63], v[28:31], v[100:103]
    ds_read_b64_tr_b16 v[40:41], v8 offset:10304
    v_mfma_f32_16x16x32_bf16 v[104:107], v[64:67], v[24:27], v[104:107]
    ds_read_b64_tr_b16 v[42:43], v8 offset:11584
    v_mfma_f32_16x16x32_bf16 v[108:111], v[64:67], v[28:31], v[108:111]
    ds_read_b64_tr_b16 v[44:45], v8 offset:10336
    s_waitcnt lgkmcnt(9)
    v_mfma_f32_16x16x32_bf16 v[112:115], v[68:71], v[24:27], v[112:115]
    ds_read_b64_tr_b16 v[46:47], v8 offset:11616
    v_mfma_f32_16x16x32_bf16 v[116:119], v[68:71], v[28:31], v[116:119]
    ds_read_b64_tr_b16 v[48:49], v8 offset:10368
    ds_read_b64_tr_b16 v[50:51], v8 offset:11648
    s_mul_i32 s36, s60, 80
    s_lshl_b32 s37, s36, 1
    s_sub_u32 s37, 1120, s37
    v_lshl_add_u32 v2, v210, 3, s36
    v_add_u32 v3, s37, v2
    v_cmp_gt_u32 vcc, 2, v210
    s_nop 1
    v_cndmask_b32 v4, v3, v2, vcc
    s_mov_b32 s20, s8
    s_mov_b32 s21, s9
    s_mov_b32 s22, 1280
    buffer_load_dwordx2 v[196:197], v2, s[20:23], 0 offen offset:0
    buffer_load_dwordx2 v[198:199], v2, s[20:23], 0 offen offset:32
    buffer_load_dwordx2 v[200:201], v4, s[20:23], 0 offen offset:64
    buffer_load_dwordx2 v[202:203], v3, s[20:23], 0 offen offset:96
    buffer_load_dwordx2 v[204:205], v3, s[20:23], 0 offen offset:128
    s_lshr_b32 s38, s52, 1
    s_xor_b32 s38, s38, s61
    s_and_b32 s39, s52, 1
    s_waitcnt lgkmcnt(0)
    s_waitcnt vmcnt(9)
    s_barrier
    v_mfma_f32_16x16x32_bf16 v[80:83], v[32:35], v[16:19], v[80:83]
    ds_read_b128 v[24:27], v12 offset:0
    v_mfma_f32_16x16x32_bf16 v[84:87], v[32:35], v[20:23], v[84:87]
    ds_read_b128 v[28:31], v12 offset:256
    v_mfma_f32_16x16x32_bf16 v[88:91], v[36:39], v[16:19], v[88:91]
    ds_read_b64_tr_b16 v[52:53], v9 offset:0
    v_mfma_f32_16x16x32_bf16 v[92:95], v[36:39], v[20:23], v[92:95]
    ds_read_b64_tr_b16 v[54:55], v9 offset:1280
    v_mfma_f32_16x16x32_bf16 v[96:99], v[40:43], v[16:19], v[96:99]
    ds_read_b64_tr_b16 v[56:57], v9 offset:32
    ds_read_b64_tr_b16 v[58:59], v9 offset:1312
    v_mfma_f32_16x16x32_bf16 v[100:103], v[40:43], v[20:23], v[100:103]
    ds_read_b64_tr_b16 v[60:61], v9 offset:64
    s_bfe_u32 s54, s45, 393240
    s_mul_i32 s54, s54, 5120
    s_bfe_u32 s55, s46, 393216
    s_mul_i32 s55, s55, 5120
    s_bfe_u32 s56, s46, 393222
    s_mul_i32 s56, s56, 5120
    s_add_u32 m0, s7, 122880
    s_nop 0
    buffer_load_dwordx4 v241, s[24:27], s54 offen sc1 lds
    v_mfma_f32_16x16x32_bf16 v[104:107], v[44:47], v[16:19], v[104:107]
    ds_read_b64_tr_b16 v[62:63], v9 offset:1344
    v_mfma_f32_16x16x32_bf16 v[108:111], v[44:47], v[20:23], v[108:111]
    ds_read_b64_tr_b16 v[64:65], v9 offset:96
    v_mfma_f32_16x16x32_bf16 v[112:115], v[48:51], v[16:19], v[112:115]
    ds_read_b64_tr_b16 v[66:67], v9 offset:1376
    v_mfma_f32_16x16x32_bf16 v[116:119], v[48:51], v[20:23], v[116:119]
    ds_read_b64_tr_b16 v[68:69], v9 offset:128
    ds_read_b64_tr_b16 v[70:71], v9 offset:1408
    s_xor_b32 s40, s2, 1
    s_lshl_b32 s40, s40, 1
    s_add_u32 s40, s40, s39
    s_mul_i32 s41, s40, 6144
    s_add_u32 s41, s41, 16777216
    s_lshl_b32 s40, s40, 7
    s_add_u32 s40, s40, 28704768
    s_lshl_b32 s34, s2, 1
    s_add_u32 s34, s34, s39
    s_mul_i32 s35, s34, 6144
    s_waitcnt lgkmcnt(6)
    v_mfma_f32_16x16x32_bf16 v[80:83], v[52:55], v[24:27], v[80:83]
    ds_read_b128 v[16:19], v12 offset:2048
    v_mfma_f32_16x16x32_bf16 v[84:87], v[52:55], v[28:31], v[84:87]
    ds_read_b128 v[20:23], v12 offset:2304
    v_mfma_f32_16x16x32_bf16 v[88:91], v[56:59], v[24:27], v[88:91]
    ds_read_b64_tr_b16 v[32:33], v9 offset:5120
    s_add_u32 m0, s7, 126976
    s_cmp_eq_u32 s52, 0
    s_cselect_b32 s57, s54, s55
    buffer_load_dwordx4 v242, s[24:27], s57 offen sc1 lds
    v_mfma_f32_16x16x32_bf16 v[92:95], v[56:59], v[28:31], v[92:95]
    ds_read_b64_tr_b16 v[34:35], v9 offset:6400
    s_waitcnt lgkmcnt(6)
    v_mfma_f32_16x16x32_bf16 v[96:99], v[60:63], v[24:27], v[96:99]
    ds_read_b64_tr_b16 v[36:37], v9 offset:5152
    ds_read_b64_tr_b16 v[38:39], v9 offset:6432
    v_mfma_f32_16x16x32_bf16 v[100:103], v[60:63], v[28:31], v[100:103]
    ds_read_b64_tr_b16 v[40:41], v9 offset:5184
    v_mfma_f32_16x16x32_bf16 v[104:107], v[64:67], v[24:27], v[104:107]
    ds_read_b64_tr_b16 v[42:43], v9 offset:6464
    v_mfma_f32_16x16x32_bf16 v[108:111], v[64:67], v[28:31], v[108:111]
    ds_read_b64_tr_b16 v[44:45], v9 offset:5216
    s_waitcnt lgkmcnt(9)
    v_mfma_f32_16x16x32_bf16 v[112:115], v[68:71], v[24:27], v[112:115]
    ds_read_b64_tr_b16 v[46:47], v9 offset:6496
    s_add_u32 m0, s7, 131072
    s_cmp_lt_u32 s52, 2
    s_cselect_b32 s57, s55, s56
    buffer_load_dwordx4 v243, s[24:27], s57 offen sc1 lds
    v_mfma_f32_16x16x32_bf16 v[116:119], v[68:71], v[28:31], v[116:119]
    ds_read_b64_tr_b16 v[48:49], v9 offset:5248
    ds_read_b64_tr_b16 v[50:51], v9 offset:6528
    s_mul_i32 s50, s38, 3072
    s_add_u32 s35, s35, s50
    s_add_u32 s35, s35, 16777216
    s_lshl_b32 s34, s34, 7
    s_add_u32 s34, s34, 28704768
    v_lshlrev_b32 v5, 4, v1
    s_mul_i32 s50, s39, 5120
    s_add_u32 s50, s50, 92160
    v_add_u32 v14, s50, v5
    s_waitcnt lgkmcnt(6)
    v_mfma_f32_16x16x32_bf16 v[80:83], v[32:35], v[16:19], v[80:83]
    ds_read_b128 v[24:27], v12 offset:4096
    v_mfma_f32_16x16x32_bf16 v[84:87], v[32:35], v[20:23], v[84:87]
    ds_read_b128 v[28:31], v12 offset:4352
    v_mfma_f32_16x16x32_bf16 v[88:91], v[36:39], v[16:19], v[88:91]
    ds_read_b64_tr_b16 v[52:53], v9 offset:10240
    v_mfma_f32_16x16x32_bf16 v[92:95], v[36:39], v[20:23], v[92:95]
    ds_read_b64_tr_b16 v[54:55], v9 offset:11520
    s_waitcnt lgkmcnt(6)
    v_mfma_f32_16x16x32_bf16 v[96:99], v[40:43], v[16:19], v[96:99]
    ds_read_b64_tr_b16 v[56:57], v9 offset:10272
    ds_read_b64_tr_b16 v[58:59], v9 offset:11552
    s_add_u32 m0, s6, 122880
    s_nop 0
    buffer_load_dwordx4 v244, s[24:27], s56 offen sc1 lds
    v_mfma_f32_16x16x32_bf16 v[100:103], v[40:43], v[20:23], v[100:103]
    ds_read_b64_tr_b16 v[60:61], v9 offset:10304
    v_mfma_f32_16x16x32_bf16 v[104:107], v[44:47], v[16:19], v[104:107]
    ds_read_b64_tr_b16 v[62:63], v9 offset:11584
    v_mfma_f32_16x16x32_bf16 v[108:111], v[44:47], v[20:23], v[108:111]
    ds_read_b64_tr_b16 v[64:65], v9 offset:10336
    s_waitcnt lgkmcnt(9)
    v_mfma_f32_16x16x32_bf16 v[112:115], v[48:51], v[16:19], v[112:115]
    ds_read_b64_tr_b16 v[66:67], v9 offset:11616
    v_mfma_f32_16x16x32_bf16 v[116:119], v[48:51], v[20:23], v[116:119]
    ds_read_b64_tr_b16 v[68:69], v9 offset:10368
    ds_read_b64_tr_b16 v[70:71], v9 offset:11648
    s_lshl_b32 s50, s39, 5
    s_lshl_b32 s51, s38, 4
    s_add_u32 s50, s50, s51
    v_add_u32 v15, s50, v211
    v_mul_u32_u24 v208, 320, v15
    v_lshl_add_u32 v208, v210, 4, v208
    v_add_u32 v208, 102400, v208
    v_mul_u32_u24 v209, 160, v15
    v_lshl_add_u32 v209, v210, 3, v209
    v_add_u32 v209, 81920, v209
    s_waitcnt lgkmcnt(0)
    s_waitcnt vmcnt(9)
    s_waitcnt vmcnt(4)
    s_barrier
    s_or_b32 s39, s3, 5
    v_mov_b32 v6, s39
    v_mov_b32 v7, 0
    s_mov_b64 exec, 1
    buffer_store_dword v6, v7, s[24:27], s59 offen sc1
    s_mov_b64 exec, -1
    v_mfma_f32_16x16x32_bf16 v[80:83], v[52:55], v[24:27], v[80:83]
    ds_read_b128 v[16:19], v13 offset:0
    v_mfma_f32_16x16x32_bf16 v[84:87], v[52:55], v[28:31], v[84:87]
    ds_read_b128 v[20:23], v13 offset:256
    v_mfma_f32_16x16x32_bf16 v[88:91], v[56:59], v[24:27], v[88:91]
    ds_read_b64_tr_b16 v[32:33], v10 offset:0
    v_mfma_f32_16x16x32_bf16 v[92:95], v[56:59], v[28:31], v[92:95]
    ds_read_b64_tr_b16 v[34:35], v10 offset:1280
    v_mfma_f32_16x16x32_bf16 v[96:99], v[60:63], v[24:27], v[96:99]
    ds_read_b64_tr_b16 v[36:37], v10 offset:32
    ds_read_b64_tr_b16 v[38:39], v10 offset:1312
    v_mfma_f32_16x16x32_bf16 v[100:103], v[60:63], v[28:31], v[100:103]
    ds_read_b64_tr_b16 v[40:41], v10 offset:64
    s_bfe_u32 s54, s46, 393228
    s_mul_i32 s54, s54, 5120
    s_bfe_u32 s55, s46, 393234
    s_mul_i32 s55, s55, 5120
    s_bfe_u32 s56, s46, 393240
    s_mul_i32 s56, s56, 5120
    s_add_u32 m0, s7, 81920
    s_nop 0
    buffer_load_dwordx4 v241, s[24:27], s54 offen sc1 lds
    v_mfma_f32_16x16x32_bf16 v[104:107], v[64:67], v[24:27], v[104:107]
    ds_read_b64_tr_b16 v[42:43], v10 offset:1344
    v_mfma_f32_16x16x32_bf16 v[108:111], v[64:67], v[28:31], v[108:111]
    ds_read_b64_tr_b16 v[44:45], v10 offset:96
    v_mfma_f32_16x16x32_bf16 v[112:115], v[68:71], v[24:27], v[112:115]
    ds_read_b64_tr_b16 v[46:47], v10 offset:1376
    v_mfma_f32_16x16x32_bf16 v[116:119], v[68:71], v[28:31], v[116:119]
    ds_read_b64_tr_b16 v[48:49], v10 offset:128
    ds_read_b64_tr_b16 v[50:51], v10 offset:1408
    s_waitcnt lgkmcnt(6)
    v_mfma_f32_16x16x32_bf16 v[80:83], v[32:35], v[16:19], v[80:83]
    ds_read_b128 v[24:27], v13 offset:2048
    v_mfma_f32_16x16x32_bf16 v[84:87], v[32:35], v[20:23], v[84:87]
    ds_read_b128 v[28:31], v13 offset:2304
    v_mfma_f32_16x16x32_bf16 v[88:91], v[36:39], v[16:19], v[88:91]
    ds_read_b64_tr_b16 v[52:53], v10 offset:5120
    s_add_u32 m0, s7, 86016
    s_cmp_eq_u32 s52, 0
    s_cselect_b32 s57, s54, s55
    buffer_load_dwordx4 v242, s[24:27], s57 offen sc1 lds
    v_mfma_f32_16x16x32_bf16 v[92:95], v[36:39], v[20:23], v[92:95]
    ds_read_b64_tr_b16 v[54:55], v10 offset:6400
    s_waitcnt lgkmcnt(6)
    v_mfma_f32_16x16x32_bf16 v[96:99], v[40:43], v[16:19], v[96:99]
    ds_read_b64_tr_b16 v[56:57], v10 offset:5152
    ds_read_b64_tr_b16 v[58:59], v10 offset:6432
    v_mfma_f32_16x16x32_bf16 v[100:103], v[40:43], v[20:23], v[100:103]
    ds_read_b64_tr_b16 v[60:61], v10 offset:5184
    v_mfma_f32_16x16x32_bf16 v[104:107], v[44:47], v[16:19], v[104:107]
    ds_read_b64_tr_b16 v[62:63], v10 offset:6464
    v_mfma_f32_16x16x32_bf16 v[108:111], v[44:47], v[20:23], v[108:111]
    ds_read_b64_tr_b16 v[64:65], v10 offset:5216
    s_waitcnt lgkmcnt(9)
    v_mfma_f32_16x16x32_bf16 v[112:115], v[48:51], v[16:19], v[112:115]
    ds_read_b64_tr_b16 v[66:67], v10 offset:6496
    s_add_u32 m0, s7, 90112
    s_cmp_lt_u32 s52, 2
    s_cselect_b32 s57, s55, s56
    buffer_load_dwordx4 v243, s[24:27], s57 offen sc1 lds
    v_mfma_f32_16x16x32_bf16 v[116:119], v[48:51], v[20:23], v[116:119]
    ds_read_b64_tr_b16 v[68:69], v10 offset:5248
    ds_read_b64_tr_b16 v[70:71], v10 offset:6528
    s_waitcnt lgkmcnt(6)
    v_mfma_f32_16x16x32_bf16 v[80:83], v[52:55], v[24:27], v[80:83]
    ds_read_b128 v[16:19], v13 offset:4096
    v_mfma_f32_16x16x32_bf16 v[84:87], v[52:55], v[28:31], v[84:87]
    ds_read_b128 v[20:23], v13 offset:4352
    v_mfma_f32_16x16x32_bf16 v[88:91], v[56:59], v[24:27], v[88:91]
    ds_read_b64_tr_b16 v[32:33], v10 offset:10240
    v_mfma_f32_16x16x32_bf16 v[92:95], v[56:59], v[28:31], v[92:95]
    ds_read_b64_tr_b16 v[34:35], v10 offset:11520
    s_waitcnt lgkmcnt(6)
    v_mfma_f32_16x16x32_bf16 v[96:99], v[60:63], v[24:27], v[96:99]
    ds_read_b64_tr_b16 v[36:37], v10 offset:10272
    ds_read_b64_tr_b16 v[38:39], v10 offset:11552
    s_add_u32 m0, s6, 81920
    s_nop 0
    buffer_load_dwordx4 v244, s[24:27], s56 offen sc1 lds
    v_mfma_f32_16x16x32_bf16 v[100:103], v[60:63], v[28:31], v[100:103]
    ds_read_b64_tr_b16 v[40:41], v10 offset:10304
    v_mfma_f32_16x16x32_bf16 v[104:107], v[64:67], v[24:27], v[104:107]
    ds_read_b64_tr_b16 v[42:43], v10 offset:11584
    v_mfma_f32_16x16x32_bf16 v[108:111], v[64:67], v[28:31], v[108:111]
    ds_read_b64_tr_b16 v[44:45], v10 offset:10336
    s_waitcnt lgkmcnt(9)
    v_mfma_f32_16x16x32_bf16 v[112:115], v[68:71], v[24:27], v[112:115]
    ds_read_b64_tr_b16 v[46:47], v10 offset:11616
    v_mfma_f32_16x16x32_bf16 v[116:119], v[68:71], v[28:31], v[116:119]
    ds_read_b64_tr_b16 v[48:49], v10 offset:10368
    ds_read_b64_tr_b16 v[50:51], v10 offset:11648
    s_waitcnt lgkmcnt(0)
    s_waitcnt vmcnt(5)
    s_barrier
    v_mfma_f32_16x16x32_bf16 v[80:83], v[32:35], v[16:19], v[80:83]
    ds_read_b128 v[24:27], v11 offset:0
    v_mfma_f32_16x16x32_bf16 v[84:87], v[32:35], v[20:23], v[84:87]
    ds_read_b128 v[28:31], v11 offset:256
    v_mfma_f32_16x16x32_bf16 v[88:91], v[36:39], v[16:19], v[88:91]
    ds_read_b64_tr_b16 v[52:53], v8 offset:0
    v_mfma_f32_16x16x32_bf16 v[92:95], v[36:39], v[20:23], v[92:95]
    ds_read_b64_tr_b16 v[54:55], v8 offset:1280
    v_mfma_f32_16x16x32_bf16 v[96:99], v[40:43], v[16:19], v[96:99]
    ds_read_b64_tr_b16 v[56:57], v8 offset:32
    ds_read_b64_tr_b16 v[58:59], v8 offset:1312
    v_mfma_f32_16x16x32_bf16 v[100:103], v[40:43], v[20:23], v[100:103]
    ds_read_b64_tr_b16 v[60:61], v8 offset:64
    s_bfe_u32 s54, s47, 393216
    s_mul_i32 s54, s54, 5120
    s_bfe_u32 s55, s47, 393222
    s_mul_i32 s55, s55, 5120
    s_bfe_u32 s56, s47, 393228
    s_mul_i32 s56, s56, 5120
    s_add_u32 m0, s7, 0
    s_nop 0
    buffer_load_dwordx4 v241, s[24:27], s54 offen sc1 lds
    v_mfma_f32_16x16x32_bf16 v[104:107], v[44:47], v[16:19], v[104:107]
    ds_read_b64_tr_b16 v[62:63], v8 offset:1344
    v_mfma_f32_16x16x32_bf16 v[108:111], v[44:47], v[20:23], v[108:111]
    ds_read_b64_tr_b16 v[64:65], v8 offset:96
    v_mfma_f32_16x16x32_bf16 v[112:115], v[48:51], v[16:19], v[112:115]
    ds_read_b64_tr_b16 v[66:67], v8 offset:1376
    v_mfma_f32_16x16x32_bf16 v[116:119], v[48:51], v[20:23], v[116:119]
    ds_read_b64_tr_b16 v[68:69], v8 offset:128
    ds_read_b64_tr_b16 v[70:71], v8 offset:1408
    s_waitcnt lgkmcnt(6)
    v_mfma_f32_16x16x32_bf16 v[80:83], v[52:55], v[24:27], v[80:83]
    ds_read_b128 v[16:19], v11 offset:2048
    v_mfma_f32_16x16x32_bf16 v[84:87], v[52:55], v[28:31], v[84:87]
    ds_read_b128 v[20:23], v11 offset:2304
    v_mfma_f32_16x16x32_bf16 v[88:91], v[56:59], v[24:27], v[88:91]
    ds_read_b64_tr_b16 v[32:33], v8 offset:5120
    s_add_u32 m0, s7, 4096
    s_cmp_eq_u32 s52, 0
    s_cselect_b32 s57, s54, s55
    buffer_load_dwordx4 v242, s[24:27], s57 offen sc1 lds
    v_mfma_f32_16x16x32_bf16 v[92:95], v[56:59], v[28:31], v[92:95]
    ds_read_b64_tr_b16 v[34:35], v8 offset:6400
    s_waitcnt lgkmcnt(6)
    v_mfma_f32_16x16x32_bf16 v[96:99], v[60:63], v[24:27], v[96:99]
    ds_read_b64_tr_b16 v[36:37], v8 offset:5152
    ds_read_b64_tr_b16 v[38:39], v8 offset:6432
    v_mfma_f32_16x16x32_bf16 v[100:103], v[60:63], v[28:31], v[100:103]
    ds_read_b64_tr_b16 v[40:41], v8 offset:5184
    v_mfma_f32_16x16x32_bf16 v[104:107], v[64:67], v[24:27], v[104:107]
    ds_read_b64_tr_b16 v[42:43], v8 offset:6464
    v_mfma_f32_16x16x32_bf16 v[108:111], v[64:67], v[28:31], v[108:111]
    ds_read_b64_tr_b16 v[44:45], v8 offset:5216
    s_waitcnt lgkmcnt(9)
    v_mfma_f32_16x16x32_bf16 v[112:115], v[68:71], v[24:27], v[112:115]
    ds_read_b64_tr_b16 v[46:47], v8 offset:6496
    s_add_u32 m0, s7, 8192
    s_cmp_lt_u32 s52, 2
    s_cselect_b32 s57, s55, s56
    buffer_load_dwordx4 v243, s[24:27], s57 offen sc1 lds
    v_mfma_f32_16x16x32_bf16 v[116:119], v[68:71], v[28:31], v[116:119]
    ds_read_b64_tr_b16 v[48:49], v8 offset:5248
    ds_read_b64_tr_b16 v[50:51], v8 offset:6528
    s_waitcnt lgkmcnt(6)
    v_mfma_f32_16x16x32_bf16 v[80:83], v[32:35], v[16:19], v[80:83]
    ds_read_b128 v[24:27], v11 offset:4096
    v_mfma_f32_16x16x32_bf16 v[84:87], v[32:35], v[20:23], v[84:87]
    ds_read_b128 v[28:31], v11 offset:4352
    v_mfma_f32_16x16x32_bf16 v[88:91], v[36:39], v[16:19], v[88:91]
    ds_read_b64_tr_b16 v[52:53], v8 offset:10240
    v_mfma_f32_16x16x32_bf16 v[92:95], v[36:39], v[20:23], v[92:95]
    ds_read_b64_tr_b16 v[54:55], v8 offset:11520
    s_waitcnt lgkmcnt(6)
    v_mfma_f32_16x16x32_bf16 v[96:99], v[40:43], v[16:19], v[96:99]
    ds_read_b64_tr_b16 v[56:57], v8 offset:10272
    ds_read_b64_tr_b16 v[58:59], v8 offset:11552
    s_add_u32 m0, s6, 0
    s_nop 0
    buffer_load_dwordx4 v244, s[24:27], s56 offen sc1 lds
    v_mfma_f32_16x16x32_bf16 v[100:103], v[40:43], v[20:23], v[100:103]
    ds_read_b64_tr_b16 v[60:61], v8 offset:10304
    v_mfma_f32_16x16x32_bf16 v[104:107], v[44:47], v[16:19], v[104:107]
    ds_read_b64_tr_b16 v[62:63], v8 offset:11584
    v_mfma_f32_16x16x32_bf16 v[108:111], v[44:47], v[20:23], v[108:111]
    ds_read_b64_tr_b16 v[64:65], v8 offset:10336
    s_waitcnt lgkmcnt(9)
    v_mfma_f32_16x16x32_bf16 v[112:115], v[48:51], v[16:19], v[112:115]
    ds_read_b64_tr_b16 v[66:67], v8 offset:11616
    v_mfma_f32_16x16x32_bf16 v[116:119], v[48:51], v[20:23], v[116:119]
    ds_read_b64_tr_b16 v[68:69], v8 offset:10368
    ds_read_b64_tr_b16 v[70:71], v8 offset:11648
    s_waitcnt lgkmcnt(0)
    s_waitcnt vmcnt(4)
    s_barrier
    v_mfma_f32_16x16x32_bf16 v[80:83], v[52:55], v[24:27], v[80:83]
    ds_read_b128 v[16:19], v12 offset:0
    v_mfma_f32_16x16x32_bf16 v[84:87], v[52:55], v[28:31], v[84:87]
    ds_read_b128 v[20:23], v12 offset:256
    v_mfma_f32_16x16x32_bf16 v[88:91], v[56:59], v[24:27], v[88:91]
    ds_read_b64_tr_b16 v[32:33], v9 offset:0
    v_mfma_f32_16x16x32_bf16 v[92:95], v[56:59], v[28:31], v[92:95]
    ds_read_b64_tr_b16 v[34:35], v9 offset:1280
    v_mfma_f32_16x16x32_bf16 v[96:99], v[60:63], v[24:27], v[96:99]
    ds_read_b64_tr_b16 v[36:37], v9 offset:32
    ds_read_b64_tr_b16 v[38:39], v9 offset:1312
    v_mfma_f32_16x16x32_bf16 v[100:103], v[60:63], v[28:31], v[100:103]
    ds_read_b64_tr_b16 v[40:41], v9 offset:64
    s_bfe_u32 s54, s47, 393234
    s_mul_i32 s54, s54, 5120
    s_bfe_u32 s55, s47, 393240
    s_mul_i32 s55, s55, 5120
    s_bfe_u32 s56, s48, 393216
    s_mul_i32 s56, s56, 5120
    s_add_u32 m0, s7, 122880
    s_nop 0
    buffer_load_dwordx4 v241, s[24:27], s54 offen sc1 lds
    v_mfma_f32_16x16x32_bf16 v[104:107], v[64:67], v[24:27], v[104:107]
    ds_read_b64_tr_b16 v[42:43], v9 offset:1344
    v_mfma_f32_16x16x32_bf16 v[108:111], v[64:67], v[28:31], v[108:111]
    ds_read_b64_tr_b16 v[44:45], v9 offset:96
    v_mfma_f32_16x16x32_bf16 v[112:115], v[68:71], v[24:27], v[112:115]
    ds_read_b64_tr_b16 v[46:47], v9 offset:1376
    v_mfma_f32_16x16x32_bf16 v[116:119], v[68:71], v[28:31], v[116:119]
    ds_read_b64_tr_b16 v[48:49], v9 offset:128
    ds_read_b64_tr_b16 v[50:51], v9 offset:1408
    s_waitcnt lgkmcnt(6)
    v_mfma_f32_16x16x32_bf16 v[80:83], v[32:35], v[16:19], v[80:83]
    ds_read_b128 v[24:27], v12 offset:2048
    v_mfma_f32_16x16x32_bf16 v[84:87], v[32:35], v[20:23], v[84:87]
    ds_read_b128 v[28:31], v12 offset:2304
    v_mfma_f32_16x16x32_bf16 v[88:91], v[36:39], v[16:19], v[88:91]
    ds_read_b64_tr_b16 v[52:53], v9 offset:5120
    s_add_u32 m0, s7, 126976
    s_cmp_eq_u32 s52, 0
    s_cselect_b32 s57, s54, s55
    buffer_load_dwordx4 v242, s[24:27], s57 offen sc1 lds
    v_mfma_f32_16x16x32_bf16 v[92:95], v[36:39], v[20:23], v[92:95]
    ds_read_b64_tr_b16 v[54:55], v9 offset:6400
    s_waitcnt lgkmcnt(6)
    v_mfma_f32_16x16x32_bf16 v[96:99], v[40:43], v[16:19], v[96:99]
    ds_read_b64_tr_b16 v[56:57], v9 offset:5152
    ds_read_b64_tr_b16 v[58:59], v9 offset:6432
    v_mfma_f32_16x16x32_bf16 v[100:103], v[40:43], v[20:23], v[100:103]
    ds_read_b64_tr_b16 v[60:61], v9 offset:5184
    v_mfma_f32_16x16x32_bf16 v[104:107], v[44:47], v[16:19], v[104:107]
    ds_read_b64_tr_b16 v[62:63], v9 offset:6464
    v_mfma_f32_16x16x32_bf16 v[108:111], v[44:47], v[20:23], v[108:111]
    ds_read_b64_tr_b16 v[64:65], v9 offset:5216
    s_waitcnt lgkmcnt(9)
    v_mfma_f32_16x16x32_bf16 v[112:115], v[48:51], v[16:19], v[112:115]
    ds_read_b64_tr_b16 v[66:67], v9 offset:6496
    s_add_u32 m0, s7, 131072
    s_cmp_lt_u32 s52, 2
    s_cselect_b32 s57, s55, s56
    buffer_load_dwordx4 v243, s[24:27], s57 offen sc1 lds
    v_mfma_f32_16x16x32_bf16 v[116:119], v[48:51], v[20:23], v[116:119]
    ds_read_b64_tr_b16 v[68:69], v9 offset:5248
    ds_read_b64_tr_b16 v[70:71], v9 offset:6528
    s_waitcnt lgkmcnt(6)
    v_mfma_f32_16x16x32_bf16 v[80:83], v[52:55], v[24:27], v[80:83]
    ds_read_b128 v[16:19], v12 offset:4096
    v_mfma_f32_16x16x32_bf16 v[84:87], v[52:55], v[28:31], v[84:87]
    ds_read_b128 v[20:23], v12 offset:4352
    v_mfma_f32_16x16x32_bf16 v[88:91], v[56:59], v[24:27], v[88:91]
    ds_read_b64_tr_b16 v[32:33], v9 offset:10240
    v_mfma_f32_16x16x32_bf16 v[92:95], v[56:59], v[28:31], v[92:95]
    ds_read_b64_tr_b16 v[34:35], v9 offset:11520
    s_waitcnt lgkmcnt(6)
    v_mfma_f32_16x16x32_bf16 v[96:99], v[60:63], v[24:27], v[96:99]
    ds_read_b64_tr_b16 v[36:37], v9 offset:10272
    ds_read_b64_tr_b16 v[38:39], v9 offset:11552
    s_add_u32 m0, s6, 122880
    s_nop 0
    buffer_load_dwordx4 v244, s[24:27], s56 offen sc1 lds
    v_mfma_f32_16x16x32_bf16 v[100:103], v[60:63], v[28:31], v[100:103]
    ds_read_b64_tr_b16 v[40:41], v9 offset:10304
    v_mfma_f32_16x16x32_bf16 v[104:107], v[64:67], v[24:27], v[104:107]
    ds_read_b64_tr_b16 v[42:43], v9 offset:11584
    v_mfma_f32_16x16x32_bf16 v[108:111], v[64:67], v[28:31], v[108:111]
    ds_read_b64_tr_b16 v[44:45], v9 offset:10336
    s_waitcnt lgkmcnt(9)
    v_mfma_f32_16x16x32_bf16 v[112:115], v[68:71], v[24:27], v[112:115]
    ds_read_b64_tr_b16 v[46:47], v9 offset:11616
    v_mfma_f32_16x16x32_bf16 v[116:119], v[68:71], v[28:31], v[116:119]
    ds_read_b64_tr_b16 v[48:49], v9 offset:10368
    ds_read_b64_tr_b16 v[50:51], v9 offset:11648
    s_waitcnt lgkmcnt(0)
    s_waitcnt vmcnt(4)
    s_barrier
    v_mfma_f32_16x16x32_bf16 v[80:83], v[32:35], v[16:19], v[80:83]
    ds_read_b128 v[24:27], v13 offset:0
    v_mfma_f32_16x16x32_bf16 v[84:87], v[32:35], v[20:23], v[84:87]
    ds_read_b128 v[28:31], v13 offset:256
    v_mfma_f32_16x16x32_bf16 v[88:91], v[36:39], v[16:19], v[88:91]
    ds_read_b64_tr_b16 v[52:53], v10 offset:0
    v_mfma_f32_16x16x32_bf16 v[92:95], v[36:39], v[20:23], v[92:95]
    ds_read_b64_tr_b16 v[54:55], v10 offset:1280
    v_mfma_f32_16x16x32_bf16 v[96:99], v[40:43], v[16:19], v[96:99]
    ds_read_b64_tr_b16 v[56:57], v10 offset:32
    ds_read_b64_tr_b16 v[58:59], v10 offset:1312
    v_mfma_f32_16x16x32_bf16 v[100:103], v[40:43], v[20:23], v[100:103]
    ds_read_b64_tr_b16 v[60:61], v10 offset:64
    s_bfe_u32 s54, s48, 393222
    s_mul_i32 s54, s54, 5120
    s_bfe_u32 s55, s48, 393228
    s_mul_i32 s55, s55, 5120
    s_bfe_u32 s56, s48, 393234
    s_mul_i32 s56, s56, 5120
    s_add_u32 m0, s7, 81920
    s_nop 0
    buffer_load_dwordx4 v241, s[24:27], s54 offen sc1 lds
    v_mfma_f32_16x16x32_bf16 v[104:107], v[44:47], v[16:19], v[104:107]
    ds_read_b64_tr_b16 v[62:63], v10 offset:1344
    v_mfma_f32_16x16x32_bf16 v[108:111], v[44:47], v[20:23], v[108:111]
    ds_read_b64_tr_b16 v[64:65], v10 offset:96
    v_mfma_f32_16x16x32_bf16 v[112:115], v[48:51], v[16:19], v[112:115]
    ds_read_b64_tr_b16 v[66:67], v10 offset:1376
    v_mfma_f32_16x16x32_bf16 v[116:119], v[48:51], v[20:23], v[116:119]
    ds_read_b64_tr_b16 v[68:69], v10 offset:128
    ds_read_b64_tr_b16 v[70:71], v10 offset:1408
    s_waitcnt lgkmcnt(6)
    v_mfma_f32_16x16x32_bf16 v[80:83], v[52:55], v[24:27], v[80:83]
    ds_read_b128 v[16:19], v13 offset:2048
    v_mfma_f32_16x16x32_bf16 v[84:87], v[52:55], v[28:31], v[84:87]
    ds_read_b128 v[20:23], v13 offset:2304
    v_mfma_f32_16x16x32_bf16 v[88:91], v[56:59], v[24:27], v[88:91]
    ds_read_b64_tr_b16 v[32:33], v10 offset:5120
    s_add_u32 m0, s7, 86016
    s_cmp_eq_u32 s52, 0
    s_cselect_b32 s57, s54, s55
    buffer_load_dwordx4 v242, s[24:27], s57 offen sc1 lds
    v_mfma_f32_16x16x32_bf16 v[92:95], v[56:59], v[28:31], v[92:95]
    ds_read_b64_tr_b16 v[34:35], v10 offset:6400
    s_waitcnt lgkmcnt(6)
    v_mfma_f32_16x16x32_bf16 v[96:99], v[60:63], v[24:27], v[96:99]
    ds_read_b64_tr_b16 v[36:37], v10 offset:5152
    ds_read_b64_tr_b16 v[38:39], v10 offset:6432
    v_mfma_f32_16x16x32_bf16 v[100:103], v[60:63], v[28:31], v[100:103]
    ds_read_b64_tr_b16 v[40:41], v10 offset:5184
    v_mfma_f32_16x16x32_bf16 v[104:107], v[64:67], v[24:27], v[104:107]
    ds_read_b64_tr_b16 v[42:43], v10 offset:6464
    v_mfma_f32_16x16x32_bf16 v[108:111], v[64:67], v[28:31], v[108:111]
    ds_read_b64_tr_b16 v[44:45], v10 offset:5216
    s_waitcnt lgkmcnt(9)
    v_mfma_f32_16x16x32_bf16 v[112:115], v[68:71], v[24:27], v[112:115]
    ds_read_b64_tr_b16 v[46:47], v10 offset:6496
    s_add_u32 m0, s7, 90112
    s_cmp_lt_u32 s52, 2
    s_cselect_b32 s57, s55, s56
    buffer_load_dwordx4 v243, s[24:27], s57 offen sc1 lds
    v_mfma_f32_16x16x32_bf16 v[116:119], v[68:71], v[28:31], v[116:119]
    ds_read_b64_tr_b16 v[48:49], v10 offset:5248
    ds_read_b64_tr_b16 v[50:51], v10 offset:6528
    s_waitcnt lgkmcnt(6)
    v_mfma_f32_16x16x32_bf16 v[80:83], v[32:35], v[16:19], v[80:83]
    ds_read_b128 v[24:27], v13 offset:4096
    v_mfma_f32_16x16x32_bf16 v[84:87], v[32:35], v[20:23], v[84:87]
    ds_read_b128 v[28:31], v13 offset:4352
    v_mfma_f32_16x16x32_bf16 v[88:91], v[36:39], v[16:19], v[88:91]
    ds_read_b64_tr_b16 v[52:53], v10 offset:10240
    v_mfma_f32_16x16x32_bf16 v[92:95], v[36:39], v[20:23], v[92:95]
    ds_read_b64_tr_b16 v[54:55], v10 offset:11520
    s_waitcnt lgkmcnt(6)
    v_mfma_f32_16x16x32_bf16 v[96:99], v[40:43], v[16:19], v[96:99]
    ds_read_b64_tr_b16 v[56:57], v10 offset:10272
    ds_read_b64_tr_b16 v[58:59], v10 offset:11552
    s_add_u32 m0, s6, 81920
    s_nop 0
    buffer_load_dwordx4 v244, s[24:27], s56 offen sc1 lds
    v_mfma_f32_16x16x32_bf16 v[100:103], v[40:43], v[20:23], v[100:103]
    ds_read_b64_tr_b16 v[60:61], v10 offset:10304
    v_mfma_f32_16x16x32_bf16 v[104:107], v[44:47], v[16:19], v[104:107]
    ds_read_b64_tr_b16 v[62:63], v10 offset:11584
    v_mfma_f32_16x16x32_bf16 v[108:111], v[44:47], v[20:23], v[108:111]
    ds_read_b64_tr_b16 v[64:65], v10 offset:10336
    s_waitcnt lgkmcnt(9)
    v_mfma_f32_16x16x32_bf16 v[112:115], v[48:51], v[16:19], v[112:115]
    ds_read_b64_tr_b16 v[66:67], v10 offset:11616
    v_mfma_f32_16x16x32_bf16 v[116:119], v[48:51], v[20:23], v[116:119]
    ds_read_b64_tr_b16 v[68:69], v10 offset:10368
    ds_read_b64_tr_b16 v[70:71], v10 offset:11648
    s_waitcnt lgkmcnt(0)
    s_waitcnt vmcnt(4)
    s_barrier
    v_mfma_f32_16x16x32_bf16 v[80:83], v[52:55], v[24:27], v[80:83]
    ds_read_b128 v[16:19], v11 offset:0
    v_mfma_f32_16x16x32_bf16 v[84:87], v[52:55], v[28:31], v[84:87]
    ds_read_b128 v[20:23], v11 offset:256
    v_mfma_f32_16x16x32_bf16 v[88:91], v[56:59], v[24:27], v[88:91]
    ds_read_b64_tr_b16 v[32:33], v8 offset:0
    v_mfma_f32_16x16x32_bf16 v[92:95], v[56:59], v[28:31], v[92:95]
    ds_read_b64_tr_b16 v[34:35], v8 offset:1280
    v_mfma_f32_16x16x32_bf16 v[96:99], v[60:63], v[24:27], v[96:99]
    ds_read_b64_tr_b16 v[36:37], v8 offset:32
    ds_read_b64_tr_b16 v[38:39], v8 offset:1312
    v_mfma_f32_16x16x32_bf16 v[100:103], v[60:63], v[28:31], v[100:103]
    ds_read_b64_tr_b16 v[40:41], v8 offset:64
    s_bfe_u32 s54, s48, 393240
    s_mul_i32 s54, s54, 5120
    s_bfe_u32 s55, s49, 393216
    s_mul_i32 s55, s55, 5120
    s_bfe_u32 s56, s49, 393222
    s_mul_i32 s56, s56, 5120
    s_add_u32 m0, s7, 0
    s_nop 0
    buffer_load_dwordx4 v241, s[24:27], s54 offen sc1 lds
    v_mfma_f32_16x16x32_bf16 v[104:107], v[64:67], v[24:27], v[104:107]
    ds_read_b64_tr_b16 v[42:43], v8 offset:1344
    v_mfma_f32_16x16x32_bf16 v[108:111], v[64:67], v[28:31], v[108:111]
    ds_read_b64_tr_b16 v[44:45], v8 offset:96
    v_mfma_f32_16x16x32_bf16 v[112:115], v[68:71], v[24:27], v[112:115]
    ds_read_b64_tr_b16 v[46:47], v8 offset:1376
    v_mfma_f32_16x16x32_bf16 v[116:119], v[68:71], v[28:31], v[116:119]
    ds_read_b64_tr_b16 v[48:49], v8 offset:128
    ds_read_b64_tr_b16 v[50:51], v8 offset:1408
    s_waitcnt lgkmcnt(6)
    v_mfma_f32_16x16x32_bf16 v[80:83], v[32:35], v[16:19], v[80:83]
    ds_read_b128 v[24:27], v11 offset:2048
    v_mfma_f32_16x16x32_bf16 v[84:87], v[32:35], v[20:23], v[84:87]
    ds_read_b128 v[28:31], v11 offset:2304
    v_mfma_f32_16x16x32_bf16 v[88:91], v[36:39], v[16:19], v[88:91]
    ds_read_b64_tr_b16 v[52:53], v8 offset:5120
    s_add_u32 m0, s7, 4096
    s_cmp_eq_u32 s52, 0
    s_cselect_b32 s57, s54, s55
    buffer_load_dwordx4 v242, s[24:27], s57 offen sc1 lds
    v_mfma_f32_16x16x32_bf16 v[92:95], v[36:39], v[20:23], v[92:95]
    ds_read_b64_tr_b16 v[54:55], v8 offset:6400
    s_waitcnt lgkmcnt(6)
    v_mfma_f32_16x16x32_bf16 v[96:99], v[40:43], v[16:19], v[96:99]
    ds_read_b64_tr_b16 v[56:57], v8 offset:5152
    ds_read_b64_tr_b16 v[58:59], v8 offset:6432
    v_mfma_f32_16x16x32_bf16 v[100:103], v[40:43], v[20:23], v[100:103]
    ds_read_b64_tr_b16 v[60:61], v8 offset:5184
    v_mfma_f32_16x16x32_bf16 v[104:107], v[44:47], v[16:19], v[104:107]
    ds_read_b64_tr_b16 v[62:63], v8 offset:6464
    v_mfma_f32_16x16x32_bf16 v[108:111], v[44:47], v[20:23], v[108:111]
    ds_read_b64_tr_b16 v[64:65], v8 offset:5216
    s_waitcnt lgkmcnt(9)
    v_mfma_f32_16x16x32_bf16 v[112:115], v[48:51], v[16:19], v[112:115]
    ds_read_b64_tr_b16 v[66:67], v8 offset:6496
    s_add_u32 m0, s7, 8192
    s_cmp_lt_u32 s52, 2
    s_cselect_b32 s57, s55, s56
    buffer_load_dwordx4 v243, s[24:27], s57 offen sc1 lds
    v_mfma_f32_16x16x32_bf16 v[116:119], v[48:51], v[20:23], v[116:119]
    ds_read_b64_tr_b16 v[68:69], v8 offset:5248
    ds_read_b64_tr_b16 v[70:71], v8 offset:6528
    s_waitcnt lgkmcnt(6)
    v_mfma_f32_16x16x32_bf16 v[80:83], v[52:55], v[24:27], v[80:83]
    ds_read_b128 v[16:19], v11 offset:4096
    v_mfma_f32_16x16x32_bf16 v[84:87], v[52:55], v[28:31], v[84:87]
    ds_read_b128 v[20:23], v11 offset:4352
    v_mfma_f32_16x16x32_bf16 v[88:91], v[56:59], v[24:27], v[88:91]
    ds_read_b64_tr_b16 v[32:33], v8 offset:10240
    v_mfma_f32_16x16x32_bf16 v[92:95], v[56:59], v[28:31], v[92:95]
    ds_read_b64_tr_b16 v[34:35], v8 offset:11520
    s_waitcnt lgkmcnt(6)
    v_mfma_f32_16x16x32_bf16 v[96:99], v[60:63], v[24:27], v[96:99]
    ds_read_b64_tr_b16 v[36:37], v8 offset:10272
    ds_read_b64_tr_b16 v[38:39], v8 offset:11552
    s_add_u32 m0, s6, 0
    s_nop 0
    buffer_load_dwordx4 v244, s[24:27], s56 offen sc1 lds
    v_mfma_f32_16x16x32_bf16 v[100:103], v[60:63], v[28:31], v[100:103]
    ds_read_b64_tr_b16 v[40:41], v8 offset:10304
    v_mfma_f32_16x16x32_bf16 v[104:107], v[64:67], v[24:27], v[104:107]
    ds_read_b64_tr_b16 v[42:43], v8 offset:11584
    v_mfma_f32_16x16x32_bf16 v[108:111], v[64:67], v[28:31], v[108:111]
    ds_read_b64_tr_b16 v[44:45], v8 offset:10336
    s_waitcnt lgkmcnt(9)
    v_mfma_f32_16x16x32_bf16 v[112:115], v[68:71], v[24:27], v[112:115]
    ds_read_b64_tr_b16 v[46:47], v8 offset:11616
    v_mfma_f32_16x16x32_bf16 v[116:119], v[68:71], v[28:31], v[116:119]
    ds_read_b64_tr_b16 v[48:49], v8 offset:10368
    ds_read_b64_tr_b16 v[50:51], v8 offset:11648
    s_waitcnt lgkmcnt(0)
    s_waitcnt vmcnt(4)
    s_barrier
    v_mfma_f32_16x16x32_bf16 v[80:83], v[32:35], v[16:19], v[80:83]
    ds_read_b128 v[24:27], v12 offset:0
    v_mfma_f32_16x16x32_bf16 v[84:87], v[32:35], v[20:23], v[84:87]
    ds_read_b128 v[28:31], v12 offset:256
    v_mfma_f32_16x16x32_bf16 v[88:91], v[36:39], v[16:19], v[88:91]
    ds_read_b64_tr_b16 v[52:53], v9 offset:0
    v_mfma_f32_16x16x32_bf16 v[92:95], v[36:39], v[20:23], v[92:95]
    ds_read_b64_tr_b16 v[54:55], v9 offset:1280
    v_mfma_f32_16x16x32_bf16 v[96:99], v[40:43], v[16:19], v[96:99]
    ds_read_b64_tr_b16 v[56:57], v9 offset:32
    ds_read_b64_tr_b16 v[58:59], v9 offset:1312
    v_mfma_f32_16x16x32_bf16 v[100:103], v[40:43], v[20:23], v[100:103]
    ds_read_b64_tr_b16 v[60:61], v9 offset:64
    v_mfma_f32_16x16x32_bf16 v[104:107], v[44:47], v[16:19], v[104:107]
    ds_read_b64_tr_b16 v[62:63], v9 offset:1344
    v_mfma_f32_16x16x32_bf16 v[108:111], v[44:47], v[20:23], v[108:111]
    ds_read_b64_tr_b16 v[64:65], v9 offset:96
    v_mfma_f32_16x16x32_bf16 v[112:115], v[48:51], v[16:19], v[112:115]
    ds_read_b64_tr_b16 v[66:67], v9 offset:1376
    v_mfma_f32_16x16x32_bf16 v[116:119], v[48:51], v[20:23], v[116:119]
    ds_read_b64_tr_b16 v[68:69], v9 offset:128
    ds_read_b64_tr_b16 v[70:71], v9 offset:1408
    s_waitcnt lgkmcnt(6)
    v_mfma_f32_16x16x32_bf16 v[80:83], v[52:55], v[24:27], v[80:83]
    ds_read_b128 v[16:19], v12 offset:2048
    v_mfma_f32_16x16x32_bf16 v[84:87], v[52:55], v[28:31], v[84:87]
    ds_read_b128 v[20:23], v12 offset:2304
    v_mfma_f32_16x16x32_bf16 v[88:91], v[56:59], v[24:27], v[88:91]
    ds_read_b64_tr_b16 v[32:33], v9 offset:5120
    v_mfma_f32_16x16x32_bf16 v[92:95], v[56:59], v[28:31], v[92:95]
    ds_read_b64_tr_b16 v[34:35], v9 offset:6400
    s_waitcnt lgkmcnt(6)
    v_mfma_f32_16x16x32_bf16 v[96:99], v[60:63], v[24:27], v[96:99]
    ds_read_b64_tr_b16 v[36:37], v9 offset:5152
    ds_read_b64_tr_b16 v[38:39], v9 offset:6432
    v_mfma_f32_16x16x32_bf16 v[100:103], v[60:63], v[28:31], v[100:103]
    ds_read_b64_tr_b16 v[40:41], v9 offset:5184
    v_mfma_f32_16x16x32_bf16 v[104:107], v[64:67], v[24:27], v[104:107]
    ds_read_b64_tr_b16 v[42:43], v9 offset:6464
    v_mfma_f32_16x16x32_bf16 v[108:111], v[64:67], v[28:31], v[108:111]
    ds_read_b64_tr_b16 v[44:45], v9 offset:5216
    s_waitcnt lgkmcnt(9)
    v_mfma_f32_16x16x32_bf16 v[112:115], v[68:71], v[24:27], v[112:115]
    ds_read_b64_tr_b16 v[46:47], v9 offset:6496
    v_mfma_f32_16x16x32_bf16 v[116:119], v[68:71], v[28:31], v[116:119]
    ds_read_b64_tr_b16 v[48:49], v9 offset:5248
    ds_read_b64_tr_b16 v[50:51], v9 offset:6528
    s_waitcnt lgkmcnt(6)
    v_mfma_f32_16x16x32_bf16 v[80:83], v[32:35], v[16:19], v[80:83]
    ds_read_b128 v[24:27], v12 offset:4096
    v_mfma_f32_16x16x32_bf16 v[84:87], v[32:35], v[20:23], v[84:87]
    ds_read_b128 v[28:31], v12 offset:4352
    v_mfma_f32_16x16x32_bf16 v[88:91], v[36:39], v[16:19], v[88:91]
    ds_read_b64_tr_b16 v[52:53], v9 offset:10240
    v_mfma_f32_16x16x32_bf16 v[92:95], v[36:39], v[20:23], v[92:95]
    ds_read_b64_tr_b16 v[54:55], v9 offset:11520
    s_waitcnt lgkmcnt(6)
    v_mfma_f32_16x16x32_bf16 v[96:99], v[40:43], v[16:19], v[96:99]
    ds_read_b64_tr_b16 v[56:57], v9 offset:10272
    ds_read_b64_tr_b16 v[58:59], v9 offset:11552
    v_mfma_f32_16x16x32_bf16 v[100:103], v[40:43], v[20:23], v[100:103]
    ds_read_b64_tr_b16 v[60:61], v9 offset:10304
    v_mfma_f32_16x16x32_bf16 v[104:107], v[44:47], v[16:19], v[104:107]
    ds_read_b64_tr_b16 v[62:63], v9 offset:11584
    v_mfma_f32_16x16x32_bf16 v[108:111], v[44:47], v[20:23], v[108:111]
    ds_read_b64_tr_b16 v[64:65], v9 offset:10336
    s_waitcnt lgkmcnt(9)
    v_mfma_f32_16x16x32_bf16 v[112:115], v[48:51], v[16:19], v[112:115]
    ds_read_b64_tr_b16 v[66:67], v9 offset:11616
    v_mfma_f32_16x16x32_bf16 v[116:119], v[48:51], v[20:23], v[116:119]
    ds_read_b64_tr_b16 v[68:69], v9 offset:10368
    ds_read_b64_tr_b16 v[70:71], v9 offset:11648
    s_waitcnt lgkmcnt(0)
    s_waitcnt vmcnt(0)
    s_barrier
    v_mfma_f32_16x16x32_bf16 v[80:83], v[52:55], v[24:27], v[80:83]
    ds_read_b128 v[16:19], v13 offset:0
    v_mfma_f32_16x16x32_bf16 v[84:87], v[52:55], v[28:31], v[84:87]
    ds_read_b128 v[20:23], v13 offset:256
    v_mfma_f32_16x16x32_bf16 v[88:91], v[56:59], v[24:27], v[88:91]
    ds_read_b64_tr_b16 v[32:33], v10 offset:0
    v_mfma_f32_16x16x32_bf16 v[92:95], v[56:59], v[28:31], v[92:95]
    ds_read_b64_tr_b16 v[34:35], v10 offset:1280
    v_mfma_f32_16x16x32_bf16 v[96:99], v[60:63], v[24:27], v[96:99]
    ds_read_b64_tr_b16 v[36:37], v10 offset:32
    ds_read_b64_tr_b16 v[38:39], v10 offset:1312
    v_mfma_f32_16x16x32_bf16 v[100:103], v[60:63], v[28:31], v[100:103]
    ds_read_b64_tr_b16 v[40:41], v10 offset:64
    v_mfma_f32_16x16x32_bf16 v[104:107], v[64:67], v[24:27], v[104:107]
    ds_read_b64_tr_b16 v[42:43], v10 offset:1344
    v_mfma_f32_16x16x32_bf16 v[108:111], v[64:67], v[28:31], v[108:111]
    ds_read_b64_tr_b16 v[44:45], v10 offset:96
    v_mfma_f32_16x16x32_bf16 v[112:115], v[68:71], v[24:27], v[112:115]
    ds_read_b64_tr_b16 v[46:47], v10 offset:1376
    v_mfma_f32_16x16x32_bf16 v[116:119], v[68:71], v[28:31], v[116:119]
    ds_read_b64_tr_b16 v[48:49], v10 offset:128
    ds_read_b64_tr_b16 v[50:51], v10 offset:1408
    s_waitcnt lgkmcnt(6)
    v_mfma_f32_16x16x32_bf16 v[80:83], v[32:35], v[16:19], v[80:83]
    ds_read_b128 v[24:27], v13 offset:2048
    v_mfma_f32_16x16x32_bf16 v[84:87], v[32:35], v[20:23], v[84:87]
    ds_read_b128 v[28:31], v13 offset:2304
    v_mfma_f32_16x16x32_bf16 v[88:91], v[36:39], v[16:19], v[88:91]
    ds_read_b64_tr_b16 v[52:53], v10 offset:5120
    v_mfma_f32_16x16x32_bf16 v[92:95], v[36:39], v[20:23], v[92:95]
    ds_read_b64_tr_b16 v[54:55], v10 offset:6400
    s_waitcnt lgkmcnt(6)
    v_mfma_f32_16x16x32_bf16 v[96:99], v[40:43], v[16:19], v[96:99]
    ds_read_b64_tr_b16 v[56:57], v10 offset:5152
    ds_read_b64_tr_b16 v[58:59], v10 offset:6432
    v_mfma_f32_16x16x32_bf16 v[100:103], v[40:43], v[20:23], v[100:103]
    ds_read_b64_tr_b16 v[60:61], v10 offset:5184
    v_mfma_f32_16x16x32_bf16 v[104:107], v[44:47], v[16:19], v[104:107]
    ds_read_b64_tr_b16 v[62:63], v10 offset:6464
    v_mfma_f32_16x16x32_bf16 v[108:111], v[44:47], v[20:23], v[108:111]
    ds_read_b64_tr_b16 v[64:65], v10 offset:5216
    s_waitcnt lgkmcnt(9)
    v_mfma_f32_16x16x32_bf16 v[112:115], v[48:51], v[16:19], v[112:115]
    ds_read_b64_tr_b16 v[66:67], v10 offset:6496
    v_mfma_f32_16x16x32_bf16 v[116:119], v[48:51], v[20:23], v[116:119]
    ds_read_b64_tr_b16 v[68:69], v10 offset:5248
    ds_read_b64_tr_b16 v[70:71], v10 offset:6528
    s_waitcnt lgkmcnt(6)
    v_mfma_f32_16x16x32_bf16 v[80:83], v[52:55], v[24:27], v[80:83]
    ds_read_b128 v[16:19], v13 offset:4096
    v_mfma_f32_16x16x32_bf16 v[84:87], v[52:55], v[28:31], v[84:87]
    ds_read_b128 v[20:23], v13 offset:4352
    v_mfma_f32_16x16x32_bf16 v[88:91], v[56:59], v[24:27], v[88:91]
    ds_read_b64_tr_b16 v[32:33], v10 offset:10240
    v_mfma_f32_16x16x32_bf16 v[92:95], v[56:59], v[28:31], v[92:95]
    ds_read_b64_tr_b16 v[34:35], v10 offset:11520
    s_waitcnt lgkmcnt(6)
    v_mfma_f32_16x16x32_bf16 v[96:99], v[60:63], v[24:27], v[96:99]
    ds_read_b64_tr_b16 v[36:37], v10 offset:10272
    ds_read_b64_tr_b16 v[38:39], v10 offset:11552
    v_mfma_f32_16x16x32_bf16 v[100:103], v[60:63], v[28:31], v[100:103]
    ds_read_b64_tr_b16 v[40:41], v10 offset:10304
    v_mfma_f32_16x16x32_bf16 v[104:107], v[64:67], v[24:27], v[104:107]
    ds_read_b64_tr_b16 v[42:43], v10 offset:11584
    v_mfma_f32_16x16x32_bf16 v[108:111], v[64:67], v[28:31], v[108:111]
    ds_read_b64_tr_b16 v[44:45], v10 offset:10336
    s_waitcnt lgkmcnt(9)
    v_mfma_f32_16x16x32_bf16 v[112:115], v[68:71], v[24:27], v[112:115]
    ds_read_b64_tr_b16 v[46:47], v10 offset:11616
    v_mfma_f32_16x16x32_bf16 v[116:119], v[68:71], v[28:31], v[116:119]
    ds_read_b64_tr_b16 v[48:49], v10 offset:10368
    ds_read_b64_tr_b16 v[50:51], v10 offset:11648
    s_waitcnt lgkmcnt(6)
    v_mfma_f32_16x16x32_bf16 v[80:83], v[32:35], v[16:19], v[80:83]
    v_mfma_f32_16x16x32_bf16 v[84:87], v[32:35], v[20:23], v[84:87]
    v_mfma_f32_16x16x32_bf16 v[88:91], v[36:39], v[16:19], v[88:91]
    v_mfma_f32_16x16x32_bf16 v[92:95], v[36:39], v[20:23], v[92:95]
    s_waitcnt lgkmcnt(2)
    v_mfma_f32_16x16x32_bf16 v[96:99], v[40:43], v[16:19], v[96:99]
    v_mfma_f32_16x16x32_bf16 v[100:103], v[40:43], v[20:23], v[100:103]
    v_mfma_f32_16x16x32_bf16 v[104:107], v[44:47], v[16:19], v[104:107]
    v_mfma_f32_16x16x32_bf16 v[108:111], v[44:47], v[20:23], v[108:111]
    s_waitcnt lgkmcnt(0)
    v_mfma_f32_16x16x32_bf16 v[112:115], v[48:51], v[16:19], v[112:115]
    v_mfma_f32_16x16x32_bf16 v[116:119], v[48:51], v[20:23], v[116:119]
    s_cmp_eq_u32 s38, 0
    s_cbranch_scc1 L_keep
    v_cvt_pk_bf16_f32 v16, v80, v81
    v_cvt_pk_bf16_f32 v17, v82, v83
    v_cvt_pk_bf16_f32 v18, v88, v89
    v_cvt_pk_bf16_f32 v19, v90, v91
    v_cvt_pk_bf16_f32 v20, v96, v97
    v_cvt_pk_bf16_f32 v21, v98, v99
    v_cvt_pk_bf16_f32 v22, v104, v105
    v_cvt_pk_bf16_f32 v23, v106, v107
    v_cvt_pk_bf16_f32 v24, v112, v113
    v_cvt_pk_bf16_f32 v25, v114, v115
    buffer_store_dwordx4 v[16:19], v5, s[24:27], s41 offen offset:0 sc1
    buffer_store_dwordx4 v[20:23], v5, s[24:27], s41 offen offset:1024 sc1
    buffer_store_dwordx4 v[24:27], v5, s[24:27], s41 offen offset:2048 sc1
    s_add_u32 s41, s41, 3072
    v_cvt_pk_bf16_f32 v28, v84, v85
    v_cvt_pk_bf16_f32 v29, v86, v87
    v_cvt_pk_bf16_f32 v30, v92, v93
    v_cvt_pk_bf16_f32 v31, v94, v95
    v_cvt_pk_bf16_f32 v32, v100, v101
    v_cvt_pk_bf16_f32 v33, v102, v103
    v_cvt_pk_bf16_f32 v34, v108, v109
    v_cvt_pk_bf16_f32 v35, v110, v111
    v_cvt_pk_bf16_f32 v36, v116, v117
    v_cvt_pk_bf16_f32 v37, v118, v119
    buffer_store_dwordx4 v[28:31], v5, s[24:27], s41 offen offset:0 sc1
    buffer_store_dwordx4 v[32:35], v5, s[24:27], s41 offen offset:1024 sc1
    buffer_store_dwordx4 v[36:39], v5, s[24:27], s41 offen offset:2048 sc1
    s_barrier
    ds_read_b128 v[80:83], v14 offset:0
    ds_read_b128 v[88:91], v14 offset:1024
    ds_read_b128 v[96:99], v14 offset:2048
    ds_read_b128 v[104:107], v14 offset:3072
    ds_read_b128 v[112:115], v14 offset:4096
    s_waitcnt vmcnt(0)
    s_or_b32 s57, s3, 5
    v_mov_b32 v6, s57
    v_mov_b32 v7, 0
    s_mov_b64 exec, 1
    buffer_store_dword v6, v7, s[24:27], s40 offen sc1
    s_mov_b64 exec, -1
    s_branch L_kept
L_keep:
    s_nop 7
    ds_write_b128 v14, v[84:87] offset:0
    ds_write_b128 v14, v[92:95] offset:1024
    ds_write_b128 v14, v[100:103] offset:2048
    ds_write_b128 v14, v[108:111] offset:3072
    ds_write_b128 v14, v[116:119] offset:4096
    s_waitcnt lgkmcnt(0)
    s_barrier
L_kept:
    s_add_u32 s8, s24, s34
    s_addc_u32 s9, s25, 0
    s_load_dword s10, s[8:9], 0 glc
    v_mov_b32 v6, 0x3f80
    v_mov_b32 v7, 0x3f800000
    s_waitcnt lgkmcnt(0)
    v_dot2c_f32_bf16 v80, v196, v6
    v_dot2c_f32_bf16 v81, v196, v7
    v_dot2c_f32_bf16 v82, v197, v6
    v_dot2c_f32_bf16 v83, v197, v7
    v_dot2c_f32_bf16 v88, v198, v6
    v_dot2c_f32_bf16 v89, v198, v7
    v_dot2c_f32_bf16 v90, v199, v6
    v_dot2c_f32_bf16 v91, v199, v7
    v_dot2c_f32_bf16 v96, v200, v6
    v_dot2c_f32_bf16 v97, v200, v7
    v_dot2c_f32_bf16 v98, v201, v6
    v_dot2c_f32_bf16 v99, v201, v7
    v_dot2c_f32_bf16 v104, v202, v6
    v_dot2c_f32_bf16 v105, v202, v7
    v_dot2c_f32_bf16 v106, v203, v6
    v_dot2c_f32_bf16 v107, v203, v7
    v_dot2c_f32_bf16 v112, v204, v6
    v_dot2c_f32_bf16 v113, v204, v7
    v_dot2c_f32_bf16 v114, v205, v6
    v_dot2c_f32_bf16 v115, v205, v7
    s_mov_b32 s56, 0
    s_add_u32 s57, s3, 5
Lsp_13:
    s_waitcnt lgkmcnt(0)
    s_sub_u32 s10, s10, s57
    s_cmp_le_u32 s10, 2
    s_cbranch_scc1 Lsp_13d
    s_add_u32 s56, s56, 1
    s_cmp_ge_u32 s56, 40000
    s_cbranch_scc1 Lsp_13d
    s_sleep 2
    s_load_dword s10, s[8:9], 0 glc
    s_branch Lsp_13
Lsp_13d:
    buffer_load_dwordx4 v[212:215], v5, s[24:27], s35 offen offset:0 sc1
    buffer_load_dwordx4 v[216:219], v5, s[24:27], s35 offen offset:1024 sc1
    buffer_load_dwordx4 v[220:223], v5, s[24:27], s35 offen offset:2048 sc1
    s_barrier
    ds_read_b128 v[16:19], v208 offset:0
    ds_read_b64 v[40:41], v209 offset:0
    ds_read_b128 v[20:23], v208 offset:64
    ds_read_b64 v[42:43], v209 offset:32
    ds_read_b128 v[24:27], v208 offset:128
    ds_read_b64 v[44:45], v209 offset:64
    ds_read_b128 v[28:31], v208 offset:192
    ds_read_b64 v[46:47], v209 offset:96
    ds_read_b128 v[32:35], v208 offset:256
    ds_read_b64 v[48:49], v209 offset:128
    s_waitcnt lgkmcnt(0)
    v_lshlrev_b32 v56, 16, v40
    v_and_b32 v57, 0xffff0000, v40
    v_lshlrev_b32 v58, 16, v41
    v_and_b32 v59, 0xffff0000, v41
    v_lshlrev_b32 v60, 16, v42
    v_and_b32 v61, 0xffff0000, v42
    v_lshlrev_b32 v62, 16, v43
    v_and_b32 v63, 0xffff0000, v43
    v_lshlrev_b32 v64, 16, v44
    v_and_b32 v65, 0xffff0000, v44
    v_lshlrev_b32 v66, 16, v45
    v_and_b32 v67, 0xffff0000, v45
    v_lshlrev_b32 v68, 16, v46
    v_and_b32 v69, 0xffff0000, v46
    v_lshlrev_b32 v70, 16, v47
    v_and_b32 v71, 0xffff0000, v47
    v_lshlrev_b32 v72, 16, v48
    v_and_b32 v73, 0xffff0000, v48
    v_lshlrev_b32 v74, 16, v49
    v_and_b32 v75, 0xffff0000, v49
    s_waitcnt vmcnt(2)
    v_dot2c_f32_bf16 v80, v212, v6
    v_dot2c_f32_bf16 v81, v212, v7
    v_dot2c_f32_bf16 v82, v213, v6
    v_dot2c_f32_bf16 v83, v213, v7
    v_dot2c_f32_bf16 v88, v214, v6
    v_dot2c_f32_bf16 v89, v214, v7
    v_dot2c_f32_bf16 v90, v215, v6
    v_dot2c_f32_bf16 v91, v215, v7
    s_waitcnt vmcnt(1)
    v_dot2c_f32_bf16 v96, v216, v6
    v_dot2c_f32_bf16 v97, v216, v7
    v_dot2c_f32_bf16 v98, v217, v6
    v_dot2c_f32_bf16 v99, v217, v7
    v_dot2c_f32_bf16 v104, v218, v6
    v_dot2c_f32_bf16 v105, v218, v7
    v_dot2c_f32_bf16 v106, v219, v6
    v_dot2c_f32_bf16 v107, v219, v7
    s_waitcnt vmcnt(0)
    v_dot2c_f32_bf16 v112, v220, v6
    v_dot2c_f32_bf16 v113, v220, v7
    v_dot2c_f32_bf16 v114, v221, v6
    v_dot2c_f32_bf16 v115, v221, v7
    v_mul_f32 v128, 0xbfb8aa3b, v80
    v_mul_f32 v129, 0xbfb8aa3b, v81
    v_mul_f32 v130, 0xbfb8aa3b, v82
    v_mul_f32 v131, 0xbfb8aa3b, v83
    v_mul_f32 v132, 0xbfb8aa3b, v88
    v_mul_f32 v133, 0xbfb8aa3b, v89
    v_mul_f32 v134, 0xbfb8aa3b, v90
    v_mul_f32 v135, 0xbfb8aa3b, v91
    v_mul_f32 v136, 0xbfb8aa3b, v96
    v_mul_f32 v137, 0xbfb8aa3b, v97
    v_mul_f32 v138, 0xbfb8aa3b, v98
    v_mul_f32 v139, 0xbfb8aa3b, v99
    v_mul_f32 v140, 0xbfb8aa3b, v104
    v_mul_f32 v141, 0xbfb8aa3b, v105
    v_mul_f32 v142, 0xbfb8aa3b, v106
    v_mul_f32 v143, 0xbfb8aa3b, v107
    v_mul_f32 v144, 0xbfb8aa3b, v112
    v_mul_f32 v145, 0xbfb8aa3b, v113
    v_mul_f32 v146, 0xbfb8aa3b, v114
    v_mul_f32 v147, 0xbfb8aa3b, v115
    v_exp_f32 v128, v128
    v_exp_f32 v129, v129
    v_exp_f32 v130, v130
    v_exp_f32 v131, v131
    v_exp_f32 v132, v132
    v_exp_f32 v133, v133
    v_exp_f32 v134, v134
    v_exp_f32 v135, v135
    v_exp_f32 v136, v136
    v_exp_f32 v137, v137
    v_exp_f32 v138, v138
    v_exp_f32 v139, v139
    v_exp_f32 v140, v140
    v_exp_f32 v141, v141
    v_exp_f32 v142, v142
    v_exp_f32 v143, v143
    v_exp_f32 v144, v144
    v_exp_f32 v145, v145
    v_exp_f32 v146, v146
    v_exp_f32 v147, v147
    v_mul_f32 v16, v16, v80
    v_mul_f32 v17, v17, v81
    v_mul_f32 v18, v18, v82
    v_mul_f32 v19, v19, v83
    v_mul_f32 v20, v20, v88
    v_mul_f32 v21, v21, v89
    v_mul_f32 v22, v22, v90
    v_mul_f32 v23, v23, v91
    v_mul_f32 v24, v24, v96
    v_mul_f32 v25, v25, v97
    v_mul_f32 v26, v26, v98
    v_mul_f32 v27, v27, v99
    v_mul_f32 v28, v28, v104
    v_mul_f32 v29, v29, v105
    v_mul_f32 v30, v30, v106
    v_mul_f32 v31, v31, v107
    v_mul_f32 v32, v32, v112
    v_mul_f32 v33, v33, v113
    v_mul_f32 v34, v34, v114
    v_mul_f32 v35, v35, v115
    v_add_f32 v128, 1.0, v128
    v_add_f32 v129, 1.0, v129
    v_add_f32 v130, 1.0, v130
    v_add_f32 v131, 1.0, v131
    v_add_f32 v132, 1.0, v132
    v_add_f32 v133, 1.0, v133
    v_add_f32 v134, 1.0, v134
    v_add_f32 v135, 1.0, v135
    v_add_f32 v136, 1.0, v136
    v_add_f32 v137, 1.0, v137
    v_add_f32 v138, 1.0, v138
    v_add_f32 v139, 1.0, v139
    v_add_f32 v140, 1.0, v140
    v_add_f32 v141, 1.0, v141
    v_add_f32 v142, 1.0, v142
    v_add_f32 v143, 1.0, v143
    v_add_f32 v144, 1.0, v144
    v_add_f32 v145, 1.0, v145
    v_add_f32 v146, 1.0, v146
    v_add_f32 v147, 1.0, v147
    v_rcp_f32 v128, v128
    v_rcp_f32 v129, v129
    v_rcp_f32 v130, v130
    v_rcp_f32 v131, v131
    v_rcp_f32 v132, v132
    v_rcp_f32 v133, v133
    v_rcp_f32 v134, v134
    v_rcp_f32 v135, v135
    v_rcp_f32 v136, v136
    v_rcp_f32 v137, v137
    v_rcp_f32 v138, v138
    v_rcp_f32 v139, v139
    v_rcp_f32 v140, v140
    v_rcp_f32 v141, v141
    v_rcp_f32 v142, v142
    v_rcp_f32 v143, v143
    v_rcp_f32 v144, v144
    v_rcp_f32 v145, v145
    v_rcp_f32 v146, v146
    v_rcp_f32 v147, v147
    v_fmac_f32 v56, v16, v128
    v_fmac_f32 v57, v17, v129
    v_fmac_f32 v58, v18, v130
    v_fmac_f32 v59, v19, v131
    v_cvt_pk_bf16_f32 v40, v56, v57
    v_cvt_pk_bf16_f32 v41, v58, v59
    ds_write_b64 v209, v[40:41] offset:0
    v_fmac_f32 v60, v20, v132
    v_fmac_f32 v61, v21, v133
    v_fmac_f32 v62, v22, v134
    v_fmac_f32 v63, v23, v135
    v_cvt_pk_bf16_f32 v42, v60, v61
    v_cvt_pk_bf16_f32 v43, v62, v63
    ds_write_b64 v209, v[42:43] offset:32
    v_fmac_f32 v64, v24, v136
    v_fmac_f32 v65, v25, v137
    v_fmac_f32 v66, v26, v138
    v_fmac_f32 v67, v27, v139
    v_cvt_pk_bf16_f32 v44, v64, v65
    v_cvt_pk_bf16_f32 v45, v66, v67
    ds_write_b64 v209, v[44:45] offset:64
    v_fmac_f32 v68, v28, v140
    v_fmac_f32 v69, v29, v141
    v_fmac_f32 v70, v30, v142
    v_fmac_f32 v71, v31, v143
    v_cvt_pk_bf16_f32 v46, v68, v69
    v_cvt_pk_bf16_f32 v47, v70, v71
    ds_write_b64 v209, v[46:47] offset:96
    v_fmac_f32 v72, v32, v144
    v_fmac_f32 v73, v33, v145
    v_fmac_f32 v74, v34, v146
    v_fmac_f32 v75, v35, v147
    v_cvt_pk_bf16_f32 v48, v72, v73
    v_cvt_pk_bf16_f32 v49, v74, v75
    ds_write_b64 v209, v[48:49] offset:128
    s_waitcnt lgkmcnt(0)
    s_barrier
    s_endpgm
L_CB:
    s_bfe_u32 s55, s44, 393234
    s_add_u32 m0, s97, 97280
    s_lshl_b32 s55, s55, 11
    buffer_load_dwordx4 v240, s[24:27], s55 offen offset:0 sc1 lds
    buffer_load_dwordx4 v240, s[24:27], s55 offen offset:1024 sc1 lds
    s_bfe_u32 s55, s44, 393240
    s_add_u32 m0, s97, 99328
    s_lshl_b32 s55, s55, 11
    buffer_load_dwordx4 v240, s[24:27], s55 offen offset:0 sc1 lds
    buffer_load_dwordx4 v240, s[24:27], s55 offen offset:1024 sc1 lds
    s_bfe_u32 s55, s45, 393216
    s_add_u32 m0, s97, 101376
    s_lshl_b32 s55, s55, 11
    buffer_load_dwordx4 v240, s[24:27], s55 offen offset:0 sc1 lds
    buffer_load_dwordx4 v240, s[24:27], s55 offen offset:1024 sc1 lds
    s_waitcnt vmcnt(6)
L_CB2:
    s_load_dwordx2 s[4:5], s[0:1], 64
    s_barrier
    s_or_b32 s57, s3, 5
    v_mov_b32 v28, s57
    v_mov_b32 v29, 0
    s_mov_b64 exec, 1
    buffer_store_dword v28, v29, s[24:27], s58 offen sc1
    s_mov_b64 exec, -1
    s_load_dword s10, s[8:9], 0 glc
    s_load_dword s11, s[8:9], 128 glc
    s_load_dword s42, s[8:9], 256 glc
    s_load_dword s43, s[8:9], 384 glc
    s_load_dword s50, s[8:9], 512 glc
    s_load_dword s51, s[8:9], 640 glc
    s_bfe_u32 s55, s45, 393222
    s_add_u32 m0, s97, 15360
    s_lshl_b32 s55, s55, 11
    buffer_load_dwordx4 v240, s[24:27], s55 offen offset:0 sc1 lds
    buffer_load_dwordx4 v240, s[24:27], s55 offen offset:1024 sc1 lds
    s_bfe_u32 s55, s45, 393228
    s_add_u32 m0, s97, 17408
    s_lshl_b32 s55, s55, 11
    buffer_load_dwordx4 v240, s[24:27], s55 offen offset:0 sc1 lds
    buffer_load_dwordx4 v240, s[24:27], s55 offen offset:1024 sc1 lds
    s_bfe_u32 s55, s45, 393234
    s_add_u32 m0, s97, 19456
    s_lshl_b32 s55, s55, 11
    buffer_load_dwordx4 v240, s[24:27], s55 offen offset:0 sc1 lds
    buffer_load_dwordx4 v240, s[24:27], s55 offen offset:1024 sc1 lds
    s_lshr_b32 s60, s2, 5
    s_and_b32 s61, s2, 1
    v_lshrrev_b32 v210, 4, v1
    v_and_b32 v211, 15, v1
    s_lshl_b32 s62, s29, 2
    s_lshl_b32 s63, s61, 1
    s_add_u32 s62, s62, s63
    s_mul_i32 s36, s60, 80
    s_lshl_b32 s37, s36, 1
    s_sub_u32 s37, 1200, s37
    s_mul_i32 s38, s62, 1280
    s_add_u32 s36, s36, s38
    s_lshl_b32 s38, s52, 6
    s_mov_b32 s39, 81920
    s_mul_i32 s64, s60, 40
    s_lshl_b32 s63, s52, 4
    s_add_u32 s64, s64, s63
    v_cmp_eq_u32 s[32:33], 0, v210
    v_cmp_eq_u32 s[34:35], 2, v210
    v_add_u32 v128, s38, v1
    v_add_u32 v128, 0, v128
    v_mul_u32_u24 v129, 13108, v128
    v_lshrrev_b32 v129, 16, v129
    v_mul_u32_u24 v130, 5, v129
    v_sub_u32 v130, v128, v130
    v_bfe_u32 v131, v129, 1, 5
    v_mul_lo_u32 v131, v131, s39
    v_lshl_add_u32 v131, v130, 4, v131
    v_lshrrev_b32 v130, 6, v129
    v_mul_u32_u24 v130, 1280, v130
    v_and_b32 v129, 1, v129
    v_mul_u32_u24 v129, s37, v129
    v_add3_u32 v131, v131, v129, v130
    v_add_u32 v212, s36, v131
    v_add_u32 v128, s38, v1
    v_add_u32 v128, 256, v128
    v_mul_u32_u24 v129, 13108, v128
    v_lshrrev_b32 v129, 16, v129
    v_mul_u32_u24 v130, 5, v129
    v_sub_u32 v130, v128, v130
    v_bfe_u32 v131, v129, 1, 5
    v_mul_lo_u32 v131, v131, s39
    v_lshl_add_u32 v131, v130, 4, v131
    v_lshrrev_b32 v130, 6, v129
    v_mul_u32_u24 v130, 1280, v130
    v_and_b32 v129, 1, v129
    v_mul_u32_u24 v129, s37, v129
    v_add3_u32 v131, v131, v129, v130
    v_add_u32 v213, s36, v131
    v_add_u32 v128, s38, v1
    v_add_u32 v128, 512, v128
    v_mul_u32_u24 v129, 13108, v128
    v_lshrrev_b32 v129, 16, v129
    v_mul_u32_u24 v130, 5, v129
    v_sub_u32 v130, v128, v130
    v_bfe_u32 v131, v129, 1, 5
    v_mul_lo_u32 v131, v131, s39
    v_lshl_add_u32 v131, v130, 4, v131
    v_lshrrev_b32 v130, 6, v129
    v_mul_u32_u24 v130, 1280, v130
    v_and_b32 v129, 1, v129
    v_mul_u32_u24 v129, s37, v129
    v_add3_u32 v131, v131, v129, v130
    v_add_u32 v214, s36, v131
    v_mov_b32 v128, 2130706432
    s_cmp_lt_u32 s52, 2
    s_cselect_b64 vcc, -1, 0
    v_cndmask_b32 v214, v128, v214, vcc
    s_waitcnt vmcnt(7)
    s_barrier
    s_mov_b32 s56, 0
    s_add_u32 s57, s3, 3
Lsp_14:
    s_waitcnt lgkmcnt(0)
    s_sub_u32 s10, s10, s57
    s_sub_u32 s11, s11, s57
    s_sub_u32 s42, s42, s57
    s_sub_u32 s43, s43, s57
    s_sub_u32 s50, s50, s57
    s_sub_u32 s51, s51, s57
    s_max_u32 s10, s10, s11
    s_max_u32 s10, s10, s42
    s_max_u32 s10, s10, s43
    s_max_u32 s10, s10, s50
    s_max_u32 s10, s10, s51
    s_cmp_le_u32 s10, 4
    s_cbranch_scc1 Lsp_14d
    s_add_u32 s56, s56, 1
    s_cmp_ge_u32 s56, 40000
    s_cbranch_scc1 Lsp_14d
    s_sleep 2
    s_load_dword s10, s[8:9], 0 glc
    s_load_dword s11, s[8:9], 128 glc
    s_load_dword s42, s[8:9], 256 glc
    s_load_dword s43, s[8:9], 384 glc
    s_load_dword s50, s[8:9], 512 glc
    s_load_dword s51, s[8:9], 640 glc
    s_branch Lsp_14
Lsp_14d:
    s_bfe_u32 s55, s45, 393240
    s_add_u32 m0, s97, 138240
    s_lshl_b32 s55, s55, 11
    buffer_load_dwordx4 v240, s[24:27], s55 offen offset:0 sc1 lds
    v_add_u32 v132, s64, v211
    v_cvt_f32_u32 v132, v132
    v_add_f32 v132, 0.5, v132
    v_mul_f32 v132, 0x3acccccd, v132
    v_and_b32 v128, 1, v210
    v_lshlrev_b32 v128, 1, v128
    v_sub_u32 v129, 320, v128
    v_cmp_lt_u32 s[40:41], 31, v1
    s_nop 1
    v_cndmask_b32 v128, v128, v129, s[40:41]
    v_cvt_f32_u32 v128, v128
    v_mul_f32 v128, v128, v132
    buffer_load_dwordx4 v240, s[24:27], s55 offen offset:1024 sc1 lds
    v_sub_f32 v129, 0, v132
    v_cndmask_b32 v129, v132, v129, s[40:41]
    v_mul_f32 v130, 0x41800000, v132
    v_cos_f32 v130, v130
    v_mul_f32 v132, 0x43200000, v132
    v_sin_f32 v133, -v132
    v_cos_f32 v132, v132
    v_add_f32 v130, v130, v130
    v_sub_f32 v131, 0, v130
    v_mov_b32 v96, v128
    v_fmamk_f32 v97, v129, 0x3f800000, v128
    s_bfe_u32 s55, s46, 393216
    s_add_u32 m0, s97, 140288
    s_lshl_b32 s55, s55, 11
    buffer_load_dwordx4 v240, s[24:27], s55 offen offset:0 sc1 lds
    v_fmamk_f32 v98, v129, 0x40800000, v128
    v_fmamk_f32 v99, v129, 0x40a00000, v128
    v_fmamk_f32 v100, v129, 0x41000000, v128
    v_fmamk_f32 v101, v129, 0x41100000, v128
    v_fmamk_f32 v102, v129, 0x41400000, v128
    v_fmamk_f32 v103, v129, 0x41500000, v128
    v_sin_f32 v112, -v96
    v_cos_f32 v96, v96
    v_sin_f32 v113, -v97
    v_cos_f32 v97, v97
    v_sin_f32 v114, -v98
    buffer_load_dwordx4 v240, s[24:27], s55 offen offset:1024 sc1 lds
    v_cos_f32 v98, v98
    v_sin_f32 v115, -v99
    v_cos_f32 v99, v99
    v_sin_f32 v116, -v100
    v_cos_f32 v100, v100
    v_sin_f32 v117, -v101
    v_cos_f32 v101, v101
    v_sin_f32 v118, -v102
    v_cos_f32 v102, v102
    v_sin_f32 v119, -v103
    v_cos_f32 v103, v103
    s_bfe_u32 s55, s46, 393222
    s_add_u32 m0, s97, 142336
    s_lshl_b32 s55, s55, 11
    buffer_load_dwordx4 v240, s[24:27], s55 offen offset:0 sc1 lds
    v_fmamk_f32 v104, v129, 0x41800000, v128
    v_fmamk_f32 v105, v129, 0x41880000, v128
    v_fmamk_f32 v106, v129, 0x41a00000, v128
    v_fmamk_f32 v107, v129, 0x41a80000, v128
    v_fmamk_f32 v108, v129, 0x41c00000, v128
    v_fmamk_f32 v109, v129, 0x41c80000, v128
    v_fmamk_f32 v110, v129, 0x41e00000, v128
    v_fmamk_f32 v111, v129, 0x41e80000, v128
    v_sin_f32 v120, -v104
    v_cos_f32 v104, v104
    v_sin_f32 v121, -v105
    buffer_load_dwordx4 v240, s[24:27], s55 offen offset:1024 sc1 lds
    v_cos_f32 v105, v105
    v_sin_f32 v122, -v106
    v_cos_f32 v106, v106
    v_sin_f32 v123, -v107
    v_cos_f32 v107, v107
    v_sin_f32 v124, -v108
    v_cos_f32 v108, v108
    v_sin_f32 v125, -v109
    v_cos_f32 v109, v109
    v_sin_f32 v126, -v110
    v_cos_f32 v110, v110
    s_waitcnt vmcnt(6)
    s_barrier
    s_load_dword s10, s[8:9], 0 glc
    s_load_dword s11, s[8:9], 128 glc
    s_load_dword s42, s[8:9], 256 glc
    s_load_dword s43, s[8:9], 384 glc
    s_load_dword s50, s[8:9], 512 glc
    s_load_dword s51, s[8:9], 640 glc
    s_add_u32 s8, s24, s99
    s_addc_u32 s9, s25, 0
    s_load_dword s66, s[8:9], 0 glc
    s_load_dword s67, s[8:9], 128 glc
    s_load_dword s68, s[8:9], 256 glc
    s_load_dword s69, s[8:9], 384 glc
    s_load_dword s70, s[8:9], 512 glc
    s_load_dword s96, s[8:9], 640 glc
    s_bfe_u32 s55, s46, 393228
    s_add_u32 m0, s97, 97280
    s_lshl_b32 s55, s55, 11
    buffer_load_dwordx4 v240, s[24:27], s55 offen offset:0 sc1 lds
    v_sin_f32 v127, -v111
    v_cos_f32 v111, v111
    v_cndmask_b32 v132, v96, v132, s[32:33]
    v_cndmask_b32 v133, v112, v133, s[32:33]
    v_mul_f32 v128, 0.5, v132
    v_mul_f32 v129, 0.5, v133
    v_cndmask_b32 v132, v132, v128, s[34:35]
    v_cndmask_b32 v133, v133, v129, s[34:35]
    v_cvt_pk_bf16_f32 v16, v132, v97
    v_cvt_pk_bf16_f32 v56, v133, v113
    v_cvt_pk_bf16_f32 v17, v98, v99
    buffer_load_dwordx4 v240, s[24:27], s55 offen offset:1024 sc1 lds
    v_cvt_pk_bf16_f32 v57, v114, v115
    v_cvt_pk_bf16_f32 v18, v100, v101
    v_cvt_pk_bf16_f32 v58, v116, v117
    v_cvt_pk_bf16_f32 v19, v102, v103
    v_cvt_pk_bf16_f32 v59, v118, v119
    v_fmac_f32 v96, v131, v104
    v_fmac_f32 v112, v131, v120
    v_fmac_f32 v97, v131, v105
    v_fmac_f32 v113, v131, v121
    v_fmac_f32 v98, v131, v106
    v_fmac_f32 v114, v131, v122
    s_bfe_u32 s55, s46, 393234
    s_add_u32 m0, s97, 99328
    s_lshl_b32 s55, s55, 11
    buffer_load_dwordx4 v240, s[24:27], s55 offen offset:0 sc1 lds
    v_fmac_f32 v99, v131, v107
    v_fmac_f32 v115, v131, v123
    v_fmac_f32 v100, v131, v108
    v_fmac_f32 v116, v131, v124
    v_fmac_f32 v101, v131, v109
    v_fmac_f32 v117, v131, v125
    v_fmac_f32 v102, v131, v110
    v_fmac_f32 v118, v131, v126
    v_fmac_f32 v103, v131, v111
    v_fmac_f32 v119, v131, v127
    v_cvt_pk_bf16_f32 v20, v104, v105
    buffer_load_dwordx4 v240, s[24:27], s55 offen offset:1024 sc1 lds
    v_cvt_pk_bf16_f32 v60, v120, v121
    v_cvt_pk_bf16_f32 v21, v106, v107
    v_cvt_pk_bf16_f32 v61, v122, v123
    v_cvt_pk_bf16_f32 v22, v108, v109
    v_cvt_pk_bf16_f32 v62, v124, v125
    v_cvt_pk_bf16_f32 v23, v110, v111
    v_cvt_pk_bf16_f32 v63, v126, v127
    v_fmac_f32 v104, v130, v96
    v_fmac_f32 v120, v130, v112
    v_fmac_f32 v105, v130, v97
    v_fmac_f32 v121, v130, v113
    s_bfe_u32 s55, s46, 393240
    s_add_u32 m0, s97, 101376
    s_lshl_b32 s55, s55, 11
    buffer_load_dwordx4 v240, s[24:27], s55 offen offset:0 sc1 lds
    v_fmac_f32 v106, v130, v98
    v_fmac_f32 v122, v130, v114
    v_fmac_f32 v107, v130, v99
    v_fmac_f32 v123, v130, v115
    v_fmac_f32 v108, v130, v100
    v_fmac_f32 v124, v130, v116
    v_fmac_f32 v109, v130, v101
    v_fmac_f32 v125, v130, v117
    v_fmac_f32 v110, v130, v102
    v_fmac_f32 v126, v130, v118
    v_fmac_f32 v111, v130, v103
    buffer_load_dwordx4 v240, s[24:27], s55 offen offset:1024 sc1 lds
    v_fmac_f32 v127, v130, v119
    v_cvt_pk_bf16_f32 v24, -v96, -v97
    v_cvt_pk_bf16_f32 v64, -v112, -v113
    v_cvt_pk_bf16_f32 v25, -v98, -v99
    v_cvt_pk_bf16_f32 v65, -v114, -v115
    v_cvt_pk_bf16_f32 v26, -v100, -v101
    v_cvt_pk_bf16_f32 v66, -v116, -v117
    v_cvt_pk_bf16_f32 v27, -v102, -v103
    v_cvt_pk_bf16_f32 v67, -v118, -v119
    v_fmac_f32 v96, v131, v104
    v_fmac_f32 v112, v131, v120
    v_fmac_f32 v97, v131, v105
    s_waitcnt vmcnt(6)
    s_barrier
    s_mov_b32 s56, 0
    s_add_u32 s57, s3, 4
Lsp_15:
    s_waitcnt lgkmcnt(0)
    s_sub_u32 s66, s66, s57
    s_sub_u32 s67, s67, s57
    s_sub_u32 s68, s68, s57
    s_sub_u32 s69, s69, s57
    s_sub_u32 s70, s70, s57
    s_sub_u32 s96, s96, s57
    s_max_u32 s66, s66, s67
    s_max_u32 s66, s66, s68
    s_max_u32 s66, s66, s69
    s_max_u32 s66, s66, s70
    s_max_u32 s66, s66, s96
    s_cmp_le_u32 s66, 3
    s_cbranch_scc1 Lsp_15d
    s_add_u32 s56, s56, 1
    s_cmp_ge_u32 s56, 40000
    s_cbranch_scc1 Lsp_15d
    s_sleep 2
    s_load_dword s66, s[8:9], 0 glc
    s_load_dword s67, s[8:9], 128 glc
    s_load_dword s68, s[8:9], 256 glc
    s_load_dword s69, s[8:9], 384 glc
    s_load_dword s70, s[8:9], 512 glc
    s_load_dword s96, s[8:9], 640 glc
    s_branch Lsp_15
Lsp_15d:
    s_add_u32 s8, s24, s98
    s_addc_u32 s9, s25, 0
    s_mov_b32 s56, 0
    s_add_u32 s57, s3, 4
Lsp_16:
    s_waitcnt lgkmcnt(0)
    s_sub_u32 s10, s10, s57
    s_sub_u32 s11, s11, s57
    s_sub_u32 s42, s42, s57
    s_sub_u32 s43, s43, s57
    s_sub_u32 s50, s50, s57
    s_sub_u32 s51, s51, s57
    s_max_u32 s10, s10, s11
    s_max_u32 s10, s10, s42
    s_max_u32 s10, s10, s43
    s_max_u32 s10, s10, s50
    s_max_u32 s10, s10, s51
    s_cmp_le_u32 s10, 3
    s_cbranch_scc1 Lsp_16d
    s_add_u32 s56, s56, 1
    s_cmp_ge_u32 s56, 40000
    s_cbranch_scc1 Lsp_16d
    s_sleep 2
    s_load_dword s10, s[8:9], 0 glc
    s_load_dword s11, s[8:9], 128 glc
    s_load_dword s42, s[8:9], 256 glc
    s_load_dword s43, s[8:9], 384 glc
    s_load_dword s50, s[8:9], 512 glc
    s_load_dword s51, s[8:9], 640 glc
    s_branch Lsp_16
Lsp_16d:
    s_bfe_u32 s55, s47, 393216
    s_add_u32 m0, s97, 15360
    s_lshl_b32 s55, s55, 11
    buffer_load_dwordx4 v240, s[24:27], s55 offen offset:0 sc1 lds
    v_fmac_f32 v113, v131, v121
    v_fmac_f32 v98, v131, v106
    v_fmac_f32 v114, v131, v122
    v_fmac_f32 v99, v131, v107
    v_fmac_f32 v115, v131, v123
    v_fmac_f32 v100, v131, v108
    v_fmac_f32 v116, v131, v124
    v_fmac_f32 v101, v131, v109
    v_fmac_f32 v117, v131, v125
    v_fmac_f32 v102, v131, v110
    v_fmac_f32 v118, v131, v126
    buffer_load_dwordx4 v240, s[24:27], s55 offen offset:1024 sc1 lds
    v_fmac_f32 v103, v131, v111
    v_fmac_f32 v119, v131, v127
    v_cvt_pk_bf16_f32 v28, -v104, -v105
    v_cvt_pk_bf16_f32 v68, -v120, -v121
    v_cvt_pk_bf16_f32 v29, -v106, -v107
    v_cvt_pk_bf16_f32 v69, -v122, -v123
    v_cvt_pk_bf16_f32 v30, -v108, -v109
    v_cvt_pk_bf16_f32 v70, -v124, -v125
    v_cvt_pk_bf16_f32 v31, -v110, -v111
    v_cvt_pk_bf16_f32 v71, -v126, -v127
    v_fmac_f32 v104, v130, v96
    s_bfe_u32 s55, s47, 393222
    s_add_u32 m0, s97, 17408
    s_lshl_b32 s55, s55, 11
    buffer_load_dwordx4 v240, s[24:27], s55 offen offset:0 sc1 lds
    v_fmac_f32 v120, v130, v112
    v_fmac_f32 v105, v130, v97
    v_fmac_f32 v121, v130, v113
    v_fmac_f32 v106, v130, v98
    v_fmac_f32 v122, v130, v114
    v_fmac_f32 v107, v130, v99
    v_fmac_f32 v123, v130, v115
    v_fmac_f32 v108, v130, v100
    v_fmac_f32 v124, v130, v116
    v_fmac_f32 v109, v130, v101
    v_fmac_f32 v125, v130, v117
    buffer_load_dwordx4 v240, s[24:27], s55 offen offset:1024 sc1 lds
    v_fmac_f32 v110, v130, v102
    v_fmac_f32 v126, v130, v118
    v_fmac_f32 v111, v130, v103
    v_fmac_f32 v127, v130, v119
    v_cvt_pk_bf16_f32 v32, v96, v97
    v_cvt_pk_bf16_f32 v72, v112, v113
    v_cvt_pk_bf16_f32 v33, v98, v99
    v_cvt_pk_bf16_f32 v73, v114, v115
    v_cvt_pk_bf16_f32 v34, v100, v101
    v_cvt_pk_bf16_f32 v74, v116, v117
    v_cvt_pk_bf16_f32 v35, v102, v103
    s_bfe_u32 s55, s47, 393228
    s_add_u32 m0, s97, 19456
    s_lshl_b32 s55, s55, 11
    buffer_load_dwordx4 v240, s[24:27], s55 offen offset:0 sc1 lds
    v_cvt_pk_bf16_f32 v75, v118, v119
    v_fmac_f32 v96, v131, v104
    v_fmac_f32 v112, v131, v120
    v_fmac_f32 v97, v131, v105
    v_fmac_f32 v113, v131, v121
    v_fmac_f32 v98, v131, v106
    v_fmac_f32 v114, v131, v122
    v_fmac_f32 v99, v131, v107
    v_fmac_f32 v115, v131, v123
    v_fmac_f32 v100, v131, v108
    v_fmac_f32 v116, v131, v124
    buffer_load_dwordx4 v240, s[24:27], s55 offen offset:1024 sc1 lds
    v_fmac_f32 v101, v131, v109
    v_fmac_f32 v117, v131, v125
    v_fmac_f32 v102, v131, v110
    v_fmac_f32 v118, v131, v126
    v_fmac_f32 v103, v131, v111
    v_fmac_f32 v119, v131, v127
    v_cvt_pk_bf16_f32 v36, v104, v105
    v_cvt_pk_bf16_f32 v76, v120, v121
    v_cvt_pk_bf16_f32 v37, v106, v107
    v_cvt_pk_bf16_f32 v77, v122, v123
    v_cvt_pk_bf16_f32 v38, v108, v109
    v_cvt_pk_bf16_f32 v78, v124, v125
    s_waitcnt vmcnt(6)
    s_barrier
    s_load_dword s10, s[8:9], 0 glc
    s_load_dword s11, s[8:9], 128 glc
    s_load_dword s42, s[8:9], 256 glc
    s_load_dword s43, s[8:9], 384 glc
    s_load_dword s50, s[8:9], 512 glc
    s_load_dword s51, s[8:9], 640 glc
    s_add_u32 s8, s24, s99
    s_addc_u32 s9, s25, 0
    s_load_dword s66, s[8:9], 0 glc
    s_load_dword s67, s[8:9], 128 glc
    s_load_dword s68, s[8:9], 256 glc
    s_load_dword s69, s[8:9], 384 glc
    s_load_dword s70, s[8:9], 512 glc
    s_load_dword s96, s[8:9], 640 glc
    s_bfe_u32 s55, s47, 393234
    s_add_u32 m0, s97, 138240
    s_lshl_b32 s55, s55, 11
    buffer_load_dwordx4 v240, s[24:27], s55 offen offset:0 sc1 lds
    v_cvt_pk_bf16_f32 v39, v110, v111
    v_cvt_pk_bf16_f32 v79, v126, v127
    v_fmac_f32 v104, v130, v96
    v_fmac_f32 v120, v130, v112
    v_fmac_f32 v105, v130, v97
    v_fmac_f32 v121, v130, v113
    v_fmac_f32 v106, v130, v98
    v_fmac_f32 v122, v130, v114
    v_fmac_f32 v107, v130, v99
    v_fmac_f32 v123, v130, v115
    v_fmac_f32 v108, v130, v100
    buffer_load_dwordx4 v240, s[24:27], s55 offen offset:1024 sc1 lds
    v_fmac_f32 v124, v130, v116
    v_fmac_f32 v109, v130, v101
    v_fmac_f32 v125, v130, v117
    v_fmac_f32 v110, v130, v102
    v_fmac_f32 v126, v130, v118
    v_fmac_f32 v111, v130, v103
    v_fmac_f32 v127, v130, v119
    v_cvt_pk_bf16_f32 v40, -v96, -v97
    v_cvt_pk_bf16_f32 v80, -v112, -v113
    v_cvt_pk_bf16_f32 v41, -v98, -v99
    v_cvt_pk_bf16_f32 v81, -v114, -v115
    s_bfe_u32 s55, s47, 393240
    s_add_u32 m0, s97, 140288
    s_lshl_b32 s55, s55, 11
    buffer_load_dwordx4 v240, s[24:27], s55 offen offset:0 sc1 lds
    v_cvt_pk_bf16_f32 v42, -v100, -v101
    v_cvt_pk_bf16_f32 v82, -v116, -v117
    v_cvt_pk_bf16_f32 v43, -v102, -v103
    v_cvt_pk_bf16_f32 v83, -v118, -v119
    v_fmac_f32 v96, v131, v104
    v_fmac_f32 v112, v131, v120
    v_fmac_f32 v97, v131, v105
    v_fmac_f32 v113, v131, v121
    v_fmac_f32 v98, v131, v106
    v_fmac_f32 v114, v131, v122
    v_fmac_f32 v99, v131, v107
    buffer_load_dwordx4 v240, s[24:27], s55 offen offset:1024 sc1 lds
    v_fmac_f32 v115, v131, v123
    v_fmac_f32 v100, v131, v108
    v_fmac_f32 v116, v131, v124
    v_fmac_f32 v101, v131, v109
    v_fmac_f32 v117, v131, v125
    v_fmac_f32 v102, v131, v110
    v_fmac_f32 v118, v131, v126
    v_fmac_f32 v103, v131, v111
    v_fmac_f32 v119, v131, v127
    v_cvt_pk_bf16_f32 v44, -v104, -v105
    v_cvt_pk_bf16_f32 v84, -v120, -v121
    s_bfe_u32 s55, s48, 393216
    s_add_u32 m0, s97, 142336
    s_lshl_b32 s55, s55, 11
    buffer_load_dwordx4 v240, s[24:27], s55 offen offset:0 sc1 lds
    v_cvt_pk_bf16_f32 v45, -v106, -v107
    v_cvt_pk_bf16_f32 v85, -v122, -v123
    v_cvt_pk_bf16_f32 v46, -v108, -v109
    v_cvt_pk_bf16_f32 v86, -v124, -v125
    v_cvt_pk_bf16_f32 v47, -v110, -v111
    v_cvt_pk_bf16_f32 v87, -v126, -v127
    v_fmac_f32 v104, v130, v96
    v_fmac_f32 v120, v130, v112
    v_fmac_f32 v105, v130, v97
    v_fmac_f32 v121, v130, v113
    v_fmac_f32 v106, v130, v98
    buffer_load_dwordx4 v240, s[24:27], s55 offen offset:1024 sc1 lds
    v_fmac_f32 v122, v130, v114
    v_fmac_f32 v107, v130, v99
    v_fmac_f32 v123, v130, v115
    v_fmac_f32 v108, v130, v100
    v_fmac_f32 v124, v130, v116
    v_fmac_f32 v109, v130, v101
    v_fmac_f32 v125, v130, v117
    v_fmac_f32 v110, v130, v102
    v_fmac_f32 v126, v130, v118
    v_fmac_f32 v111, v130, v103
    v_fmac_f32 v127, v130, v119
    s_waitcnt vmcnt(6)
    s_barrier
    s_mov_b64 s[74:75], 0xfffff
    s_mul_i32 s63, s52, 2560
    s_add_u32 s63, s63, 28327936
    v_lshlrev_b32 v7, 7, v1
    v_lshlrev_b32 v9, 4, v1
    s_mov_b64 exec, s[74:75]
    buffer_load_dword v10, v7, s[24:27], s63 offen offset:0 sc1
    s_mov_b64 exec, -1
    s_mov_b32 s56, 0
    s_add_u32 s57, s3, 5
Lsp_17:
    s_waitcnt lgkmcnt(0)
    s_sub_u32 s66, s66, s57
    s_sub_u32 s67, s67, s57
    s_sub_u32 s68, s68, s57
    s_sub_u32 s69, s69, s57
    s_sub_u32 s70, s70, s57
    s_sub_u32 s96, s96, s57
    s_max_u32 s66, s66, s67
    s_max_u32 s66, s66, s68
    s_max_u32 s66, s66, s69
    s_max_u32 s66, s66, s70
    s_max_u32 s66, s66, s96
    s_cmp_le_u32 s66, 2
    s_cbranch_scc1 Lsp_17d
    s_add_u32 s56, s56, 1
    s_cmp_ge_u32 s56, 40000
    s_cbranch_scc1 Lsp_17d
    s_sleep 2
    s_load_dword s66, s[8:9], 0 glc
    s_load_dword s67, s[8:9], 128 glc
    s_load_dword s68, s[8:9], 256 glc
    s_load_dword s69, s[8:9], 384 glc
    s_load_dword s70, s[8:9], 512 glc
    s_load_dword s96, s[8:9], 640 glc
    s_branch Lsp_17
Lsp_17d:
    s_add_u32 s8, s24, s98
    s_addc_u32 s9, s25, 0
    s_mov_b32 s56, 0
    s_add_u32 s57, s3, 5
Lsp_18:
    s_waitcnt lgkmcnt(0)
    s_sub_u32 s10, s10, s57
    s_sub_u32 s11, s11, s57
    s_sub_u32 s42, s42, s57
    s_sub_u32 s43, s43, s57
    s_sub_u32 s50, s50, s57
    s_sub_u32 s51, s51, s57
    s_max_u32 s10, s10, s11
    s_max_u32 s10, s10, s42
    s_max_u32 s10, s10, s43
    s_max_u32 s10, s10, s50
    s_max_u32 s10, s10, s51
    s_cmp_le_u32 s10, 2
    s_cbranch_scc1 Lsp_18d
    s_add_u32 s56, s56, 1
    s_cmp_ge_u32 s56, 40000
    s_cbranch_scc1 Lsp_18d
    s_sleep 2
    s_load_dword s10, s[8:9], 0 glc
    s_load_dword s11, s[8:9], 128 glc
    s_load_dword s42, s[8:9], 256 glc
    s_load_dword s43, s[8:9], 384 glc
    s_load_dword s50, s[8:9], 512 glc
    s_load_dword s51, s[8:9], 640 glc
    s_branch Lsp_18
Lsp_18d:
    s_bfe_u32 s55, s48, 393222
    s_add_u32 m0, s97, 97280
    s_lshl_b32 s55, s55, 11
    buffer_load_dwordx4 v240, s[24:27], s55 offen offset:0 sc1 lds
    v_cvt_pk_bf16_f32 v48, v96, v97
    v_cvt_pk_bf16_f32 v88, v112, v113
    v_cvt_pk_bf16_f32 v49, v98, v99
    v_cvt_pk_bf16_f32 v89, v114, v115
    v_cvt_pk_bf16_f32 v50, v100, v101
    v_cvt_pk_bf16_f32 v90, v116, v117
    v_cvt_pk_bf16_f32 v51, v102, v103
    v_cvt_pk_bf16_f32 v91, v118, v119
    v_cvt_pk_bf16_f32 v52, v104, v105
    v_cvt_pk_bf16_f32 v92, v120, v121
    v_cvt_pk_bf16_f32 v53, v106, v107
    buffer_load_dwordx4 v240, s[24:27], s55 offen offset:1024 sc1 lds
    v_cvt_pk_bf16_f32 v93, v122, v123
    v_cvt_pk_bf16_f32 v54, v108, v109
    v_cvt_pk_bf16_f32 v94, v124, v125
    v_cvt_pk_bf16_f32 v55, v110, v111
    v_cvt_pk_bf16_f32 v95, v126, v127
    v_lshlrev_b32 v128, 6, v211
    v_add_u32 v128, s62, v128
    v_cvt_f32_u32 v128, v128
    v_mul_f32 v128, 0x3a000000, v128
    v_lshlrev_b32 v129, 1, v210
    v_cvt_f32_u32 v129, v129
    s_bfe_u32 s55, s48, 393228
    s_add_u32 m0, s97, 99328
    s_lshl_b32 s55, s55, 11
    buffer_load_dwordx4 v240, s[24:27], s55 offen offset:0 sc1 lds
    v_cvt_f32_u32 v130, v211
    v_mul_f32 v130, 0.5, v130
    v_mul_f32 v131, v129, v128
    v_mov_b32 v132, v131
    v_add_f32 v133, 0x3e800000, v132
    v_fmamk_f32 v134, v128, 0x3f800000, v131
    v_add_f32 v135, 0x3e800000, v134
    v_fmamk_f32 v136, v128, 0x41000000, v131
    v_add_f32 v137, 0x3e800000, v136
    v_fmamk_f32 v138, v128, 0x41100000, v131
    v_add_f32 v139, 0x3e800000, v138
    buffer_load_dwordx4 v240, s[24:27], s55 offen offset:1024 sc1 lds
    v_cndmask_b32 v133, v133, v130, s[32:33]
    v_cos_f32 v132, v132
    v_cos_f32 v133, v133
    v_cos_f32 v134, v134
    v_cos_f32 v135, v135
    v_cos_f32 v136, v136
    v_cos_f32 v137, v137
    v_cos_f32 v138, v138
    v_cos_f32 v139, v139
    v_cvt_pk_bf16_f32 v220, v132, v133
    v_cvt_pk_bf16_f32 v221, v134, v135
    s_bfe_u32 s55, s48, 393234
    s_add_u32 m0, s97, 101376
    s_lshl_b32 s55, s55, 11
    buffer_load_dwordx4 v240, s[24:27], s55 offen offset:0 sc1 lds
    v_cvt_pk_bf16_f32 v222, v136, v137
    v_cvt_pk_bf16_f32 v223, v138, v139
    v_add_f32 v128, 0.5, v128
    v_mul_f32 v131, v129, v128
    v_mov_b32 v132, v131
    v_add_f32 v133, 0x3e800000, v132
    v_fmamk_f32 v134, v128, 0x3f800000, v131
    v_add_f32 v135, 0x3e800000, v134
    v_fmamk_f32 v136, v128, 0x41000000, v131
    v_add_f32 v137, 0x3e800000, v136
    v_fmamk_f32 v138, v128, 0x41100000, v131
    buffer_load_dwordx4 v240, s[24:27], s55 offen offset:1024 sc1 lds
    v_add_f32 v139, 0x3e800000, v138
    v_cndmask_b32 v133, v133, v130, s[32:33]
    v_cos_f32 v132, v132
    v_cos_f32 v133, v133
    v_cos_f32 v134, v134
    v_cos_f32 v135, v135
    v_cos_f32 v136, v136
    v_cos_f32 v137, v137
    v_cos_f32 v138, v138
    v_cos_f32 v139, v139
    v_cvt_pk_bf16_f32 v224, v132, v133
    v_cvt_pk_bf16_f32 v225, v134, v135
    s_waitcnt vmcnt(6)
    s_mov_b32 s56, 0
    s_add_u32 s57, s3, 5
    s_mov_b64 exec, s[74:75]
Lpoll_19:
    v_subrev_u32 v10, s57, v10
    v_cmp_lt_u32 vcc, 2, v10
    s_add_u32 s56, s56, 1
    s_cbranch_vccz Lpoll_19d
    s_cmp_ge_u32 s56, 40000
    s_cbranch_scc1 Lpoll_19d
    s_sleep 12
    buffer_load_dword v10, v7, s[24:27], s63 offen offset:0 sc1
    s_waitcnt vmcnt(0)
    s_branch Lpoll_19
Lpoll_19d:
    s_mov_b64 exec, -1
    s_barrier
    s_bfe_u32 s55, s48, 393240
    s_add_u32 m0, s97, 15360
    s_lshl_b32 s55, s55, 11
    buffer_load_dwordx4 v240, s[24:27], s55 offen offset:0 sc1 lds
    buffer_load_dwordx4 v240, s[24:27], s55 offen offset:1024 sc1 lds
    s_bfe_u32 s55, s49, 393216
    s_add_u32 m0, s97, 17408
    s_lshl_b32 s55, s55, 11
    buffer_load_dwordx4 v240, s[24:27], s55 offen offset:0 sc1 lds
    buffer_load_dwordx4 v240, s[24:27], s55 offen offset:1024 sc1 lds
    s_bfe_u32 s55, s49, 393222
    s_add_u32 m0, s97, 19456
    s_lshl_b32 s55, s55, 11
    buffer_load_dwordx4 v240, s[24:27], s55 offen offset:0 sc1 lds
    buffer_load_dwordx4 v240, s[24:27], s55 offen offset:1024 sc1 lds
    s_add_u32 s54, s62, 0
    s_mul_i32 s54, s54, 41344
    s_mul_i32 s55, s52, 10240
    s_add_u32 s54, s54, s55
    s_add_u32 s54, s54, 12582912
    s_add_u32 m0, s55, 40960
    s_nop 0
    buffer_load_dwordx4 v9, s[24:27], s54 offen offset:0 sc1 lds
    buffer_load_dwordx4 v9, s[24:27], s54 offen offset:1024 sc1 lds
    buffer_load_dwordx4 v9, s[24:27], s54 offen offset:2048 sc1 lds
    buffer_load_dwordx4 v9, s[24:27], s54 offen offset:3072 sc1 lds
    s_add_u32 m0, s55, 45056
    s_add_u32 s54, s54, 4096
    buffer_load_dwordx4 v9, s[24:27], s54 offen offset:0 sc1 lds
    buffer_load_dwordx4 v9, s[24:27], s54 offen offset:1024 sc1 lds
    buffer_load_dwordx4 v9, s[24:27], s54 offen offset:2048 sc1 lds
    buffer_load_dwordx4 v9, s[24:27], s54 offen offset:3072 sc1 lds
    s_add_u32 m0, s55, 49152
    s_add_u32 s54, s54, 4096
    buffer_load_dwordx4 v9, s[24:27], s54 offen offset:0 sc1 lds
    buffer_load_dwordx4 v9, s[24:27], s54 offen offset:1024 sc1 lds
    s_waitcnt vmcnt(16)
    s_barrier
    s_add_u32 s54, s62, 1
    s_mul_i32 s54, s54, 41344
    s_mul_i32 s55, s52, 10240
    s_add_u32 s54, s54, s55
    s_add_u32 s54, s54, 12582912
    s_add_u32 m0, s55, 122880
    s_nop 0
    buffer_load_dwordx4 v9, s[24:27], s54 offen offset:0 sc1 lds
    buffer_load_dwordx4 v9, s[24:27], s54 offen offset:1024 sc1 lds
    buffer_load_dwordx4 v9, s[24:27], s54 offen offset:2048 sc1 lds
    buffer_load_dwordx4 v9, s[24:27], s54 offen offset:3072 sc1 lds
    s_add_u32 m0, s55, 126976
    s_add_u32 s54, s54, 4096
    buffer_load_dwordx4 v9, s[24:27], s54 offen offset:0 sc1 lds
    buffer_load_dwordx4 v9, s[24:27], s54 offen offset:1024 sc1 lds
    buffer_load_dwordx4 v9, s[24:27], s54 offen offset:2048 sc1 lds
    buffer_load_dwordx4 v9, s[24:27], s54 offen offset:3072 sc1 lds
    s_add_u32 m0, s55, 131072
    s_add_u32 s54, s54, 4096
    buffer_load_dwordx4 v9, s[24:27], s54 offen offset:0 sc1 lds
    buffer_load_dwordx4 v9, s[24:27], s54 offen offset:1024 sc1 lds
    v_cvt_pk_bf16_f32 v226, v136, v137
    v_cvt_pk_bf16_f32 v227, v138, v139
    v_add_f32 v128, 0xbeffc000, v128
    v_mul_f32 v131, v129, v128
    v_mov_b32 v132, v131
    v_add_f32 v133, 0x3e800000, v132
    v_fmamk_f32 v134, v128, 0x3f800000, v131
    v_add_f32 v135, 0x3e800000, v134
    v_fmamk_f32 v136, v128, 0x41000000, v131
    v_add_f32 v137, 0x3e800000, v136
    v_fmamk_f32 v138, v128, 0x41100000, v131
    v_add_f32 v139, 0x3e800000, v138
    v_cndmask_b32 v133, v133, v130, s[32:33]
    v_cos_f32 v132, v132
    v_cos_f32 v133, v133
    v_cos_f32 v134, v134
    v_cos_f32 v135, v135
    v_cos_f32 v136, v136
    v_cos_f32 v137, v137
    v_cos_f32 v138, v138
    v_cos_f32 v139, v139
    v_cvt_pk_bf16_f32 v228, v132, v133
    v_cvt_pk_bf16_f32 v229, v134, v135
    v_cvt_pk_bf16_f32 v230, v136, v137
    v_cvt_pk_bf16_f32 v231, v138, v139
    v_add_f32 v128, 0.5, v128
    v_mul_f32 v131, v129, v128
    v_mov_b32 v132, v131
    v_add_f32 v133, 0x3e800000, v132
    v_fmamk_f32 v134, v128, 0x3f800000, v131
    v_add_f32 v135, 0x3e800000, v134
    v_fmamk_f32 v136, v128, 0x41000000, v131
    v_add_f32 v137, 0x3e800000, v136
    v_fmamk_f32 v138, v128, 0x41100000, v131
    v_add_f32 v139, 0x3e800000, v138
    v_cndmask_b32 v133, v133, v130, s[32:33]
    v_cos_f32 v132, v132
    v_cos_f32 v133, v133
    v_cos_f32 v134, v134
    v_cos_f32 v135, v135
    v_cos_f32 v136, v136
    v_cos_f32 v137, v137
    v_cos_f32 v138, v138
    v_cos_f32 v139, v139
    v_cvt_pk_bf16_f32 v232, v132, v133
    v_cvt_pk_bf16_f32 v233, v134, v135
    v_cvt_pk_bf16_f32 v234, v136, v137
    v_cvt_pk_bf16_f32 v235, v138, v139
    v_mul_u32_u24 v6, 320, v211
    s_lshl_b32 s38, s52, 6
    v_lshl_add_u32 v12, v210, 4, s38
    v_add_u32 v6, 102400, v6
    v_sub_u32 v13, 304, v12
    v_add_u32 v12, v6, v12
    v_add_u32 v13, v6, v13
    v_bfe_u32 v2, v1, 2, 2
    v_and_b32 v2, 2, v2
    v_and_b32 v3, 1, v210
    v_xor_b32 v2, v2, v3
    v_lshlrev_b32 v2, 4, v2
    v_lshl_add_u32 v2, v211, 6, v2
    v_lshrrev_b32 v3, 1, v210
    v_lshl_add_u32 v2, v3, 11, v2
    v_add_u32 v4, 122880, v2
    v_add_u32 v2, 40960, v2
    v_xor_b32 v3, 32, v2
    v_xor_b32 v5, 32, v4
    s_waitcnt vmcnt(10)
    s_barrier
    s_add_u32 m0, s7, 81920
    s_nop 0
    buffer_load_dwordx4 v212, s[12:15], 0 offen lds
    s_add_u32 m0, s7, 86016
    s_nop 0
    buffer_load_dwordx4 v213, s[12:15], 0 offen lds
    s_cmp_ge_u32 s52, 2
    s_cbranch_scc1 L_nx3
    s_add_u32 m0, s7, 90112
    s_nop 0
    buffer_load_dwordx4 v214, s[12:15], 0 offen lds
L_nx3:
    ds_read_b128 v[96:99], v2 offset:0
    ds_read_b128 v[100:103], v2 offset:1024
    ds_read_b128 v[104:107], v3 offset:0
    ds_read_b128 v[108:111], v3 offset:1024
    ds_read_b128 v[112:115], v2 offset:4096
    ds_read_b128 v[116:119], v2 offset:5120
    ds_read_b128 v[120:123], v3 offset:4096
    ds_read_b128 v[124:127], v3 offset:5120
    s_waitcnt lgkmcnt(7)
    v_mfma_f32_16x16x32_bf16 v[144:147], v[96:99], v[16:19], 0
    s_waitcnt lgkmcnt(6)
    v_mfma_f32_16x16x32_bf16 v[148:151], v[100:103], v[16:19], 0
    s_waitcnt lgkmcnt(5)
    v_mfma_f32_16x16x32_bf16 v[152:155], v[104:107], v[56:59], 0
    s_waitcnt lgkmcnt(4)
    v_mfma_f32_16x16x32_bf16 v[156:159], v[108:111], v[56:59], 0
    ds_read_b128 v[96:99], v2 offset:8192
    ds_read_b128 v[100:103], v2 offset:9216
    ds_read_b128 v[104:107], v3 offset:8192
    ds_read_b128 v[108:111], v3 offset:9216
    s_waitcnt lgkmcnt(7)
    v_mfma_f32_16x16x32_bf16 v[144:147], v[112:115], v[20:23], v[144:147]
    s_waitcnt lgkmcnt(6)
    v_mfma_f32_16x16x32_bf16 v[148:151], v[116:119], v[20:23], v[148:151]
    s_waitcnt lgkmcnt(5)
    v_mfma_f32_16x16x32_bf16 v[152:155], v[120:123], v[60:63], v[152:155]
    s_waitcnt lgkmcnt(4)
    v_mfma_f32_16x16x32_bf16 v[156:159], v[124:127], v[60:63], v[156:159]
    ds_read_b128 v[112:115], v2 offset:12288
    ds_read_b128 v[116:119], v2 offset:13312
    ds_read_b128 v[120:123], v3 offset:12288
    ds_read_b128 v[124:127], v3 offset:13312
    s_waitcnt lgkmcnt(7)
    v_mfma_f32_16x16x32_bf16 v[144:147], v[96:99], v[24:27], v[144:147]
    s_waitcnt lgkmcnt(6)
    v_mfma_f32_16x16x32_bf16 v[148:151], v[100:103], v[24:27], v[148:151]
    s_waitcnt lgkmcnt(5)
    v_mfma_f32_16x16x32_bf16 v[152:155], v[104:107], v[64:67], v[152:155]
    s_waitcnt lgkmcnt(4)
    v_mfma_f32_16x16x32_bf16 v[156:159], v[108:111], v[64:67], v[156:159]
    ds_read_b128 v[96:99], v2 offset:16384
    ds_read_b128 v[100:103], v2 offset:17408
    ds_read_b128 v[104:107], v3 offset:16384
    ds_read_b128 v[108:111], v3 offset:17408
    s_waitcnt lgkmcnt(7)
    v_mfma_f32_16x16x32_bf16 v[144:147], v[112:115], v[28:31], v[144:147]
    s_waitcnt lgkmcnt(6)
    v_mfma_f32_16x16x32_bf16 v[148:151], v[116:119], v[28:31], v[148:151]
    s_waitcnt lgkmcnt(5)
    v_mfma_f32_16x16x32_bf16 v[152:155], v[120:123], v[68:71], v[152:155]
    s_waitcnt lgkmcnt(4)
    v_mfma_f32_16x16x32_bf16 v[156:159], v[124:127], v[68:71], v[156:159]
    ds_read_b128 v[112:115], v2 offset:20480
    ds_read_b128 v[116:119], v2 offset:21504
    ds_read_b128 v[120:123], v3 offset:20480
    ds_read_b128 v[124:127], v3 offset:21504
    s_waitcnt lgkmcnt(7)
    v_mfma_f32_16x16x32_bf16 v[144:147], v[96:99], v[32:35], v[144:147]
    s_waitcnt lgkmcnt(6)
    v_mfma_f32_16x16x32_bf16 v[148:151], v[100:103], v[32:35], v[148:151]
    s_waitcnt lgkmcnt(5)
    v_mfma_f32_16x16x32_bf16 v[152:155], v[104:107], v[72:75], v[152:155]
    s_waitcnt lgkmcnt(4)
    v_mfma_f32_16x16x32_bf16 v[156:159], v[108:111], v[72:75], v[156:159]
    ds_read_b128 v[96:99], v2 offset:24576
    ds_read_b128 v[100:103], v2 offset:25600
    ds_read_b128 v[104:107], v3 offset:24576
    ds_read_b128 v[108:111], v3 offset:25600
    s_waitcnt lgkmcnt(7)
    v_mfma_f32_16x16x32_bf16 v[144:147], v[112:115], v[36:39], v[144:147]
    s_waitcnt lgkmcnt(6)
    v_mfma_f32_16x16x32_bf16 v[148:151], v[116:119], v[36:39], v[148:151]
    s_waitcnt lgkmcnt(5)
    v_mfma_f32_16x16x32_bf16 v[152:155], v[120:123], v[76:79], v[152:155]
    s_waitcnt lgkmcnt(4)
    v_mfma_f32_16x16x32_bf16 v[156:159], v[124:127], v[76:79], v[156:159]
    ds_read_b128 v[112:115], v2 offset:28672
    ds_read_b128 v[116:119], v2 offset:29696
    ds_read_b128 v[120:123], v3 offset:28672
    ds_read_b128 v[124:127], v3 offset:29696
    s_waitcnt lgkmcnt(7)
    v_mfma_f32_16x16x32_bf16 v[144:147], v[96:99], v[40:43], v[144:147]
    s_waitcnt lgkmcnt(6)
    v_mfma_f32_16x16x32_bf16 v[148:151], v[100:103], v[40:43], v[148:151]
    s_waitcnt lgkmcnt(5)
    v_mfma_f32_16x16x32_bf16 v[152:155], v[104:107], v[80:83], v[152:155]
    s_waitcnt lgkmcnt(4)
    v_mfma_f32_16x16x32_bf16 v[156:159], v[108:111], v[80:83], v[156:159]
    ds_read_b128 v[96:99], v2 offset:32768
    ds_read_b128 v[100:103], v2 offset:33792
    ds_read_b128 v[104:107], v3 offset:32768
    ds_read_b128 v[108:111], v3 offset:33792
    s_waitcnt lgkmcnt(7)
    v_mfma_f32_16x16x32_bf16 v[144:147], v[112:115], v[44:47], v[144:147]
    s_waitcnt lgkmcnt(6)
    v_mfma_f32_16x16x32_bf16 v[148:151], v[116:119], v[44:47], v[148:151]
    s_waitcnt lgkmcnt(5)
    v_mfma_f32_16x16x32_bf16 v[152:155], v[120:123], v[84:87], v[152:155]
    s_waitcnt lgkmcnt(4)
    v_mfma_f32_16x16x32_bf16 v[156:159], v[124:127], v[84:87], v[156:159]
    ds_read_b128 v[112:115], v2 offset:36864
    ds_read_b128 v[116:119], v2 offset:37888
    ds_read_b128 v[120:123], v3 offset:36864
    ds_read_b128 v[124:127], v3 offset:37888
    s_waitcnt lgkmcnt(7)
    v_mfma_f32_16x16x32_bf16 v[144:147], v[96:99], v[48:51], v[144:147]
    s_waitcnt lgkmcnt(6)
    v_mfma_f32_16x16x32_bf16 v[148:151], v[100:103], v[48:51], v[148:151]
    s_waitcnt lgkmcnt(5)
    v_mfma_f32_16x16x32_bf16 v[152:155], v[104:107], v[88:91], v[152:155]
    s_waitcnt lgkmcnt(4)
    v_mfma_f32_16x16x32_bf16 v[156:159], v[108:111], v[88:91], v[156:159]
    s_waitcnt lgkmcnt(3)
    v_mfma_f32_16x16x32_bf16 v[144:147], v[112:115], v[52:55], v[144:147]
    s_waitcnt lgkmcnt(2)
    v_mfma_f32_16x16x32_bf16 v[148:151], v[116:119], v[52:55], v[148:151]
    s_waitcnt lgkmcnt(1)
    v_mfma_f32_16x16x32_bf16 v[152:155], v[120:123], v[92:95], v[152:155]
    s_waitcnt lgkmcnt(0)
    v_mfma_f32_16x16x32_bf16 v[156:159], v[124:127], v[92:95], v[156:159]
    s_waitcnt vmcnt(0)
    s_barrier
    s_cmp_eq_u32 s52, 3
    s_cbranch_scc1 L_nod
    ds_read_b128 v[96:99], v4 offset:0
    ds_read_b128 v[100:103], v4 offset:1024
    ds_read_b128 v[104:107], v5 offset:0
    ds_read_b128 v[108:111], v5 offset:1024
    ds_read_b128 v[112:115], v4 offset:4096
    ds_read_b128 v[116:119], v4 offset:5120
    ds_read_b128 v[120:123], v5 offset:4096
    ds_read_b128 v[124:127], v5 offset:5120
    s_waitcnt lgkmcnt(7)
    v_mfma_f32_16x16x32_bf16 v[160:163], v[96:99], v[16:19], 0
    s_waitcnt lgkmcnt(6)
    v_mfma_f32_16x16x32_bf16 v[164:167], v[100:103], v[16:19], 0
    s_waitcnt lgkmcnt(5)
    v_mfma_f32_16x16x32_bf16 v[168:171], v[104:107], v[56:59], 0
    s_waitcnt lgkmcnt(4)
    v_mfma_f32_16x16x32_bf16 v[172:175], v[108:111], v[56:59], 0
    ds_read_b128 v[96:99], v4 offset:8192
    ds_read_b128 v[100:103], v4 offset:9216
    ds_read_b128 v[104:107], v5 offset:8192
    ds_read_b128 v[108:111], v5 offset:9216
    s_waitcnt lgkmcnt(7)
    v_mfma_f32_16x16x32_bf16 v[160:163], v[112:115], v[20:23], v[160:163]
    s_waitcnt lgkmcnt(6)
    v_mfma_f32_16x16x32_bf16 v[164:167], v[116:119], v[20:23], v[164:167]
    s_waitcnt lgkmcnt(5)
    v_mfma_f32_16x16x32_bf16 v[168:171], v[120:123], v[60:63], v[168:171]
    s_waitcnt lgkmcnt(4)
    v_mfma_f32_16x16x32_bf16 v[172:175], v[124:127], v[60:63], v[172:175]
    ds_read_b128 v[112:115], v4 offset:12288
    ds_read_b128 v[116:119], v4 offset:13312
    ds_read_b128 v[120:123], v5 offset:12288
    ds_read_b128 v[124:127], v5 offset:13312
    s_waitcnt lgkmcnt(7)
    v_mfma_f32_16x16x32_bf16 v[160:163], v[96:99], v[24:27], v[160:163]
    s_waitcnt lgkmcnt(6)
    v_mfma_f32_16x16x32_bf16 v[164:167], v[100:103], v[24:27], v[164:167]
    s_waitcnt lgkmcnt(5)
    v_mfma_f32_16x16x32_bf16 v[168:171], v[104:107], v[64:67], v[168:171]
    s_waitcnt lgkmcnt(4)
    v_mfma_f32_16x16x32_bf16 v[172:175], v[108:111], v[64:67], v[172:175]
    ds_read_b128 v[96:99], v4 offset:16384
    ds_read_b128 v[100:103], v4 offset:17408
    ds_read_b128 v[104:107], v5 offset:16384
    ds_read_b128 v[108:111], v5 offset:17408
    s_waitcnt lgkmcnt(7)
    v_mfma_f32_16x16x32_bf16 v[160:163], v[112:115], v[28:31], v[160:163]
    s_waitcnt lgkmcnt(6)
    v_mfma_f32_16x16x32_bf16 v[164:167], v[116:119], v[28:31], v[164:167]
    s_waitcnt lgkmcnt(5)
    v_mfma_f32_16x16x32_bf16 v[168:171], v[120:123], v[68:71], v[168:171]
    s_waitcnt lgkmcnt(4)
    v_mfma_f32_16x16x32_bf16 v[172:175], v[124:127], v[68:71], v[172:175]
    ds_read_b128 v[112:115], v4 offset:20480
    ds_read_b128 v[116:119], v4 offset:21504
    ds_read_b128 v[120:123], v5 offset:20480
    ds_read_b128 v[124:127], v5 offset:21504
    s_waitcnt lgkmcnt(7)
    v_mfma_f32_16x16x32_bf16 v[160:163], v[96:99], v[32:35], v[160:163]
    s_waitcnt lgkmcnt(6)
    v_mfma_f32_16x16x32_bf16 v[164:167], v[100:103], v[32:35], v[164:167]
    s_waitcnt lgkmcnt(5)
    v_mfma_f32_16x16x32_bf16 v[168:171], v[104:107], v[72:75], v[168:171]
    s_waitcnt lgkmcnt(4)
    v_mfma_f32_16x16x32_bf16 v[172:175], v[108:111], v[72:75], v[172:175]
    ds_read_b128 v[96:99], v4 offset:24576
    ds_read_b128 v[100:103], v4 offset:25600
    ds_read_b128 v[104:107], v5 offset:24576
    ds_read_b128 v[108:111], v5 offset:25600
    s_waitcnt lgkmcnt(7)
    v_mfma_f32_16x16x32_bf16 v[160:163], v[112:115], v[36:39], v[160:163]
    s_waitcnt lgkmcnt(6)
    v_mfma_f32_16x16x32_bf16 v[164:167], v[116:119], v[36:39], v[164:167]
    s_waitcnt lgkmcnt(5)
    v_mfma_f32_16x16x32_bf16 v[168:171], v[120:123], v[76:79], v[168:171]
    s_waitcnt lgkmcnt(4)
    v_mfma_f32_16x16x32_bf16 v[172:175], v[124:127], v[76:79], v[172:175]
    ds_read_b128 v[112:115], v4 offset:28672
    ds_read_b128 v[116:119], v4 offset:29696
    ds_read_b128 v[120:123], v5 offset:28672
    ds_read_b128 v[124:127], v5 offset:29696
    s_waitcnt lgkmcnt(7)
    v_mfma_f32_16x16x32_bf16 v[160:163], v[96:99], v[40:43], v[160:163]
    s_waitcnt lgkmcnt(6)
    v_mfma_f32_16x16x32_bf16 v[164:167], v[100:103], v[40:43], v[164:167]
    s_waitcnt lgkmcnt(5)
    v_mfma_f32_16x16x32_bf16 v[168:171], v[104:107], v[80:83], v[168:171]
    s_waitcnt lgkmcnt(4)
    v_mfma_f32_16x16x32_bf16 v[172:175], v[108:111], v[80:83], v[172:175]
    ds_read_b128 v[96:99], v4 offset:32768
    ds_read_b128 v[100:103], v4 offset:33792
    ds_read_b128 v[104:107], v5 offset:32768
    ds_read_b128 v[108:111], v5 offset:33792
    s_waitcnt lgkmcnt(7)
    v_mfma_f32_16x16x32_bf16 v[160:163], v[112:115], v[44:47], v[160:163]
    s_waitcnt lgkmcnt(6)
    v_mfma_f32_16x16x32_bf16 v[164:167], v[116:119], v[44:47], v[164:167]
    s_waitcnt lgkmcnt(5)
    v_mfma_f32_16x16x32_bf16 v[168:171], v[120:123], v[84:87], v[168:171]
    s_waitcnt lgkmcnt(4)
    v_mfma_f32_16x16x32_bf16 v[172:175], v[124:127], v[84:87], v[172:175]
    ds_read_b128 v[112:115], v4 offset:36864
    ds_read_b128 v[116:119], v4 offset:37888
    ds_read_b128 v[120:123], v5 offset:36864
    ds_read_b128 v[124:127], v5 offset:37888
    s_waitcnt lgkmcnt(7)
    v_mfma_f32_16x16x32_bf16 v[160:163], v[96:99], v[48:51], v[160:163]
    s_waitcnt lgkmcnt(6)
    v_mfma_f32_16x16x32_bf16 v[164:167], v[100:103], v[48:51], v[164:167]
    s_waitcnt lgkmcnt(5)
    v_mfma_f32_16x16x32_bf16 v[168:171], v[104:107], v[88:91], v[168:171]
    s_waitcnt lgkmcnt(4)
    v_mfma_f32_16x16x32_bf16 v[172:175], v[108:111], v[88:91], v[172:175]
    s_waitcnt lgkmcnt(3)
    v_mfma_f32_16x16x32_bf16 v[160:163], v[112:115], v[52:55], v[160:163]
    s_waitcnt lgkmcnt(2)
    v_mfma_f32_16x16x32_bf16 v[164:167], v[116:119], v[52:55], v[164:167]
    s_waitcnt lgkmcnt(1)
    v_mfma_f32_16x16x32_bf16 v[168:171], v[120:123], v[92:95], v[168:171]
    s_waitcnt lgkmcnt(0)
    v_mfma_f32_16x16x32_bf16 v[172:175], v[124:127], v[92:95], v[172:175]
    v_add_f32 v96, v144, v152
    v_sub_f32 v104, v144, v152
    v_add_f32 v97, v145, v153
    v_sub_f32 v105, v145, v153
    v_add_f32 v98, v146, v154
    v_sub_f32 v106, v146, v154
    v_add_f32 v99, v147, v155
    v_sub_f32 v107, v147, v155
    v_add_f32 v100, v148, v156
    v_sub_f32 v108, v148, v156
    v_add_f32 v101, v149, v157
    v_sub_f32 v109, v149, v157
    v_add_f32 v102, v150, v158
    v_sub_f32 v110, v150, v158
    v_add_f32 v103, v151, v159
    v_sub_f32 v111, v151, v159
    v_cvt_pk_bf16_f32 v112, v96, v97
    v_cvt_pk_bf16_f32 v113, v98, v99
    v_cvt_pk_bf16_f32 v114, v100, v101
    v_cvt_pk_bf16_f32 v115, v102, v103
    v_cvt_pk_bf16_f32 v116, v104, v105
    v_cvt_pk_bf16_f32 v117, v106, v107
    v_cvt_pk_bf16_f32 v118, v108, v109
    v_cvt_pk_bf16_f32 v119, v110, v111
    v_mfma_f32_16x16x32_bf16 v[176:179], v[112:115], v[220:223], 0
    v_mfma_f32_16x16x32_bf16 v[180:183], v[112:115], v[224:227], 0
    v_mfma_f32_16x16x32_bf16 v[184:187], v[116:119], v[220:223], 0
    v_mfma_f32_16x16x32_bf16 v[188:191], v[116:119], v[224:227], 0
    v_add_f32 v96, v160, v168
    v_sub_f32 v104, v160, v168
    v_add_f32 v97, v161, v169
    v_sub_f32 v105, v161, v169
    v_add_f32 v98, v162, v170
    v_sub_f32 v106, v162, v170
    v_add_f32 v99, v163, v171
    v_sub_f32 v107, v163, v171
    v_add_f32 v100, v164, v172
    v_sub_f32 v108, v164, v172
    v_add_f32 v101, v165, v173
    v_sub_f32 v109, v165, v173
    v_add_f32 v102, v166, v174
    v_sub_f32 v110, v166, v174
    v_add_f32 v103, v167, v175
    v_sub_f32 v111, v167, v175
    v_cvt_pk_bf16_f32 v120, v96, v97
    v_cvt_pk_bf16_f32 v121, v98, v99
    v_cvt_pk_bf16_f32 v122, v100, v101
    v_cvt_pk_bf16_f32 v123, v102, v103
    v_cvt_pk_bf16_f32 v124, v104, v105
    v_cvt_pk_bf16_f32 v125, v106, v107
    v_cvt_pk_bf16_f32 v126, v108, v109
    v_cvt_pk_bf16_f32 v127, v110, v111
    v_mfma_f32_16x16x32_bf16 v[192:195], v[120:123], v[228:231], 0
    v_mfma_f32_16x16x32_bf16 v[196:199], v[120:123], v[232:235], 0
    v_mfma_f32_16x16x32_bf16 v[200:203], v[124:127], v[228:231], 0
    v_mfma_f32_16x16x32_bf16 v[204:207], v[124:127], v[232:235], 0
    s_cmp_eq_u32 s52, 2
    s_cselect_b32 exec_hi, 0, -1
    v_mul_f32 v16, 0x35cccccd, v176
    v_mul_f32 v17, 0x35cccccd, v177
    v_mul_f32 v18, 0x35cccccd, v178
    v_mul_f32 v19, 0x35cccccd, v179
    ds_write_b128 v12, v[16:19] offset:0
    v_mul_f32 v20, 0x35cccccd, v180
    v_mul_f32 v21, 0x35cccccd, v181
    v_mul_f32 v22, 0x35cccccd, v182
    v_mul_f32 v23, 0x35cccccd, v183
    ds_write_b128 v12, v[20:23] offset:5120
    v_mul_f32 v24, 0x35cccccd, v187
    v_mul_f32 v25, 0x35cccccd, v186
    v_mul_f32 v26, 0x35cccccd, v185
    v_mul_f32 v27, 0x35cccccd, v184
    ds_write_b128 v13, v[24:27] offset:0
    v_mul_f32 v28, 0x35cccccd, v191
    v_mul_f32 v29, 0x35cccccd, v190
    v_mul_f32 v30, 0x35cccccd, v189
    v_mul_f32 v31, 0x35cccccd, v188
    ds_write_b128 v13, v[28:31] offset:5120
    v_mul_f32 v32, 0x35cccccd, v192
    v_mul_f32 v33, 0x35cccccd, v193
    v_mul_f32 v34, 0x35cccccd, v194
    v_mul_f32 v35, 0x35cccccd, v195
    ds_write_b128 v12, v[32:35] offset:10240
    v_mul_f32 v36, 0x35cccccd, v196
    v_mul_f32 v37, 0x35cccccd, v197
    v_mul_f32 v38, 0x35cccccd, v198
    v_mul_f32 v39, 0x35cccccd, v199
    ds_write_b128 v12, v[36:39] offset:15360
    v_mul_f32 v40, 0x35cccccd, v203
    v_mul_f32 v41, 0x35cccccd, v202
    v_mul_f32 v42, 0x35cccccd, v201
    v_mul_f32 v43, 0x35cccccd, v200
    ds_write_b128 v13, v[40:43] offset:10240
    v_mul_f32 v44, 0x35cccccd, v207
    v_mul_f32 v45, 0x35cccccd, v206
    v_mul_f32 v46, 0x35cccccd, v205
    v_mul_f32 v47, 0x35cccccd, v204
    ds_write_b128 v13, v[44:47] offset:15360
    s_mov_b64 exec, -1
L_nod:
    v_add_u32 v9, s7, v9
    s_mov_b32 s6, 2621440
    s_mov_b32 s7, 0x00020000
    v_add_u32 v9, 81920, v9
    s_waitcnt lgkmcnt(0)
    s_barrier
    s_barrier
    ds_read_b128 v[96:99], v9 offset:0
    ds_read_b128 v[100:103], v9 offset:4096
    ds_read_b128 v[104:107], v9 offset:8192
    s_waitcnt lgkmcnt(2)
    buffer_store_dwordx4 v[96:99], v212, s[4:7], 0 offen
    s_waitcnt lgkmcnt(1)
    buffer_store_dwordx4 v[100:103], v213, s[4:7], 0 offen
    s_waitcnt lgkmcnt(0)
    buffer_store_dwordx4 v[104:107], v214, s[4:7], 0 offen
L_end:
    s_endpgm
CODE_END:
    s_endpgm
.p2align 6
.type ORDER_TAB,@object
ORDER_TAB:
.long 339779968
.long 288125018
.long 305168533
.long 322212054
.long 255349015
.long 1624
.long 0
.long 0
.long 851085598
.long 799430619
.long 714737459
.long 663084336
.long 596335723
.long 2924
.long 0
.long 0
.long 441516678
.long 352367041
.long 289980930
.long 390910531
.long 406643030
.long 281
.long 0
.long 0
.long 466283044
.long 863672671
.long 799696924
.long 731780980
.long 747515248
.long 3181
.long 0
.long 0
.long 23675914
.long 35128007
.long 356852488
.long 375206729
.long 425784195
.long 324
.long 0
.long 0
.long 527379368
.long 479324773
.long 868133280
.long 816740445
.long 766654644
.long 3441
.long 0
.long 0
.long 117810448
.long 136863755
.long 39130252
.long 56194253
.long 73761737
.long 901
.long 0
.long 0
.long 628997294
.long 547506089
.long 483326630
.long 885176801
.long 834062557
.long 2229
.long 0
.long 0
.long 186390164
.long 205562240
.long 134829138
.long 151872979
.long 85038605
.long 974
.long 0
.long 0
.long 697693938
.long 649759006
.long 544422890
.long 500370151
.long 902224673
.long 2274
.long 0
.long 0
.long 2912346
.long 307298950
.long 203433297
.long 220476823
.long 236209747
.long 1551
.long 0
.long 0
.long 514217947
.long 717941284
.long 646040815
.long 561466411
.long 584522599
.long 2851
.long 0
.long 0
.long 100708801
.long 292111370
.long 305168533
.long 322212054
.long 255349015
.long 1624
.long 0
.long 0
.long 612014431
.long 795814824
.long 714737459
.long 663084336
.long 596335723
.long 2924
.long 0
.long 0
.long 169345735
.long 352691472
.long 289980930
.long 390910531
.long 406643030
.long 281
.long 0
.long 0
.long 680651365
.long 863878318
.long 799696924
.long 731780980
.long 747515248
.long 3181
.long 0
.long 0
.section .rodata,"a"
.p2align 6
.amdhsa_kernel recurrent_scan__spectral_gfnet__mixer_channel_mlp__prompt_kernel
  .amdhsa_next_free_vgpr 256
  .amdhsa_next_free_sgpr 102
  .amdhsa_accum_offset 256
  .amdhsa_group_segment_fixed_size 0
  .amdhsa_kernarg_size 88
  .amdhsa_user_sgpr_count 2
  .amdhsa_user_sgpr_kernarg_segment_ptr 1
  .amdhsa_system_sgpr_workgroup_id_x 1
.end_amdhsa_kernel
```
